```python
import torch

def _softmax(x, axis=-1):
    return torch.softmax(x, dim=axis)

def _gelu(x):
    return torch.nn.functional.gelu(x, approximate='tanh')

def _silu(x):
    return torch.nn.functional.silu(x)

def _sigmoid(x):
    return torch.sigmoid(x)

def _layernorm(x, axis=-1, eps=1e-05):
    m = x.mean(dim=axis, keepdim=True)
    v = x.var(dim=axis, keepdim=True, unbiased=False)
    return (x - m) / torch.sqrt(v + eps)

def _scatter_add(tgt, idx, src, axis=0):
    return tgt.clone().index_add_(axis, idx, src)

def _segment_sum(src, seg, n):
    out = torch.zeros((n,) + src.shape[1:], dtype=src.dtype)
    return out.index_add_(0, seg, src)

def _pad(x, pw):
    flat = tuple((v for pair in reversed(pw) for v in pair))
    return torch.nn.functional.pad(x, flat)
kernel_name = 'adaLN_cond__sliding_block_cached__mixer_gmlp__prompt'

def setup_inputs():

    _w = lambda a: (lambda t: t.to(torch.bfloat16) if t.is_floating_point() else t)(torch.as_tensor(a))

    def _A_setup():
        B, Sq, D = (1, 2048, 512)
        Hq, Hkv, Sk, Dh = (32, 8, 2048, 128)
        assert Hq % Hkv == 0, (Hq, Hkv)
        return {'x': _w((lambda *s: torch.randn(*s, dtype=torch.bfloat16) * 0.1)(B, Sq, D)), 'k_cache': _w((lambda *s: torch.randn(*s, dtype=torch.bfloat16) * 0.8)(B, Hkv, Sk, Dh)), 'v_cache': _w((lambda *s: torch.randn(*s, dtype=torch.bfloat16) * 1.6)(B, Hkv, Sk, Dh)), 'wq': _w((lambda *s: torch.randn(*s, dtype=torch.bfloat16) * 0.8)(D, Hq * Dh) * D ** (-0.5)), 'wo': _w((lambda *s: torch.randn(*s, dtype=torch.bfloat16) * 1.6)(Hq * Dh, D) * (Hq * Dh) ** (-0.5))}
    _A_in = _A_setup()

    def _B_setup():
        B, S, D, F = (1, 2048, 512, 1792)
        Fh = F // 2
        return {'x': _w((lambda *s: torch.randn(*s, dtype=torch.bfloat16) * 0.1)(B, S, D)), 'w_in': _w((lambda *s: torch.randn(*s, dtype=torch.bfloat16) * 1.6)(D, 2 * Fh)), 'w_sp': _w(0.01 * (lambda *s: torch.randn(*s, dtype=torch.bfloat16) * 1.6)(S, S)), 'b_sp': _w(1.0 + 0.01 * (lambda *s: torch.randn(*s, dtype=torch.bfloat16) * 0.2)(S)), 'w_out': _w((lambda *s: torch.randn(*s, dtype=torch.bfloat16) * 0.2)(Fh, D))}
    _B_in = _B_setup()
    return {'A_x': _A_in['x'], 'A_k_cache': _A_in['k_cache'], 'A_v_cache': _A_in['v_cache'], 'A_wq': _A_in['wq'], 'A_wo': _A_in['wo'], 'B_x': _B_in['x'], 'B_w_in': _B_in['w_in'], 'B_w_sp': _B_in['w_sp'], 'B_b_sp': _B_in['b_sp'], 'B_w_out': _B_in['w_out'], 'c': _w((lambda *s: torch.randn(*s, dtype=torch.bfloat16) * 0.8)(1, 512) * 8.0), 'w_mod': _w((lambda *s: torch.randn(*s, dtype=torch.bfloat16) * 0.8)(512, 6 * 512) * 512 ** (-0.5) * 8.0)}

def reference(A_x, A_k_cache, A_v_cache, A_wq, A_wo, B_x, B_w_in, B_w_sp, B_b_sp, B_w_out, c, w_mod):

    def _A_ref(x, k_cache, v_cache, wq, wo):
        B, Sq, D = x.shape
        Hq, Dh = (32, 128)
        Hkv, Sk = (k_cache.shape[1], k_cache.shape[2])
        W = min(4096, max(256, Sk // 4))
        rep = Hq // Hkv
        q = (lambda x, *d: x.permute(*d))((x @ wq).reshape(B, Sq, Hq, Dh), 0, 2, 1, 3)
        k = (lambda x, n, axis: torch.repeat_interleave(x, n, dim=axis))(k_cache[:, :, Sk - W:, :], rep, axis=1)
        v = (lambda x, n, axis: torch.repeat_interleave(x, n, dim=axis))(v_cache[:, :, Sk - W:, :], rep, axis=1)
        scores = torch.einsum('bhqd,bhkd->bhqk', q, k) * Dh ** (-0.5)
        p = _softmax(scores, axis=-1)
        o = torch.einsum('bhqk,bhkd->bhqd', p, v)
        return (lambda x, *d: x.permute(*d))(o, 0, 2, 1, 3).reshape(B, Sq, Hq * Dh) @ wo

    def _B_ref(x, w_in, w_sp, b_sp, w_out):
        B, S, D = x.shape
        F = w_in.shape[-1]
        Fh = F // 2
        z = _gelu(torch.einsum('bsd,df->bsf', x, w_in))
        z1 = z[..., :Fh].clone()
        z2 = _layernorm(z[..., Fh:], axis=-1)
        g = torch.einsum('ts,bsf->btf', w_sp, z2) + b_sp[None, :, None]
        return torch.einsum('bsf,fd->bsd', z1 * g, w_out)
    x = A_x
    mod = (_silu(c) @ w_mod).reshape(c.shape[0], 6, 1, -1)
    sa, ca, ga, sb, cb, gb = (mod[:, 0].clone(), mod[:, 1].clone(), mod[:, 2].clone(), mod[:, 3].clone(), mod[:, 4].clone(), mod[:, 5].clone())
    h = _layernorm(x, axis=-1) * (1 + ca) + sa
    x = x + ga * _A_ref(h, A_k_cache, A_v_cache, A_wq, A_wo)
    h = _layernorm(x, axis=-1) * (1 + cb) + sb
    x = x + gb * _B_ref(h, B_w_in, B_w_sp, B_b_sp, B_w_out)
    return x
```

```asm
; @launch grid=(256,1,1) block=(256,1,1) lds=163840
.amdgcn_target "amdgcn-amd-amdhsa--gfx950"
.text
.globl adaLN_cond__sliding_block_cached__mixer_gmlp__prompt_kernel
.p2align 8
.type adaLN_cond__sliding_block_cached__mixer_gmlp__prompt_kernel,@function
adaLN_cond__sliding_block_cached__mixer_gmlp__prompt_kernel:
  s_cmp_ge_u32 s2, 256
  s_cbranch_scc0 K1_GO
  s_endpgm
K1_GO:
  s_load_dwordx4 s[8:11], s[0:1], 80
  s_load_dwordx2 s[38:39], s[0:1], 0
  s_load_dwordx4 s[52:55], s[0:1], 104
  s_load_dwordx4 s[56:59], s[0:1], 24
  s_load_dwordx4 s[12:15], s[0:1], 8
  s_load_dwordx4 s[60:63], s[0:1], 48
  s_load_dwordx2 s[36:37], s[0:1], 72
  v_and_b32 v1, 63, v0
  v_lshrrev_b32 v2, 6, v0
  s_nop 0
  v_readfirstlane_b32 s32, v2
  s_and_b32 s33, s2, 3
  s_lshl_b32 s33, s33, 1
  s_bfe_u32 s46, s2, 0x10003
  s_add_u32 s33, s33, s46
  s_lshr_b32 s40, s2, 4
  s_mov_b32 s34, s40
  s_bfe_u32 s46, s2, 0x10002
  s_lshl_b32 s46, s46, 4
  s_add_u32 s34, s34, s46
  s_and_b32 s35, s2, 0xc0
  s_and_b32 s46, s2, 7
  s_lshl_b32 s46, s46, 3
  s_add_u32 s35, s35, s46
  s_bfe_u32 s46, s2, 0x30003
  s_add_u32 s35, s35, s46
  v_lshrrev_b32 v32, 1, v0
  v_and_b32 v33, 1, v0
  v_lshlrev_b32 v33, 4, v33
  v_mul_u32_u24 v34, 6144, v32
  v_add_u32 v34, v34, v33
  s_lshl_b32 s46, s35, 5
  v_add_u32 v34, s46, v34
  v_lshlrev_b32 v35, 1, v32
  v_lshrrev_b32 v36, 2, v1
  v_and_b32 v37, 3, v1
  v_lshlrev_b32 v38, 10, v36
  v_lshl_add_u32 v38, v37, 4, v38
  s_lshl_b32 s46, s34, 16
  s_lshl_b32 s47, s32, 14
  s_add_u32 s46, s46, s47
  s_mov_b32 s42, 0xffff0000
  s_waitcnt lgkmcnt(0)
  s_mov_b32 s20, s8
  s_mov_b32 s21, s9
  s_mov_b32 s22, 0x400
  s_mov_b32 s23, 0x20000
  s_mov_b32 s24, s10
  s_mov_b32 s25, s11
  s_mov_b32 s26, 0x300000
  s_mov_b32 s27, 0x20000
  s_add_u32 s16, s38, s46
  s_addc_u32 s17, s39, 0
  s_mov_b32 s18, 0x4000
  s_mov_b32 s19, 0x20000
  s_cmp_ge_u32 s2, 64
  s_cbranch_scc1 K1_XFIRST
  buffer_load_ushort v224, v35, s[20:23], 0 offen offset:0
  buffer_load_ushort v225, v35, s[20:23], 0 offen offset:256
  buffer_load_ushort v226, v35, s[20:23], 0 offen offset:512
  buffer_load_ushort v227, v35, s[20:23], 0 offen offset:768
  buffer_load_dwordx4 v[228:231], v34, s[24:27], 0 offen
  s_mov_b32 s47, 786432
  buffer_load_dwordx4 v[232:235], v34, s[24:27], s47 offen
  s_mov_b32 s47, 1572864
  buffer_load_dwordx4 v[236:239], v34, s[24:27], s47 offen
  s_mov_b32 s47, 2359296
  buffer_load_dwordx4 v[240:243], v34, s[24:27], s47 offen
  s_add_u32 s96, s54, 0x10000
  s_addc_u32 s97, s55, 0
  s_mov_b32 s98, 0x24000
  s_mov_b32 s99, 0x20000
  v_mov_b32 v40, 0
  v_mov_b32 v41, 0
  v_mov_b32 v42, 0
  v_mov_b32 v43, 0
  s_lshl_b32 s46, s2, 12
  v_lshlrev_b32 v44, 4, v0
  buffer_store_dwordx4 v[40:43], v44, s[96:99], s46 offen sc1
K1_XFIRST:
  s_lshl_b32 s48, s32, 12
  s_add_u32 s43, s32, 4
  s_lshl_b32 s43, s43, 14
  v_lshrrev_b32 v80, 4, v1
  v_and_b32 v81, 15, v1
  v_lshlrev_b32 v82, 2, v80
  v_xor_b32 v81, v81, v82
  v_lshlrev_b32 v81, 4, v81
  v_mul_u32_u24 v80, 8192, v80
  v_add_u32 v2, v80, v81
  v_add_u32 v3, 31744, v2
  v_add_u32 v4, 63488, v2
  v_add_u32 v5, 95232, v2
  v_lshrrev_b32 v80, 5, v1
  v_lshlrev_b32 v80, 11, v80
  v_bfe_u32 v81, v1, 2, 2
  v_lshl_add_u32 v80, v81, 8, v80
  v_bfe_u32 v82, v1, 4, 1
  v_lshl_add_u32 v80, v82, 5, v80
  v_and_b32 v82, 1, v1
  v_lshl_add_u32 v80, v82, 4, v80
  v_bfe_u32 v82, v1, 1, 1
  v_lshl_add_u32 v80, v82, 3, v80
  v_add_u32 v80, s43, v80
  v_xor_b32 v83, 0, v81
  v_lshl_add_u32 v6, v83, 6, v80
  v_xor_b32 v83, 1, v81
  v_lshl_add_u32 v7, v83, 6, v80
  v_xor_b32 v83, 2, v81
  v_lshl_add_u32 v8, v83, 6, v80
  v_xor_b32 v83, 3, v81
  v_lshl_add_u32 v9, v83, 6, v80
  s_mov_b32 s44, 0
  s_mov_b32 s49, 131072
  s_lshl_b32 s46, s33, 10
  s_lshl_b32 s47, s32, 8
  s_add_u32 s46, s46, s47
  s_add_u32 s4, s56, s46
  s_addc_u32 s5, s57, 0
  s_mov_b32 s6, 0x3fe100
  s_mov_b32 s7, 0x20000
  s_mov_b32 s50, s58
  s_mov_b32 s51, s59
  s_mov_b32 s58, s12
  s_mov_b32 s59, s13
  s_lshl_b32 s46, s33, 19
  s_lshl_b32 s47, s34, 12
  s_add_u32 s47, s47, s46
  s_add_u32 s96, s14, 0x60000
  s_addc_u32 s97, s15, 0
  s_add_u32 s96, s96, s47
  s_addc_u32 s97, s97, 0
  s_mov_b32 s98, 0x1000
  s_mov_b32 s99, 0x20000
  s_add_u32 s46, s46, s48
  s_add_u32 s8, s58, 0x60000
  s_addc_u32 s9, s59, 0
  s_add_u32 s8, s8, s46
  s_addc_u32 s9, s9, 0
  s_mov_b32 s10, 0x20000
  s_mov_b32 s11, 0x20000
  s_sub_u32 s10, s10, s48
  s_lshl_b32 s46, s33, 17
  s_add_u32 s46, s46, s48
  s_add_u32 s12, s54, 0x300000
  s_addc_u32 s13, s55, 0
  s_add_u32 s12, s12, s46
  s_addc_u32 s13, s13, 0
  s_mov_b32 s14, 0x20000
  s_mov_b32 s15, 0x20000
  s_sub_u32 s14, s14, s48
  s_add_u32 s28, s54, 0x4000
  s_addc_u32 s29, s55, 0
  s_mov_b32 s30, 0x1000
  s_mov_b32 s31, 0x20000
  s_mov_b32 s41, 0x400293ee
  s_and_b32 s46, s32, 1
  s_lshl_b32 s46, s46, 4
  v_add_u32 v39, s46, v36
  v_lshlrev_b32 v84, 1, v37
  v_xor_b32 v39, v39, v84
  v_lshlrev_b32 v39, 4, v39
  v_lshrrev_b32 v84, 1, v37
  v_lshl_add_u32 v39, v84, 11, v39
  v_and_b32 v84, 1, v37
  v_lshl_add_u32 v39, v84, 9, v39
  s_lshr_b32 s46, s32, 1
  s_lshl_b32 s46, s46, 10
  v_add_u32 v30, s46, v39
  v_lshlrev_b32 v84, 5, v37
  v_add_u32 v31, 147456, v84
  v_and_b32 v45, 0x13, v1
  v_and_b32 v84, 4, v1
  v_and_b32 v85, 8, v1
  v_lshl_add_u32 v45, v84, 1, v45
  v_lshrrev_b32 v85, 1, v85
  v_add_u32 v45, v45, v85
  v_lshlrev_b32 v45, 1, v45
  s_lshl_b32 s46, s32, 6
  v_add_u32 v45, s46, v45
  v_lshrrev_b32 v84, 5, v1
  v_lshl_add_u32 v45, v84, 10, v45
  v_lshrrev_b32 v84, 4, v1
  v_and_b32 v85, 15, v1
  v_xor_b32 v85, v85, v84
  v_lshlrev_b32 v84, 8, v84
  v_xor_b32 v86, 0, v85
  v_lshl_add_u32 v12, v86, 4, v84
  v_xor_b32 v86, 4, v85
  v_lshl_add_u32 v13, v86, 4, v84
  v_xor_b32 v86, 8, v85
  v_lshl_add_u32 v14, v86, 4, v84
  v_xor_b32 v86, 12, v85
  v_lshl_add_u32 v15, v86, 4, v84
  v_lshlrev_b32 v24, 4, v1
  v_lshrrev_b32 v84, 5, v1
  v_and_b32 v85, 31, v1
  v_lshlrev_b32 v86, 1, v84
  v_xor_b32 v85, v85, v86
  v_lshlrev_b32 v84, 9, v84
  v_lshl_add_u32 v10, v85, 4, v84
  v_xor_b32 v85, 4, v85
  v_lshl_add_u32 v11, v85, 4, v84
  v_and_b32 v84, 31, v1
  v_lshlrev_b32 v84, 8, v84
  v_add_u32 v84, 0x20000, v84
  v_lshrrev_b32 v85, 5, v1
  v_and_b32 v86, 15, v1
  v_xor_b32 v85, v85, v86
  v_xor_b32 v86, 0, v85
  v_lshl_add_u32 v16, v86, 4, v84
  v_xor_b32 v86, 2, v85
  v_lshl_add_u32 v17, v86, 4, v84
  v_xor_b32 v86, 4, v85
  v_lshl_add_u32 v18, v86, 4, v84
  v_xor_b32 v86, 6, v85
  v_lshl_add_u32 v19, v86, 4, v84
  v_xor_b32 v86, 8, v85
  v_lshl_add_u32 v20, v86, 4, v84
  v_xor_b32 v86, 10, v85
  v_lshl_add_u32 v21, v86, 4, v84
  v_xor_b32 v86, 12, v85
  v_lshl_add_u32 v22, v86, 4, v84
  v_xor_b32 v86, 14, v85
  v_lshl_add_u32 v23, v86, 4, v84
  v_lshrrev_b32 v84, 2, v1
  v_lshrrev_b32 v85, 4, v1
  v_xor_b32 v84, v84, v85
  v_and_b32 v84, 1, v84
  v_mov_b32 v85, 0x3f803f80
  v_cmp_eq_u32 vcc, 0, v84
  s_nop 1
  v_cndmask_b32 v84, 0, v85, vcc
  v_accvgpr_write_b32 a232, v84
  v_accvgpr_write_b32 a233, v84
  v_accvgpr_write_b32 a234, v84
  v_accvgpr_write_b32 a235, v84
  v_mov_b32 v26, 0xfc00fc00
  v_mov_b32 v27, 0xfc00fc00
  s_sub_u32 s3, s2, 64
  s_cmp_ge_u32 s3, 128
  s_cbranch_scc1 K1_NOGL
  buffer_load_ushort v224, v35, s[20:23], 0 offen offset:0
  buffer_load_ushort v225, v35, s[20:23], 0 offen offset:256
  buffer_load_ushort v226, v35, s[20:23], 0 offen offset:512
  buffer_load_ushort v227, v35, s[20:23], 0 offen offset:768
  buffer_load_dwordx4 v[228:231], v34, s[24:27], 0 offen
  s_mov_b32 s47, 786432
  buffer_load_dwordx4 v[232:235], v34, s[24:27], s47 offen
  s_mov_b32 s47, 1572864
  buffer_load_dwordx4 v[236:239], v34, s[24:27], s47 offen
  s_mov_b32 s47, 2359296
  buffer_load_dwordx4 v[240:243], v34, s[24:27], s47 offen
K1_NOGL:
  buffer_load_dwordx4 v[160:163], v38, s[16:19], 0 offen offset:0
  buffer_load_dwordx4 v[164:167], v38, s[16:19], 0 offen offset:64
  buffer_load_dwordx4 v[168:171], v38, s[16:19], 0 offen offset:128
  buffer_load_dwordx4 v[172:175], v38, s[16:19], 0 offen offset:192
  buffer_load_dwordx4 v[176:179], v38, s[16:19], 0 offen offset:256
  buffer_load_dwordx4 v[180:183], v38, s[16:19], 0 offen offset:320
  buffer_load_dwordx4 v[184:187], v38, s[16:19], 0 offen offset:384
  buffer_load_dwordx4 v[188:191], v38, s[16:19], 0 offen offset:448
  buffer_load_dwordx4 v[192:195], v38, s[16:19], 0 offen offset:512
  buffer_load_dwordx4 v[196:199], v38, s[16:19], 0 offen offset:576
  buffer_load_dwordx4 v[200:203], v38, s[16:19], 0 offen offset:640
  buffer_load_dwordx4 v[204:207], v38, s[16:19], 0 offen offset:704
  buffer_load_dwordx4 v[208:211], v38, s[16:19], 0 offen offset:768
  buffer_load_dwordx4 v[212:215], v38, s[16:19], 0 offen offset:832
  buffer_load_dwordx4 v[216:219], v38, s[16:19], 0 offen offset:896
  buffer_load_dwordx4 v[220:223], v38, s[16:19], 0 offen offset:960
  buffer_load_ushort a0, v45, s[96:99], 0 offen offset:0
  buffer_load_ushort a1, v45, s[96:99], 0 offen offset:256
  buffer_load_ushort a2, v45, s[96:99], 0 offen offset:512
  buffer_load_ushort a3, v45, s[96:99], 0 offen offset:768
  buffer_load_ushort a4, v45, s[96:99], 0 offen offset:2048
  buffer_load_ushort a5, v45, s[96:99], 0 offen offset:2304
  buffer_load_ushort a6, v45, s[96:99], 0 offen offset:2560
  buffer_load_ushort a7, v45, s[96:99], 0 offen offset:2816
  s_cmp_ge_u32 s2, 64
  s_cbranch_scc1 K1_NOGU
  s_mov_b32 s46, 0xbfb8aa3b
  s_mov_b32 s47, 0xb2a57060
  s_mov_b32 s45, 0x3f317218
  s_waitcnt vmcnt(29)
  v_lshlrev_b32 v224, 16, v224
  v_lshlrev_b32 v225, 16, v225
  v_lshlrev_b32 v226, 16, v226
  v_lshlrev_b32 v227, 16, v227
  v_mul_f32 v48, s46, v224
  v_mul_f32 v49, s46, v225
  v_mul_f32 v50, s46, v226
  v_mul_f32 v51, s46, v227
  v_fma_f32 v52, v224, s46, -v48
  v_fma_f32 v53, v225, s46, -v49
  v_fma_f32 v54, v226, s46, -v50
  v_fma_f32 v55, v227, s46, -v51
  v_fma_f32 v52, v224, s47, v52
  v_fma_f32 v53, v225, s47, v53
  v_fma_f32 v54, v226, s47, v54
  v_fma_f32 v55, v227, s47, v55
  v_min_f32 v48, 0x42fc0000, v48
  v_min_f32 v49, 0x42fc0000, v49
  v_min_f32 v50, 0x42fc0000, v50
  v_min_f32 v51, 0x42fc0000, v51
  v_exp_f32 v48, v48
  v_exp_f32 v49, v49
  v_exp_f32 v50, v50
  v_exp_f32 v51, v51
  v_mul_f32 v52, s45, v52
  v_mul_f32 v53, s45, v53
  v_mul_f32 v54, s45, v54
  v_mul_f32 v55, s45, v55
  v_fma_f32 v48, v48, v52, v48
  v_fma_f32 v49, v49, v53, v49
  v_fma_f32 v50, v50, v54, v50
  v_fma_f32 v51, v51, v55, v51
  v_add_f32 v52, 1.0, v48
  v_add_f32 v53, 1.0, v49
  v_add_f32 v54, 1.0, v50
  v_add_f32 v55, 1.0, v51
  v_rcp_f32 v52, v52
  v_rcp_f32 v53, v53
  v_rcp_f32 v54, v54
  v_rcp_f32 v55, v55
  v_mul_f32 v56, v224, v52
  v_mul_f32 v57, v225, v53
  v_mul_f32 v58, v226, v54
  v_mul_f32 v59, v227, v55
  v_sub_f32 v224, v224, v56
  v_sub_f32 v225, v225, v57
  v_sub_f32 v226, v226, v58
  v_sub_f32 v227, v227, v59
  v_fma_f32 v224, -v56, v48, v224
  v_fma_f32 v225, -v57, v49, v225
  v_fma_f32 v226, -v58, v50, v226
  v_fma_f32 v227, -v59, v51, v227
  v_fma_f32 v224, v224, v52, v56
  v_fma_f32 v225, v225, v53, v57
  v_fma_f32 v226, v226, v54, v58
  v_fma_f32 v227, v227, v55, v59
  v_cvt_pk_bf16_f32 v224, 0, v224
  v_cvt_pk_bf16_f32 v225, 0, v225
  v_cvt_pk_bf16_f32 v226, 0, v226
  v_cvt_pk_bf16_f32 v227, 0, v227
  s_waitcnt vmcnt(28)
  v_lshlrev_b32 v72, 16, v228
  v_and_b32 v73, s42, v228
  v_lshlrev_b32 v74, 16, v229
  v_and_b32 v75, s42, v229
  v_lshlrev_b32 v76, 16, v230
  v_and_b32 v77, s42, v230
  v_lshlrev_b32 v78, 16, v231
  v_and_b32 v79, s42, v231
  v_mul_f32 v64, v224, v72
  v_mul_f32 v65, v224, v73
  v_mul_f32 v66, v224, v74
  v_mul_f32 v67, v224, v75
  v_mul_f32 v68, v224, v76
  v_mul_f32 v69, v224, v77
  v_mul_f32 v70, v224, v78
  v_mul_f32 v71, v224, v79
  s_waitcnt vmcnt(27)
  v_lshlrev_b32 v72, 16, v232
  v_and_b32 v73, s42, v232
  v_lshlrev_b32 v74, 16, v233
  v_and_b32 v75, s42, v233
  v_lshlrev_b32 v76, 16, v234
  v_and_b32 v77, s42, v234
  v_lshlrev_b32 v78, 16, v235
  v_and_b32 v79, s42, v235
  v_fmac_f32 v64, v225, v72
  v_fmac_f32 v65, v225, v73
  v_fmac_f32 v66, v225, v74
  v_fmac_f32 v67, v225, v75
  v_fmac_f32 v68, v225, v76
  v_fmac_f32 v69, v225, v77
  v_fmac_f32 v70, v225, v78
  v_fmac_f32 v71, v225, v79
  s_waitcnt vmcnt(26)
  v_lshlrev_b32 v72, 16, v236
  v_and_b32 v73, s42, v236
  v_lshlrev_b32 v74, 16, v237
  v_and_b32 v75, s42, v237
  v_lshlrev_b32 v76, 16, v238
  v_and_b32 v77, s42, v238
  v_lshlrev_b32 v78, 16, v239
  v_and_b32 v79, s42, v239
  v_fmac_f32 v64, v226, v72
  v_fmac_f32 v65, v226, v73
  v_fmac_f32 v66, v226, v74
  v_fmac_f32 v67, v226, v75
  v_fmac_f32 v68, v226, v76
  v_fmac_f32 v69, v226, v77
  v_fmac_f32 v70, v226, v78
  v_fmac_f32 v71, v226, v79
  s_waitcnt vmcnt(25)
  v_lshlrev_b32 v72, 16, v240
  v_and_b32 v73, s42, v240
  v_lshlrev_b32 v74, 16, v241
  v_and_b32 v75, s42, v241
  v_lshlrev_b32 v76, 16, v242
  v_and_b32 v77, s42, v242
  v_lshlrev_b32 v78, 16, v243
  v_and_b32 v79, s42, v243
  v_fmac_f32 v64, v227, v72
  v_fmac_f32 v65, v227, v73
  v_fmac_f32 v66, v227, v74
  v_fmac_f32 v67, v227, v75
  v_fmac_f32 v68, v227, v76
  v_fmac_f32 v69, v227, v77
  v_fmac_f32 v70, v227, v78
  v_fmac_f32 v71, v227, v79
  v_add_f32_dpp v64, v64, v64 row_ror:2 row_mask:0xf bank_mask:0xf
  v_add_f32_dpp v65, v65, v65 row_ror:2 row_mask:0xf bank_mask:0xf
  v_add_f32_dpp v66, v66, v66 row_ror:2 row_mask:0xf bank_mask:0xf
  v_add_f32_dpp v67, v67, v67 row_ror:2 row_mask:0xf bank_mask:0xf
  v_add_f32_dpp v68, v68, v68 row_ror:2 row_mask:0xf bank_mask:0xf
  v_add_f32_dpp v69, v69, v69 row_ror:2 row_mask:0xf bank_mask:0xf
  v_add_f32_dpp v70, v70, v70 row_ror:2 row_mask:0xf bank_mask:0xf
  v_add_f32_dpp v71, v71, v71 row_ror:2 row_mask:0xf bank_mask:0xf
  v_add_f32_dpp v64, v64, v64 row_ror:4 row_mask:0xf bank_mask:0xf
  v_add_f32_dpp v65, v65, v65 row_ror:4 row_mask:0xf bank_mask:0xf
  v_add_f32_dpp v66, v66, v66 row_ror:4 row_mask:0xf bank_mask:0xf
  v_add_f32_dpp v67, v67, v67 row_ror:4 row_mask:0xf bank_mask:0xf
  v_add_f32_dpp v68, v68, v68 row_ror:4 row_mask:0xf bank_mask:0xf
  v_add_f32_dpp v69, v69, v69 row_ror:4 row_mask:0xf bank_mask:0xf
  v_add_f32_dpp v70, v70, v70 row_ror:4 row_mask:0xf bank_mask:0xf
  v_add_f32_dpp v71, v71, v71 row_ror:4 row_mask:0xf bank_mask:0xf
  v_add_f32_dpp v64, v64, v64 row_ror:8 row_mask:0xf bank_mask:0xf
  v_add_f32_dpp v65, v65, v65 row_ror:8 row_mask:0xf bank_mask:0xf
  v_add_f32_dpp v66, v66, v66 row_ror:8 row_mask:0xf bank_mask:0xf
  v_add_f32_dpp v67, v67, v67 row_ror:8 row_mask:0xf bank_mask:0xf
  v_add_f32_dpp v68, v68, v68 row_ror:8 row_mask:0xf bank_mask:0xf
  v_add_f32_dpp v69, v69, v69 row_ror:8 row_mask:0xf bank_mask:0xf
  v_add_f32_dpp v70, v70, v70 row_ror:8 row_mask:0xf bank_mask:0xf
  v_add_f32_dpp v71, v71, v71 row_ror:8 row_mask:0xf bank_mask:0xf
  v_lshrrev_b32 v224, 4, v0
  v_lshlrev_b32 v224, 6, v224
  v_and_b32 v225, 1, v0
  v_lshl_add_u32 v224, v225, 5, v224
  v_add_u32 v224, 151552, v224
  v_and_b32 v225, 15, v0
  v_cmp_gt_u32 vcc, 2, v225
  s_and_saveexec_b64 s[100:101], vcc
  ds_write_b128 v224, v[64:67]
  ds_write_b128 v224, v[68:71] offset:16
  s_mov_b64 exec, s[100:101]
  s_waitcnt lgkmcnt(0) vmcnt(24)
  s_cmp_eq_u32 s32, 0
  s_cbranch_scc1 K1_FINU
  s_barrier
  s_branch K1_DONEU
K1_FINU:
  s_barrier
  s_mov_b64 exec, 0xffff
  v_lshlrev_b32 v224, 2, v1
  v_add_u32 v225, 151552, v224
  ds_read_b32 v228, v225 offset:0
  ds_read_b32 v229, v225 offset:64
  ds_read_b32 v230, v225 offset:128
  ds_read_b32 v231, v225 offset:192
  ds_read_b32 v232, v225 offset:256
  ds_read_b32 v233, v225 offset:320
  ds_read_b32 v234, v225 offset:384
  ds_read_b32 v235, v225 offset:448
  ds_read_b32 v236, v225 offset:512
  ds_read_b32 v237, v225 offset:576
  ds_read_b32 v238, v225 offset:640
  ds_read_b32 v239, v225 offset:704
  ds_read_b32 v240, v225 offset:768
  ds_read_b32 v241, v225 offset:832
  ds_read_b32 v242, v225 offset:896
  ds_read_b32 v243, v225 offset:960
  s_mov_b32 s20, s54
  s_mov_b32 s21, s55
  s_mov_b32 s22, 0x3000
  s_mov_b32 s23, 0x20000
  s_waitcnt lgkmcnt(0)
  v_add_f32 v228, v228, v236
  v_add_f32 v229, v229, v237
  v_add_f32 v230, v230, v238
  v_add_f32 v231, v231, v239
  v_add_f32 v232, v232, v240
  v_add_f32 v233, v233, v241
  v_add_f32 v234, v234, v242
  v_add_f32 v235, v235, v243
  v_add_f32 v228, v228, v232
  v_add_f32 v229, v229, v233
  v_add_f32 v230, v230, v234
  v_add_f32 v231, v231, v235
  v_add_f32 v228, v228, v230
  v_add_f32 v229, v229, v231
  v_add_f32 v228, v228, v229
  v_cvt_pk_bf16_f32 v228, 0, v228
  v_add_f32 v229, 1.0, v228
  v_cvt_pk_bf16_f32 v229, 0, v229
  s_lshr_b32 s46, s35, 5
  s_cmp_eq_u32 s46, 1
  s_cbranch_scc0 K1_GU
  v_mov_b32 v228, v229
K1_GU:
  s_lshl_b32 s46, s35, 6
  v_add_u32 v224, s46, v224
  v_mul_f32 v228, 0x3d800000, v228
  buffer_store_dword v228, v224, s[28:31], 0 offen sc1
  s_mov_b64 exec, 1
  v_mov_b32 v224, 0
  v_mov_b32 v225, 1
  s_waitcnt vmcnt(0)
  global_atomic_add v226, v224, v225, s[52:53] sc0
  s_waitcnt vmcnt(0)
  v_readfirstlane_b32 s46, v226
  s_nop 0
  s_cmp_lg_u32 s46, 63
  s_cbranch_scc1 K1_NOTLAST
  global_store_dword v224, v225, s[52:53] offset:128 sc1
K1_NOTLAST:
  s_mov_b64 exec, -1
K1_DONEU:
K1_NOGU:
  s_add_u32 m0, s43, 0
  s_nop 0
  buffer_load_dwordx4 v2, s[4:7], s44 offen lds
  buffer_load_dwordx4 v3, s[4:7], s44 offen offset:1024 lds
  buffer_load_dwordx4 v4, s[4:7], s44 offen offset:2048 lds
  buffer_load_dwordx4 v5, s[4:7], s44 offen offset:3072 lds
  s_add_u32 s44, s44, s49
  s_add_u32 m0, s43, 4096
  s_nop 0
  buffer_load_dwordx4 v2, s[4:7], s44 offen lds
  buffer_load_dwordx4 v3, s[4:7], s44 offen offset:1024 lds
  buffer_load_dwordx4 v4, s[4:7], s44 offen offset:2048 lds
  buffer_load_dwordx4 v5, s[4:7], s44 offen offset:3072 lds
  s_add_u32 s44, s44, s49
  s_waitcnt vmcnt(16)
  v_lshlrev_b32 v32, 16, v160
  v_and_b32 v33, s42, v160
  v_lshlrev_b32 v34, 16, v161
  v_and_b32 v35, s42, v161
  v_lshlrev_b32 v36, 16, v162
  v_and_b32 v37, s42, v162
  v_lshlrev_b32 v38, 16, v163
  v_and_b32 v39, s42, v163
  v_pk_add_f32 v[244:245], v[32:33], 0 op_sel_hi:[1,0]
  v_pk_add_f32 v[246:247], v[34:35], 0 op_sel_hi:[1,0]
  v_pk_add_f32 v[248:249], v[36:37], 0 op_sel_hi:[1,0]
  v_pk_add_f32 v[250:251], v[38:39], 0 op_sel_hi:[1,0]
  v_lshlrev_b32 v40, 16, v164
  v_and_b32 v41, s42, v164
  v_lshlrev_b32 v42, 16, v165
  v_and_b32 v43, s42, v165
  v_lshlrev_b32 v44, 16, v166
  v_and_b32 v45, s42, v166
  v_lshlrev_b32 v46, 16, v167
  v_and_b32 v47, s42, v167
  v_pk_add_f32 v[244:245], v[244:245], v[40:41]
  v_pk_add_f32 v[246:247], v[246:247], v[42:43]
  v_pk_add_f32 v[248:249], v[248:249], v[44:45]
  v_pk_add_f32 v[250:251], v[250:251], v[46:47]
  s_add_u32 m0, s43, 8192
  s_nop 0
  buffer_load_dwordx4 v2, s[4:7], s44 offen lds
  v_lshlrev_b32 v48, 16, v168
  v_and_b32 v49, s42, v168
  v_lshlrev_b32 v50, 16, v169
  v_and_b32 v51, s42, v169
  v_lshlrev_b32 v52, 16, v170
  v_and_b32 v53, s42, v170
  v_lshlrev_b32 v54, 16, v171
  v_and_b32 v55, s42, v171
  v_pk_add_f32 v[244:245], v[244:245], v[48:49]
  v_pk_add_f32 v[246:247], v[246:247], v[50:51]
  v_pk_add_f32 v[248:249], v[248:249], v[52:53]
  v_pk_add_f32 v[250:251], v[250:251], v[54:55]
  buffer_load_dwordx4 v3, s[4:7], s44 offen offset:1024 lds
  v_lshlrev_b32 v56, 16, v172
  v_and_b32 v57, s42, v172
  v_lshlrev_b32 v58, 16, v173
  v_and_b32 v59, s42, v173
  v_lshlrev_b32 v60, 16, v174
  v_and_b32 v61, s42, v174
  v_lshlrev_b32 v62, 16, v175
  v_and_b32 v63, s42, v175
  v_pk_add_f32 v[244:245], v[244:245], v[56:57]
  v_pk_add_f32 v[246:247], v[246:247], v[58:59]
  v_pk_add_f32 v[248:249], v[248:249], v[60:61]
  v_pk_add_f32 v[250:251], v[250:251], v[62:63]
  buffer_load_dwordx4 v4, s[4:7], s44 offen offset:2048 lds
  v_lshlrev_b32 v64, 16, v176
  v_and_b32 v65, s42, v176
  v_lshlrev_b32 v66, 16, v177
  v_and_b32 v67, s42, v177
  v_lshlrev_b32 v68, 16, v178
  v_and_b32 v69, s42, v178
  v_lshlrev_b32 v70, 16, v179
  v_and_b32 v71, s42, v179
  v_pk_add_f32 v[244:245], v[244:245], v[64:65]
  v_pk_add_f32 v[246:247], v[246:247], v[66:67]
  v_pk_add_f32 v[248:249], v[248:249], v[68:69]
  v_pk_add_f32 v[250:251], v[250:251], v[70:71]
  buffer_load_dwordx4 v5, s[4:7], s44 offen offset:3072 lds
  v_lshlrev_b32 v72, 16, v180
  v_and_b32 v73, s42, v180
  v_lshlrev_b32 v74, 16, v181
  v_and_b32 v75, s42, v181
  v_lshlrev_b32 v76, 16, v182
  v_and_b32 v77, s42, v182
  v_lshlrev_b32 v78, 16, v183
  v_and_b32 v79, s42, v183
  v_pk_add_f32 v[244:245], v[244:245], v[72:73]
  v_pk_add_f32 v[246:247], v[246:247], v[74:75]
  v_pk_add_f32 v[248:249], v[248:249], v[76:77]
  v_pk_add_f32 v[250:251], v[250:251], v[78:79]
  v_lshlrev_b32 v80, 16, v184
  v_and_b32 v81, s42, v184
  v_lshlrev_b32 v82, 16, v185
  v_and_b32 v83, s42, v185
  v_lshlrev_b32 v84, 16, v186
  v_and_b32 v85, s42, v186
  v_lshlrev_b32 v86, 16, v187
  v_and_b32 v87, s42, v187
  v_pk_add_f32 v[244:245], v[244:245], v[80:81]
  v_pk_add_f32 v[246:247], v[246:247], v[82:83]
  v_pk_add_f32 v[248:249], v[248:249], v[84:85]
  v_pk_add_f32 v[250:251], v[250:251], v[86:87]
  s_add_u32 s44, s44, s49
  v_lshlrev_b32 v88, 16, v188
  v_and_b32 v89, s42, v188
  v_lshlrev_b32 v90, 16, v189
  v_and_b32 v91, s42, v189
  v_lshlrev_b32 v92, 16, v190
  v_and_b32 v93, s42, v190
  v_lshlrev_b32 v94, 16, v191
  v_and_b32 v95, s42, v191
  v_pk_add_f32 v[244:245], v[244:245], v[88:89]
  v_pk_add_f32 v[246:247], v[246:247], v[90:91]
  v_pk_add_f32 v[248:249], v[248:249], v[92:93]
  v_pk_add_f32 v[250:251], v[250:251], v[94:95]
  s_add_u32 m0, s43, 12288
  s_nop 0
  buffer_load_dwordx4 v2, s[4:7], s44 offen lds
  v_lshlrev_b32 v96, 16, v192
  v_and_b32 v97, s42, v192
  v_lshlrev_b32 v98, 16, v193
  v_and_b32 v99, s42, v193
  v_lshlrev_b32 v100, 16, v194
  v_and_b32 v101, s42, v194
  v_lshlrev_b32 v102, 16, v195
  v_and_b32 v103, s42, v195
  v_pk_add_f32 v[244:245], v[244:245], v[96:97]
  v_pk_add_f32 v[246:247], v[246:247], v[98:99]
  v_pk_add_f32 v[248:249], v[248:249], v[100:101]
  v_pk_add_f32 v[250:251], v[250:251], v[102:103]
  buffer_load_dwordx4 v3, s[4:7], s44 offen offset:1024 lds
  v_lshlrev_b32 v104, 16, v196
  v_and_b32 v105, s42, v196
  v_lshlrev_b32 v106, 16, v197
  v_and_b32 v107, s42, v197
  v_lshlrev_b32 v108, 16, v198
  v_and_b32 v109, s42, v198
  v_lshlrev_b32 v110, 16, v199
  v_and_b32 v111, s42, v199
  v_pk_add_f32 v[244:245], v[244:245], v[104:105]
  v_pk_add_f32 v[246:247], v[246:247], v[106:107]
  v_pk_add_f32 v[248:249], v[248:249], v[108:109]
  v_pk_add_f32 v[250:251], v[250:251], v[110:111]
  buffer_load_dwordx4 v4, s[4:7], s44 offen offset:2048 lds
  v_lshlrev_b32 v112, 16, v200
  v_and_b32 v113, s42, v200
  v_lshlrev_b32 v114, 16, v201
  v_and_b32 v115, s42, v201
  v_lshlrev_b32 v116, 16, v202
  v_and_b32 v117, s42, v202
  v_lshlrev_b32 v118, 16, v203
  v_and_b32 v119, s42, v203
  v_pk_add_f32 v[244:245], v[244:245], v[112:113]
  v_pk_add_f32 v[246:247], v[246:247], v[114:115]
  v_pk_add_f32 v[248:249], v[248:249], v[116:117]
  v_pk_add_f32 v[250:251], v[250:251], v[118:119]
  v_lshlrev_b32 v120, 16, v204
  v_and_b32 v121, s42, v204
  v_lshlrev_b32 v122, 16, v205
  v_and_b32 v123, s42, v205
  v_lshlrev_b32 v124, 16, v206
  v_and_b32 v125, s42, v206
  v_lshlrev_b32 v126, 16, v207
  v_and_b32 v127, s42, v207
  v_pk_add_f32 v[244:245], v[244:245], v[120:121]
  v_pk_add_f32 v[246:247], v[246:247], v[122:123]
  v_pk_add_f32 v[248:249], v[248:249], v[124:125]
  v_pk_add_f32 v[250:251], v[250:251], v[126:127]
  buffer_load_dwordx4 v5, s[4:7], s44 offen offset:3072 lds
  v_lshlrev_b32 v128, 16, v208
  v_and_b32 v129, s42, v208
  v_lshlrev_b32 v130, 16, v209
  v_and_b32 v131, s42, v209
  v_lshlrev_b32 v132, 16, v210
  v_and_b32 v133, s42, v210
  v_lshlrev_b32 v134, 16, v211
  v_and_b32 v135, s42, v211
  v_pk_add_f32 v[244:245], v[244:245], v[128:129]
  v_pk_add_f32 v[246:247], v[246:247], v[130:131]
  v_pk_add_f32 v[248:249], v[248:249], v[132:133]
  v_pk_add_f32 v[250:251], v[250:251], v[134:135]
  s_add_u32 s44, s44, s49
  v_lshlrev_b32 v136, 16, v212
  v_and_b32 v137, s42, v212
  v_lshlrev_b32 v138, 16, v213
  v_and_b32 v139, s42, v213
  v_lshlrev_b32 v140, 16, v214
  v_and_b32 v141, s42, v214
  v_lshlrev_b32 v142, 16, v215
  v_and_b32 v143, s42, v215
  v_pk_add_f32 v[244:245], v[244:245], v[136:137]
  v_pk_add_f32 v[246:247], v[246:247], v[138:139]
  v_pk_add_f32 v[248:249], v[248:249], v[140:141]
  v_pk_add_f32 v[250:251], v[250:251], v[142:143]
  s_lshr_b32 s46, s2, 3
  s_lshl_b32 s46, s46, 2
  s_add_u32 s46, s46, s32
  s_lshl_b32 s46, s46, 10
  v_lshlrev_b32 v144, 16, v216
  v_and_b32 v145, s42, v216
  v_lshlrev_b32 v146, 16, v217
  v_and_b32 v147, s42, v217
  v_lshlrev_b32 v148, 16, v218
  v_and_b32 v149, s42, v218
  v_lshlrev_b32 v150, 16, v219
  v_and_b32 v151, s42, v219
  v_pk_add_f32 v[244:245], v[244:245], v[144:145]
  v_pk_add_f32 v[246:247], v[246:247], v[146:147]
  v_pk_add_f32 v[248:249], v[248:249], v[148:149]
  v_pk_add_f32 v[250:251], v[250:251], v[150:151]
  s_getpc_b64 s[16:17]
K1_PC0:
  s_add_u32 s16, s16, K1_QSTART-K1_PC0
  s_addc_u32 s17, s17, 0
  s_mov_b32 s18, CODE_END-K1_QSTART
  s_mov_b32 s19, 0x20000
  v_lshlrev_b32 v152, 16, v220
  v_and_b32 v153, s42, v220
  v_lshlrev_b32 v154, 16, v221
  v_and_b32 v155, s42, v221
  v_lshlrev_b32 v156, 16, v222
  v_and_b32 v157, s42, v222
  v_lshlrev_b32 v158, 16, v223
  v_and_b32 v159, s42, v223
  v_pk_add_f32 v[244:245], v[244:245], v[152:153]
  v_pk_add_f32 v[246:247], v[246:247], v[154:155]
  v_pk_add_f32 v[248:249], v[248:249], v[156:157]
  v_pk_add_f32 v[250:251], v[250:251], v[158:159]
  buffer_load_dwordx4 a[236:239], v24, s[16:19], s46 offen
  v_pk_add_f32 v[244:245], v[244:245], v[246:247]
  v_pk_add_f32 v[248:249], v[248:249], v[250:251]
  v_pk_add_f32 v[244:245], v[244:245], v[248:249]
  v_add_f32 v244, v244, v245
  s_nop 1
  v_add_f32_dpp v244, v244, v244 quad_perm:[1,0,3,2] row_mask:0xf bank_mask:0xf
  s_nop 1
  v_add_f32_dpp v244, v244, v244 quad_perm:[2,3,0,1] row_mask:0xf bank_mask:0xf
  v_mul_f32 v252, 0xbb000000, v244
  v_pk_add_f32 v[32:33], v[32:33], v[252:253] op_sel_hi:[1,0]
  v_pk_add_f32 v[34:35], v[34:35], v[252:253] op_sel_hi:[1,0]
  v_pk_add_f32 v[36:37], v[36:37], v[252:253] op_sel_hi:[1,0]
  v_pk_add_f32 v[38:39], v[38:39], v[252:253] op_sel_hi:[1,0]
  v_pk_add_f32 v[40:41], v[40:41], v[252:253] op_sel_hi:[1,0]
  v_pk_add_f32 v[42:43], v[42:43], v[252:253] op_sel_hi:[1,0]
  v_pk_add_f32 v[44:45], v[44:45], v[252:253] op_sel_hi:[1,0]
  v_pk_add_f32 v[46:47], v[46:47], v[252:253] op_sel_hi:[1,0]
  v_pk_add_f32 v[48:49], v[48:49], v[252:253] op_sel_hi:[1,0]
  v_pk_add_f32 v[50:51], v[50:51], v[252:253] op_sel_hi:[1,0]
  v_pk_add_f32 v[52:53], v[52:53], v[252:253] op_sel_hi:[1,0]
  v_pk_add_f32 v[54:55], v[54:55], v[252:253] op_sel_hi:[1,0]
  v_pk_add_f32 v[56:57], v[56:57], v[252:253] op_sel_hi:[1,0]
  v_pk_add_f32 v[58:59], v[58:59], v[252:253] op_sel_hi:[1,0]
  v_pk_add_f32 v[60:61], v[60:61], v[252:253] op_sel_hi:[1,0]
  v_pk_add_f32 v[62:63], v[62:63], v[252:253] op_sel_hi:[1,0]
  v_pk_add_f32 v[64:65], v[64:65], v[252:253] op_sel_hi:[1,0]
  v_pk_add_f32 v[66:67], v[66:67], v[252:253] op_sel_hi:[1,0]
  v_pk_add_f32 v[68:69], v[68:69], v[252:253] op_sel_hi:[1,0]
  v_pk_add_f32 v[70:71], v[70:71], v[252:253] op_sel_hi:[1,0]
  v_pk_add_f32 v[72:73], v[72:73], v[252:253] op_sel_hi:[1,0]
  v_pk_add_f32 v[74:75], v[74:75], v[252:253] op_sel_hi:[1,0]
  v_pk_add_f32 v[76:77], v[76:77], v[252:253] op_sel_hi:[1,0]
  v_pk_add_f32 v[78:79], v[78:79], v[252:253] op_sel_hi:[1,0]
  v_pk_add_f32 v[80:81], v[80:81], v[252:253] op_sel_hi:[1,0]
  v_pk_add_f32 v[82:83], v[82:83], v[252:253] op_sel_hi:[1,0]
  v_pk_add_f32 v[84:85], v[84:85], v[252:253] op_sel_hi:[1,0]
  v_pk_add_f32 v[86:87], v[86:87], v[252:253] op_sel_hi:[1,0]
  v_pk_add_f32 v[88:89], v[88:89], v[252:253] op_sel_hi:[1,0]
  v_pk_add_f32 v[90:91], v[90:91], v[252:253] op_sel_hi:[1,0]
  v_pk_add_f32 v[92:93], v[92:93], v[252:253] op_sel_hi:[1,0]
  v_pk_add_f32 v[94:95], v[94:95], v[252:253] op_sel_hi:[1,0]
  v_pk_add_f32 v[96:97], v[96:97], v[252:253] op_sel_hi:[1,0]
  v_pk_add_f32 v[98:99], v[98:99], v[252:253] op_sel_hi:[1,0]
  v_pk_add_f32 v[100:101], v[100:101], v[252:253] op_sel_hi:[1,0]
  v_pk_add_f32 v[102:103], v[102:103], v[252:253] op_sel_hi:[1,0]
  v_pk_add_f32 v[104:105], v[104:105], v[252:253] op_sel_hi:[1,0]
  v_pk_add_f32 v[106:107], v[106:107], v[252:253] op_sel_hi:[1,0]
  v_pk_add_f32 v[108:109], v[108:109], v[252:253] op_sel_hi:[1,0]
  v_pk_add_f32 v[110:111], v[110:111], v[252:253] op_sel_hi:[1,0]
  v_pk_add_f32 v[112:113], v[112:113], v[252:253] op_sel_hi:[1,0]
  v_pk_add_f32 v[114:115], v[114:115], v[252:253] op_sel_hi:[1,0]
  v_pk_add_f32 v[116:117], v[116:117], v[252:253] op_sel_hi:[1,0]
  v_pk_add_f32 v[118:119], v[118:119], v[252:253] op_sel_hi:[1,0]
  v_pk_add_f32 v[120:121], v[120:121], v[252:253] op_sel_hi:[1,0]
  v_pk_add_f32 v[122:123], v[122:123], v[252:253] op_sel_hi:[1,0]
  v_pk_add_f32 v[124:125], v[124:125], v[252:253] op_sel_hi:[1,0]
  v_pk_add_f32 v[126:127], v[126:127], v[252:253] op_sel_hi:[1,0]
  v_pk_add_f32 v[128:129], v[128:129], v[252:253] op_sel_hi:[1,0]
  v_pk_add_f32 v[130:131], v[130:131], v[252:253] op_sel_hi:[1,0]
  v_pk_add_f32 v[132:133], v[132:133], v[252:253] op_sel_hi:[1,0]
  v_pk_add_f32 v[134:135], v[134:135], v[252:253] op_sel_hi:[1,0]
  v_pk_add_f32 v[136:137], v[136:137], v[252:253] op_sel_hi:[1,0]
  v_pk_add_f32 v[138:139], v[138:139], v[252:253] op_sel_hi:[1,0]
  v_pk_add_f32 v[140:141], v[140:141], v[252:253] op_sel_hi:[1,0]
  v_pk_add_f32 v[142:143], v[142:143], v[252:253] op_sel_hi:[1,0]
  v_pk_add_f32 v[144:145], v[144:145], v[252:253] op_sel_hi:[1,0]
  v_pk_add_f32 v[146:147], v[146:147], v[252:253] op_sel_hi:[1,0]
  v_pk_add_f32 v[148:149], v[148:149], v[252:253] op_sel_hi:[1,0]
  v_pk_add_f32 v[150:151], v[150:151], v[252:253] op_sel_hi:[1,0]
  v_pk_add_f32 v[152:153], v[152:153], v[252:253] op_sel_hi:[1,0]
  v_pk_add_f32 v[154:155], v[154:155], v[252:253] op_sel_hi:[1,0]
  v_pk_add_f32 v[156:157], v[156:157], v[252:253] op_sel_hi:[1,0]
  v_pk_add_f32 v[158:159], v[158:159], v[252:253] op_sel_hi:[1,0]
  v_pk_mul_f32 v[244:245], v[32:33], v[32:33]
  v_pk_mul_f32 v[246:247], v[34:35], v[34:35]
  v_pk_mul_f32 v[248:249], v[36:37], v[36:37]
  v_pk_mul_f32 v[250:251], v[38:39], v[38:39]
  v_pk_fma_f32 v[244:245], v[40:41], v[40:41], v[244:245]
  v_pk_fma_f32 v[246:247], v[42:43], v[42:43], v[246:247]
  v_pk_fma_f32 v[248:249], v[44:45], v[44:45], v[248:249]
  v_pk_fma_f32 v[250:251], v[46:47], v[46:47], v[250:251]
  v_pk_fma_f32 v[244:245], v[48:49], v[48:49], v[244:245]
  v_pk_fma_f32 v[246:247], v[50:51], v[50:51], v[246:247]
  v_pk_fma_f32 v[248:249], v[52:53], v[52:53], v[248:249]
  v_pk_fma_f32 v[250:251], v[54:55], v[54:55], v[250:251]
  v_pk_fma_f32 v[244:245], v[56:57], v[56:57], v[244:245]
  v_pk_fma_f32 v[246:247], v[58:59], v[58:59], v[246:247]
  v_pk_fma_f32 v[248:249], v[60:61], v[60:61], v[248:249]
  v_pk_fma_f32 v[250:251], v[62:63], v[62:63], v[250:251]
  v_pk_fma_f32 v[244:245], v[64:65], v[64:65], v[244:245]
  v_pk_fma_f32 v[246:247], v[66:67], v[66:67], v[246:247]
  v_pk_fma_f32 v[248:249], v[68:69], v[68:69], v[248:249]
  v_pk_fma_f32 v[250:251], v[70:71], v[70:71], v[250:251]
  v_pk_fma_f32 v[244:245], v[72:73], v[72:73], v[244:245]
  v_pk_fma_f32 v[246:247], v[74:75], v[74:75], v[246:247]
  v_pk_fma_f32 v[248:249], v[76:77], v[76:77], v[248:249]
  v_pk_fma_f32 v[250:251], v[78:79], v[78:79], v[250:251]
  v_pk_fma_f32 v[244:245], v[80:81], v[80:81], v[244:245]
  v_pk_fma_f32 v[246:247], v[82:83], v[82:83], v[246:247]
  v_pk_fma_f32 v[248:249], v[84:85], v[84:85], v[248:249]
  v_pk_fma_f32 v[250:251], v[86:87], v[86:87], v[250:251]
  v_pk_fma_f32 v[244:245], v[88:89], v[88:89], v[244:245]
  v_pk_fma_f32 v[246:247], v[90:91], v[90:91], v[246:247]
  v_pk_fma_f32 v[248:249], v[92:93], v[92:93], v[248:249]
  v_pk_fma_f32 v[250:251], v[94:95], v[94:95], v[250:251]
  v_pk_fma_f32 v[244:245], v[96:97], v[96:97], v[244:245]
  v_pk_fma_f32 v[246:247], v[98:99], v[98:99], v[246:247]
  v_pk_fma_f32 v[248:249], v[100:101], v[100:101], v[248:249]
  v_pk_fma_f32 v[250:251], v[102:103], v[102:103], v[250:251]
  v_pk_fma_f32 v[244:245], v[104:105], v[104:105], v[244:245]
  v_pk_fma_f32 v[246:247], v[106:107], v[106:107], v[246:247]
  v_pk_fma_f32 v[248:249], v[108:109], v[108:109], v[248:249]
  v_pk_fma_f32 v[250:251], v[110:111], v[110:111], v[250:251]
  v_pk_fma_f32 v[244:245], v[112:113], v[112:113], v[244:245]
  v_pk_fma_f32 v[246:247], v[114:115], v[114:115], v[246:247]
  v_pk_fma_f32 v[248:249], v[116:117], v[116:117], v[248:249]
  v_pk_fma_f32 v[250:251], v[118:119], v[118:119], v[250:251]
  v_pk_fma_f32 v[244:245], v[120:121], v[120:121], v[244:245]
  v_pk_fma_f32 v[246:247], v[122:123], v[122:123], v[246:247]
  v_pk_fma_f32 v[248:249], v[124:125], v[124:125], v[248:249]
  v_pk_fma_f32 v[250:251], v[126:127], v[126:127], v[250:251]
  v_pk_fma_f32 v[244:245], v[128:129], v[128:129], v[244:245]
  v_pk_fma_f32 v[246:247], v[130:131], v[130:131], v[246:247]
  v_pk_fma_f32 v[248:249], v[132:133], v[132:133], v[248:249]
  v_pk_fma_f32 v[250:251], v[134:135], v[134:135], v[250:251]
  v_pk_fma_f32 v[244:245], v[136:137], v[136:137], v[244:245]
  v_pk_fma_f32 v[246:247], v[138:139], v[138:139], v[246:247]
  v_pk_fma_f32 v[248:249], v[140:141], v[140:141], v[248:249]
  v_pk_fma_f32 v[250:251], v[142:143], v[142:143], v[250:251]
  v_pk_fma_f32 v[244:245], v[144:145], v[144:145], v[244:245]
  v_pk_fma_f32 v[246:247], v[146:147], v[146:147], v[246:247]
  v_pk_fma_f32 v[248:249], v[148:149], v[148:149], v[248:249]
  v_pk_fma_f32 v[250:251], v[150:151], v[150:151], v[250:251]
  v_pk_fma_f32 v[244:245], v[152:153], v[152:153], v[244:245]
  v_pk_fma_f32 v[246:247], v[154:155], v[154:155], v[246:247]
  v_pk_fma_f32 v[248:249], v[156:157], v[156:157], v[248:249]
  v_pk_fma_f32 v[250:251], v[158:159], v[158:159], v[250:251]
  v_pk_add_f32 v[244:245], v[244:245], v[246:247]
  v_pk_add_f32 v[248:249], v[248:249], v[250:251]
  v_pk_add_f32 v[244:245], v[244:245], v[248:249]
  v_add_f32 v244, v244, v245
  s_nop 1
  v_add_f32_dpp v244, v244, v244 quad_perm:[1,0,3,2] row_mask:0xf bank_mask:0xf
  s_nop 1
  v_add_f32_dpp v244, v244, v244 quad_perm:[2,3,0,1] row_mask:0xf bank_mask:0xf
  v_mul_f32 v252, 0x3b000000, v244
  v_add_f32 v252, 0x3727c5ac, v252
  v_rsq_f32 v252, v252
  s_nop 0
  v_pk_mul_f32 v[32:33], v[32:33], v[252:253] op_sel_hi:[1,0]
  v_pk_mul_f32 v[34:35], v[34:35], v[252:253] op_sel_hi:[1,0]
  v_pk_mul_f32 v[36:37], v[36:37], v[252:253] op_sel_hi:[1,0]
  v_pk_mul_f32 v[38:39], v[38:39], v[252:253] op_sel_hi:[1,0]
  v_pk_mul_f32 v[40:41], v[40:41], v[252:253] op_sel_hi:[1,0]
  v_pk_mul_f32 v[42:43], v[42:43], v[252:253] op_sel_hi:[1,0]
  v_pk_mul_f32 v[44:45], v[44:45], v[252:253] op_sel_hi:[1,0]
  v_pk_mul_f32 v[46:47], v[46:47], v[252:253] op_sel_hi:[1,0]
  v_pk_mul_f32 v[48:49], v[48:49], v[252:253] op_sel_hi:[1,0]
  v_pk_mul_f32 v[50:51], v[50:51], v[252:253] op_sel_hi:[1,0]
  v_pk_mul_f32 v[52:53], v[52:53], v[252:253] op_sel_hi:[1,0]
  v_pk_mul_f32 v[54:55], v[54:55], v[252:253] op_sel_hi:[1,0]
  v_pk_mul_f32 v[56:57], v[56:57], v[252:253] op_sel_hi:[1,0]
  v_pk_mul_f32 v[58:59], v[58:59], v[252:253] op_sel_hi:[1,0]
  v_pk_mul_f32 v[60:61], v[60:61], v[252:253] op_sel_hi:[1,0]
  v_pk_mul_f32 v[62:63], v[62:63], v[252:253] op_sel_hi:[1,0]
  v_pk_mul_f32 v[64:65], v[64:65], v[252:253] op_sel_hi:[1,0]
  v_pk_mul_f32 v[66:67], v[66:67], v[252:253] op_sel_hi:[1,0]
  v_pk_mul_f32 v[68:69], v[68:69], v[252:253] op_sel_hi:[1,0]
  v_pk_mul_f32 v[70:71], v[70:71], v[252:253] op_sel_hi:[1,0]
  v_pk_mul_f32 v[72:73], v[72:73], v[252:253] op_sel_hi:[1,0]
  v_pk_mul_f32 v[74:75], v[74:75], v[252:253] op_sel_hi:[1,0]
  v_pk_mul_f32 v[76:77], v[76:77], v[252:253] op_sel_hi:[1,0]
  v_pk_mul_f32 v[78:79], v[78:79], v[252:253] op_sel_hi:[1,0]
  v_pk_mul_f32 v[80:81], v[80:81], v[252:253] op_sel_hi:[1,0]
  v_pk_mul_f32 v[82:83], v[82:83], v[252:253] op_sel_hi:[1,0]
  v_pk_mul_f32 v[84:85], v[84:85], v[252:253] op_sel_hi:[1,0]
  v_pk_mul_f32 v[86:87], v[86:87], v[252:253] op_sel_hi:[1,0]
  v_pk_mul_f32 v[88:89], v[88:89], v[252:253] op_sel_hi:[1,0]
  v_pk_mul_f32 v[90:91], v[90:91], v[252:253] op_sel_hi:[1,0]
  v_pk_mul_f32 v[92:93], v[92:93], v[252:253] op_sel_hi:[1,0]
  v_pk_mul_f32 v[94:95], v[94:95], v[252:253] op_sel_hi:[1,0]
  v_pk_mul_f32 v[96:97], v[96:97], v[252:253] op_sel_hi:[1,0]
  v_pk_mul_f32 v[98:99], v[98:99], v[252:253] op_sel_hi:[1,0]
  v_pk_mul_f32 v[100:101], v[100:101], v[252:253] op_sel_hi:[1,0]
  v_pk_mul_f32 v[102:103], v[102:103], v[252:253] op_sel_hi:[1,0]
  v_pk_mul_f32 v[104:105], v[104:105], v[252:253] op_sel_hi:[1,0]
  v_pk_mul_f32 v[106:107], v[106:107], v[252:253] op_sel_hi:[1,0]
  v_pk_mul_f32 v[108:109], v[108:109], v[252:253] op_sel_hi:[1,0]
  v_pk_mul_f32 v[110:111], v[110:111], v[252:253] op_sel_hi:[1,0]
  v_pk_mul_f32 v[112:113], v[112:113], v[252:253] op_sel_hi:[1,0]
  v_pk_mul_f32 v[114:115], v[114:115], v[252:253] op_sel_hi:[1,0]
  v_pk_mul_f32 v[116:117], v[116:117], v[252:253] op_sel_hi:[1,0]
  v_pk_mul_f32 v[118:119], v[118:119], v[252:253] op_sel_hi:[1,0]
  v_pk_mul_f32 v[120:121], v[120:121], v[252:253] op_sel_hi:[1,0]
  v_pk_mul_f32 v[122:123], v[122:123], v[252:253] op_sel_hi:[1,0]
  v_pk_mul_f32 v[124:125], v[124:125], v[252:253] op_sel_hi:[1,0]
  v_pk_mul_f32 v[126:127], v[126:127], v[252:253] op_sel_hi:[1,0]
  v_pk_mul_f32 v[128:129], v[128:129], v[252:253] op_sel_hi:[1,0]
  v_pk_mul_f32 v[130:131], v[130:131], v[252:253] op_sel_hi:[1,0]
  v_pk_mul_f32 v[132:133], v[132:133], v[252:253] op_sel_hi:[1,0]
  v_pk_mul_f32 v[134:135], v[134:135], v[252:253] op_sel_hi:[1,0]
  v_pk_mul_f32 v[136:137], v[136:137], v[252:253] op_sel_hi:[1,0]
  v_pk_mul_f32 v[138:139], v[138:139], v[252:253] op_sel_hi:[1,0]
  v_pk_mul_f32 v[140:141], v[140:141], v[252:253] op_sel_hi:[1,0]
  v_pk_mul_f32 v[142:143], v[142:143], v[252:253] op_sel_hi:[1,0]
  v_pk_mul_f32 v[144:145], v[144:145], v[252:253] op_sel_hi:[1,0]
  v_pk_mul_f32 v[146:147], v[146:147], v[252:253] op_sel_hi:[1,0]
  v_pk_mul_f32 v[148:149], v[148:149], v[252:253] op_sel_hi:[1,0]
  v_pk_mul_f32 v[150:151], v[150:151], v[252:253] op_sel_hi:[1,0]
  v_pk_mul_f32 v[152:153], v[152:153], v[252:253] op_sel_hi:[1,0]
  v_pk_mul_f32 v[154:155], v[154:155], v[252:253] op_sel_hi:[1,0]
  v_pk_mul_f32 v[156:157], v[156:157], v[252:253] op_sel_hi:[1,0]
  v_pk_mul_f32 v[158:159], v[158:159], v[252:253] op_sel_hi:[1,0]
  s_lshl_b32 s46, s33, 5
  s_add_u32 s46, s46, s34
  s_lshl_b32 s46, s46, 12
  s_lshl_b32 s47, s32, 10
  s_add_u32 s46, s46, s47
  s_add_u32 s96, s54, 0x300000
  s_addc_u32 s97, s55, 0
  s_add_u32 s96, s96, s46
  s_addc_u32 s97, s97, 0
  s_mov_b32 s98, 0x400
  s_mov_b32 s99, 0x20000
  s_waitcnt vmcnt(17)
  v_accvgpr_read_b32 v208, a0
  v_accvgpr_read_b32 v209, a1
  v_accvgpr_read_b32 v210, a2
  v_accvgpr_read_b32 v211, a3
  v_accvgpr_read_b32 v212, a4
  v_accvgpr_read_b32 v213, a5
  v_accvgpr_read_b32 v214, a6
  v_accvgpr_read_b32 v215, a7
  v_lshl_or_b32 v216, v209, 16, v208
  v_lshl_or_b32 v217, v211, 16, v210
  v_lshl_or_b32 v218, v213, 16, v212
  v_lshl_or_b32 v219, v215, 16, v214
  buffer_store_dwordx4 v[216:219], v24, s[96:99], 0 offen sc1
  s_cmp_ge_u32 s3, 128
  s_cbranch_scc1 K1_NOGN
  s_mov_b32 s46, 0xbfb8aa3b
  s_mov_b32 s47, 0xb2a57060
  s_mov_b32 s45, 0x3f317218
  s_waitcnt vmcnt(13)
  v_lshlrev_b32 v224, 16, v224
  v_lshlrev_b32 v225, 16, v225
  v_lshlrev_b32 v226, 16, v226
  v_lshlrev_b32 v227, 16, v227
  v_mul_f32 v160, s46, v224
  v_mul_f32 v161, s46, v225
  v_mul_f32 v162, s46, v226
  v_mul_f32 v163, s46, v227
  v_fma_f32 v164, v224, s46, -v160
  v_fma_f32 v165, v225, s46, -v161
  v_fma_f32 v166, v226, s46, -v162
  v_fma_f32 v167, v227, s46, -v163
  v_fma_f32 v164, v224, s47, v164
  v_fma_f32 v165, v225, s47, v165
  v_fma_f32 v166, v226, s47, v166
  v_fma_f32 v167, v227, s47, v167
  v_min_f32 v160, 0x42fc0000, v160
  v_min_f32 v161, 0x42fc0000, v161
  v_min_f32 v162, 0x42fc0000, v162
  v_min_f32 v163, 0x42fc0000, v163
  v_exp_f32 v160, v160
  v_exp_f32 v161, v161
  v_exp_f32 v162, v162
  v_exp_f32 v163, v163
  v_mul_f32 v164, s45, v164
  v_mul_f32 v165, s45, v165
  v_mul_f32 v166, s45, v166
  v_mul_f32 v167, s45, v167
  v_fma_f32 v160, v160, v164, v160
  v_fma_f32 v161, v161, v165, v161
  v_fma_f32 v162, v162, v166, v162
  v_fma_f32 v163, v163, v167, v163
  v_add_f32 v164, 1.0, v160
  v_add_f32 v165, 1.0, v161
  v_add_f32 v166, 1.0, v162
  v_add_f32 v167, 1.0, v163
  v_rcp_f32 v164, v164
  v_rcp_f32 v165, v165
  v_rcp_f32 v166, v166
  v_rcp_f32 v167, v167
  v_mul_f32 v168, v224, v164
  v_mul_f32 v169, v225, v165
  v_mul_f32 v170, v226, v166
  v_mul_f32 v171, v227, v167
  v_sub_f32 v224, v224, v168
  v_sub_f32 v225, v225, v169
  v_sub_f32 v226, v226, v170
  v_sub_f32 v227, v227, v171
  v_fma_f32 v224, -v168, v160, v224
  v_fma_f32 v225, -v169, v161, v225
  v_fma_f32 v226, -v170, v162, v226
  v_fma_f32 v227, -v171, v163, v227
  v_fma_f32 v224, v224, v164, v168
  v_fma_f32 v225, v225, v165, v169
  v_fma_f32 v226, v226, v166, v170
  v_fma_f32 v227, v227, v167, v171
  v_cvt_pk_bf16_f32 v224, 0, v224
  v_cvt_pk_bf16_f32 v225, 0, v225
  v_cvt_pk_bf16_f32 v226, 0, v226
  v_cvt_pk_bf16_f32 v227, 0, v227
  s_waitcnt vmcnt(12)
  v_lshlrev_b32 v184, 16, v228
  v_and_b32 v185, s42, v228
  v_lshlrev_b32 v186, 16, v229
  v_and_b32 v187, s42, v229
  v_lshlrev_b32 v188, 16, v230
  v_and_b32 v189, s42, v230
  v_lshlrev_b32 v190, 16, v231
  v_and_b32 v191, s42, v231
  v_mul_f32 v176, v224, v184
  v_mul_f32 v177, v224, v185
  v_mul_f32 v178, v224, v186
  v_mul_f32 v179, v224, v187
  v_mul_f32 v180, v224, v188
  v_mul_f32 v181, v224, v189
  v_mul_f32 v182, v224, v190
  v_mul_f32 v183, v224, v191
  s_waitcnt vmcnt(11)
  v_lshlrev_b32 v184, 16, v232
  v_and_b32 v185, s42, v232
  v_lshlrev_b32 v186, 16, v233
  v_and_b32 v187, s42, v233
  v_lshlrev_b32 v188, 16, v234
  v_and_b32 v189, s42, v234
  v_lshlrev_b32 v190, 16, v235
  v_and_b32 v191, s42, v235
  v_fmac_f32 v176, v225, v184
  v_fmac_f32 v177, v225, v185
  v_fmac_f32 v178, v225, v186
  v_fmac_f32 v179, v225, v187
  v_fmac_f32 v180, v225, v188
  v_fmac_f32 v181, v225, v189
  v_fmac_f32 v182, v225, v190
  v_fmac_f32 v183, v225, v191
  s_waitcnt vmcnt(10)
  v_lshlrev_b32 v184, 16, v236
  v_and_b32 v185, s42, v236
  v_lshlrev_b32 v186, 16, v237
  v_and_b32 v187, s42, v237
  v_lshlrev_b32 v188, 16, v238
  v_and_b32 v189, s42, v238
  v_lshlrev_b32 v190, 16, v239
  v_and_b32 v191, s42, v239
  v_fmac_f32 v176, v226, v184
  v_fmac_f32 v177, v226, v185
  v_fmac_f32 v178, v226, v186
  v_fmac_f32 v179, v226, v187
  v_fmac_f32 v180, v226, v188
  v_fmac_f32 v181, v226, v189
  v_fmac_f32 v182, v226, v190
  v_fmac_f32 v183, v226, v191
  s_waitcnt vmcnt(9)
  v_lshlrev_b32 v184, 16, v240
  v_and_b32 v185, s42, v240
  v_lshlrev_b32 v186, 16, v241
  v_and_b32 v187, s42, v241
  v_lshlrev_b32 v188, 16, v242
  v_and_b32 v189, s42, v242
  v_lshlrev_b32 v190, 16, v243
  v_and_b32 v191, s42, v243
  v_fmac_f32 v176, v227, v184
  v_fmac_f32 v177, v227, v185
  v_fmac_f32 v178, v227, v186
  v_fmac_f32 v179, v227, v187
  v_fmac_f32 v180, v227, v188
  v_fmac_f32 v181, v227, v189
  v_fmac_f32 v182, v227, v190
  v_fmac_f32 v183, v227, v191
  v_add_f32_dpp v176, v176, v176 row_ror:2 row_mask:0xf bank_mask:0xf
  v_add_f32_dpp v177, v177, v177 row_ror:2 row_mask:0xf bank_mask:0xf
  v_add_f32_dpp v178, v178, v178 row_ror:2 row_mask:0xf bank_mask:0xf
  v_add_f32_dpp v179, v179, v179 row_ror:2 row_mask:0xf bank_mask:0xf
  v_add_f32_dpp v180, v180, v180 row_ror:2 row_mask:0xf bank_mask:0xf
  v_add_f32_dpp v181, v181, v181 row_ror:2 row_mask:0xf bank_mask:0xf
  v_add_f32_dpp v182, v182, v182 row_ror:2 row_mask:0xf bank_mask:0xf
  v_add_f32_dpp v183, v183, v183 row_ror:2 row_mask:0xf bank_mask:0xf
  v_add_f32_dpp v176, v176, v176 row_ror:4 row_mask:0xf bank_mask:0xf
  v_add_f32_dpp v177, v177, v177 row_ror:4 row_mask:0xf bank_mask:0xf
  v_add_f32_dpp v178, v178, v178 row_ror:4 row_mask:0xf bank_mask:0xf
  v_add_f32_dpp v179, v179, v179 row_ror:4 row_mask:0xf bank_mask:0xf
  v_add_f32_dpp v180, v180, v180 row_ror:4 row_mask:0xf bank_mask:0xf
  v_add_f32_dpp v181, v181, v181 row_ror:4 row_mask:0xf bank_mask:0xf
  v_add_f32_dpp v182, v182, v182 row_ror:4 row_mask:0xf bank_mask:0xf
  v_add_f32_dpp v183, v183, v183 row_ror:4 row_mask:0xf bank_mask:0xf
  v_add_f32_dpp v176, v176, v176 row_ror:8 row_mask:0xf bank_mask:0xf
  v_add_f32_dpp v177, v177, v177 row_ror:8 row_mask:0xf bank_mask:0xf
  v_add_f32_dpp v178, v178, v178 row_ror:8 row_mask:0xf bank_mask:0xf
  v_add_f32_dpp v179, v179, v179 row_ror:8 row_mask:0xf bank_mask:0xf
  v_add_f32_dpp v180, v180, v180 row_ror:8 row_mask:0xf bank_mask:0xf
  v_add_f32_dpp v181, v181, v181 row_ror:8 row_mask:0xf bank_mask:0xf
  v_add_f32_dpp v182, v182, v182 row_ror:8 row_mask:0xf bank_mask:0xf
  v_add_f32_dpp v183, v183, v183 row_ror:8 row_mask:0xf bank_mask:0xf
  v_lshrrev_b32 v224, 4, v0
  v_lshlrev_b32 v224, 6, v224
  v_and_b32 v225, 1, v0
  v_lshl_add_u32 v224, v225, 5, v224
  v_add_u32 v224, 151552, v224
  v_and_b32 v225, 15, v0
  v_cmp_gt_u32 vcc, 2, v225
  s_and_saveexec_b64 s[100:101], vcc
  ds_write_b128 v224, v[176:179]
  ds_write_b128 v224, v[180:183] offset:16
  s_mov_b64 exec, s[100:101]
  s_waitcnt lgkmcnt(0)
  s_cmp_eq_u32 s32, 1
  s_cbranch_scc1 K1_FINN
  s_barrier
  s_branch K1_DONEN
K1_FINN:
  s_barrier
  s_mov_b64 exec, 0xffff
  v_lshlrev_b32 v224, 2, v1
  v_add_u32 v225, 151552, v224
  ds_read_b32 v228, v225 offset:0
  ds_read_b32 v229, v225 offset:64
  ds_read_b32 v230, v225 offset:128
  ds_read_b32 v231, v225 offset:192
  ds_read_b32 v232, v225 offset:256
  ds_read_b32 v233, v225 offset:320
  ds_read_b32 v234, v225 offset:384
  ds_read_b32 v235, v225 offset:448
  ds_read_b32 v236, v225 offset:512
  ds_read_b32 v237, v225 offset:576
  ds_read_b32 v238, v225 offset:640
  ds_read_b32 v239, v225 offset:704
  ds_read_b32 v240, v225 offset:768
  ds_read_b32 v241, v225 offset:832
  ds_read_b32 v242, v225 offset:896
  ds_read_b32 v243, v225 offset:960
  s_mov_b32 s20, s54
  s_mov_b32 s21, s55
  s_mov_b32 s22, 0x3000
  s_mov_b32 s23, 0x20000
  s_waitcnt lgkmcnt(0)
  v_add_f32 v228, v228, v236
  v_add_f32 v229, v229, v237
  v_add_f32 v230, v230, v238
  v_add_f32 v231, v231, v239
  v_add_f32 v232, v232, v240
  v_add_f32 v233, v233, v241
  v_add_f32 v234, v234, v242
  v_add_f32 v235, v235, v243
  v_add_f32 v228, v228, v232
  v_add_f32 v229, v229, v233
  v_add_f32 v230, v230, v234
  v_add_f32 v231, v231, v235
  v_add_f32 v228, v228, v230
  v_add_f32 v229, v229, v231
  v_add_f32 v228, v228, v229
  v_cvt_pk_bf16_f32 v228, 0, v228
  v_add_f32 v229, 1.0, v228
  v_cvt_pk_bf16_f32 v229, 0, v229
  s_lshr_b32 s46, s35, 5
  s_cmp_eq_u32 s46, 4
  s_cbranch_scc0 K1_GN
  v_mov_b32 v228, v229
K1_GN:
  s_lshl_b32 s46, s35, 6
  v_add_u32 v224, s46, v224
  buffer_store_dword v228, v224, s[20:23], 0 offen sc1
  s_mov_b64 exec, -1
K1_DONEN:
K1_NOGN:
  s_lshl_b32 s46, s33, 5
  s_add_u32 s46, s46, s34
  s_lshl_b32 s46, s46, 16
  s_lshl_b32 s47, s32, 14
  s_add_u32 s46, s46, s47
  s_add_u32 s24, s54, 0x2000000
  s_addc_u32 s25, s55, 0
  s_add_u32 s24, s24, s46
  s_addc_u32 s25, s25, 0
  s_mov_b32 s26, 0x4000
  s_mov_b32 s27, 0x20000
  s_cmp_lg_u32 s32, 0
  s_cbranch_scc1 K1_NOPOLL
  v_mov_b32 v224, 128
  s_mov_b32 s45, 0
K1_POLL:
  global_load_dword v225, v224, s[52:53] sc1
  s_waitcnt vmcnt(0)
  v_readfirstlane_b32 s46, v225
  s_add_u32 s45, s45, 1
  s_cmp_ge_u32 s46, 1
  s_cbranch_scc1 K1_POLL_OK
  s_cmp_lt_u32 s45, 0x100000
  s_cbranch_scc1 K1_POLL
K1_POLL_OK:
  buffer_load_dwordx4 v[224:227], v24, s[28:31], 0 offen offset:0 sc1
  buffer_load_dwordx4 v[228:231], v24, s[28:31], 0 offen offset:1024 sc1
  buffer_load_dwordx4 v[232:235], v24, s[28:31], 0 offen offset:2048 sc1
  buffer_load_dwordx4 v[236:239], v24, s[28:31], 0 offen offset:3072 sc1
  v_add_u32 v240, 147456, v24
  s_waitcnt vmcnt(3)
  ds_write_b128 v240, v[224:227] offset:0
  s_waitcnt vmcnt(2)
  ds_write_b128 v240, v[228:231] offset:1024
  s_waitcnt vmcnt(1)
  ds_write_b128 v240, v[232:235] offset:2048
  s_waitcnt vmcnt(0)
  ds_write_b128 v240, v[236:239] offset:3072
  s_waitcnt lgkmcnt(0)
K1_NOPOLL:
  s_barrier
  ds_read_b128 v[160:163], v31 offset:2048
  ds_read_b128 v[164:167], v31 offset:2064
  ds_read_b128 v[168:171], v31 offset:0
  ds_read_b128 v[172:175], v31 offset:16
  ds_read_b128 v[176:179], v31 offset:2176
  ds_read_b128 v[180:183], v31 offset:2192
  ds_read_b128 v[184:187], v31 offset:128
  ds_read_b128 v[188:191], v31 offset:144
  ds_read_b128 v[192:195], v31 offset:2304
  ds_read_b128 v[196:199], v31 offset:2320
  ds_read_b128 v[200:203], v31 offset:256
  ds_read_b128 v[204:207], v31 offset:272
  s_waitcnt lgkmcnt(8)
  v_pk_fma_f32 v[32:33], v[32:33], v[160:161], v[168:169]
  v_pk_fma_f32 v[34:35], v[34:35], v[162:163], v[170:171]
  v_pk_fma_f32 v[36:37], v[36:37], v[164:165], v[172:173]
  v_pk_fma_f32 v[38:39], v[38:39], v[166:167], v[174:175]
  v_cvt_pk_bf16_f32 v32, v32, v33
  v_cvt_pk_bf16_f32 v33, v34, v35
  v_cvt_pk_bf16_f32 v34, v36, v37
  v_cvt_pk_bf16_f32 v35, v38, v39
  ds_write_b128 v30, v[32:35] offset:0
  ds_read_b128 v[208:211], v31 offset:2432
  ds_read_b128 v[212:215], v31 offset:2448
  ds_read_b128 v[216:219], v31 offset:384
  ds_read_b128 v[220:223], v31 offset:400
  s_waitcnt lgkmcnt(9)
  v_pk_fma_f32 v[40:41], v[40:41], v[176:177], v[184:185]
  v_pk_fma_f32 v[42:43], v[42:43], v[178:179], v[186:187]
  v_pk_fma_f32 v[44:45], v[44:45], v[180:181], v[188:189]
  v_pk_fma_f32 v[46:47], v[46:47], v[182:183], v[190:191]
  v_cvt_pk_bf16_f32 v40, v40, v41
  v_cvt_pk_bf16_f32 v41, v42, v43
  v_cvt_pk_bf16_f32 v42, v44, v45
  v_cvt_pk_bf16_f32 v43, v46, v47
  ds_write_b128 v30, v[40:43] offset:4096
  s_add_u32 s47, s40, 4
  s_mul_i32 s47, s47, s49
  buffer_load_dwordx4 a[236:239], v2, s[4:7], s47 offen offset:0
  ds_read_b128 v[160:163], v31 offset:2560
  ds_read_b128 v[164:167], v31 offset:2576
  ds_read_b128 v[168:171], v31 offset:512
  ds_read_b128 v[172:175], v31 offset:528
  s_waitcnt lgkmcnt(10)
  v_pk_fma_f32 v[48:49], v[48:49], v[192:193], v[200:201]
  v_pk_fma_f32 v[50:51], v[50:51], v[194:195], v[202:203]
  v_pk_fma_f32 v[52:53], v[52:53], v[196:197], v[204:205]
  v_pk_fma_f32 v[54:55], v[54:55], v[198:199], v[206:207]
  v_cvt_pk_bf16_f32 v48, v48, v49
  v_cvt_pk_bf16_f32 v49, v50, v51
  v_cvt_pk_bf16_f32 v50, v52, v53
  v_cvt_pk_bf16_f32 v51, v54, v55
  ds_write_b128 v30, v[48:51] offset:8192
  ds_read_b128 v[176:179], v31 offset:2688
  ds_read_b128 v[180:183], v31 offset:2704
  ds_read_b128 v[184:187], v31 offset:640
  ds_read_b128 v[188:191], v31 offset:656
  s_waitcnt lgkmcnt(10)
  v_pk_fma_f32 v[56:57], v[56:57], v[208:209], v[216:217]
  v_pk_fma_f32 v[58:59], v[58:59], v[210:211], v[218:219]
  v_pk_fma_f32 v[60:61], v[60:61], v[212:213], v[220:221]
  v_pk_fma_f32 v[62:63], v[62:63], v[214:215], v[222:223]
  v_cvt_pk_bf16_f32 v56, v56, v57
  v_cvt_pk_bf16_f32 v57, v58, v59
  v_cvt_pk_bf16_f32 v58, v60, v61
  v_cvt_pk_bf16_f32 v59, v62, v63
  ds_write_b128 v30, v[56:59] offset:12288
  buffer_load_dwordx4 a[236:239], v3, s[4:7], s47 offen offset:1024
  ds_read_b128 v[192:195], v31 offset:2816
  ds_read_b128 v[196:199], v31 offset:2832
  ds_read_b128 v[200:203], v31 offset:768
  ds_read_b128 v[204:207], v31 offset:784
  s_waitcnt lgkmcnt(10)
  v_pk_fma_f32 v[64:65], v[64:65], v[160:161], v[168:169]
  v_pk_fma_f32 v[66:67], v[66:67], v[162:163], v[170:171]
  v_pk_fma_f32 v[68:69], v[68:69], v[164:165], v[172:173]
  v_pk_fma_f32 v[70:71], v[70:71], v[166:167], v[174:175]
  v_cvt_pk_bf16_f32 v64, v64, v65
  v_cvt_pk_bf16_f32 v65, v66, v67
  v_cvt_pk_bf16_f32 v66, v68, v69
  v_cvt_pk_bf16_f32 v67, v70, v71
  ds_write_b128 v30, v[64:67] offset:16384
  ds_read_b128 v[208:211], v31 offset:2944
  ds_read_b128 v[212:215], v31 offset:2960
  ds_read_b128 v[216:219], v31 offset:896
  ds_read_b128 v[220:223], v31 offset:912
  s_waitcnt lgkmcnt(10)
  v_pk_fma_f32 v[72:73], v[72:73], v[176:177], v[184:185]
  v_pk_fma_f32 v[74:75], v[74:75], v[178:179], v[186:187]
  v_pk_fma_f32 v[76:77], v[76:77], v[180:181], v[188:189]
  v_pk_fma_f32 v[78:79], v[78:79], v[182:183], v[190:191]
  v_cvt_pk_bf16_f32 v72, v72, v73
  v_cvt_pk_bf16_f32 v73, v74, v75
  v_cvt_pk_bf16_f32 v74, v76, v77
  v_cvt_pk_bf16_f32 v75, v78, v79
  ds_write_b128 v30, v[72:75] offset:20480
  buffer_load_dwordx4 a[236:239], v4, s[4:7], s47 offen offset:2048
  ds_read_b128 v[160:163], v31 offset:3072
  ds_read_b128 v[164:167], v31 offset:3088
  ds_read_b128 v[168:171], v31 offset:1024
  ds_read_b128 v[172:175], v31 offset:1040
  s_waitcnt lgkmcnt(10)
  v_pk_fma_f32 v[80:81], v[80:81], v[192:193], v[200:201]
  v_pk_fma_f32 v[82:83], v[82:83], v[194:195], v[202:203]
  v_pk_fma_f32 v[84:85], v[84:85], v[196:197], v[204:205]
  v_pk_fma_f32 v[86:87], v[86:87], v[198:199], v[206:207]
  v_cvt_pk_bf16_f32 v80, v80, v81
  v_cvt_pk_bf16_f32 v81, v82, v83
  v_cvt_pk_bf16_f32 v82, v84, v85
  v_cvt_pk_bf16_f32 v83, v86, v87
  ds_write_b128 v30, v[80:83] offset:24576
  ds_read_b128 v[176:179], v31 offset:3200
  ds_read_b128 v[180:183], v31 offset:3216
  ds_read_b128 v[184:187], v31 offset:1152
  ds_read_b128 v[188:191], v31 offset:1168
  s_waitcnt lgkmcnt(10)
  v_pk_fma_f32 v[88:89], v[88:89], v[208:209], v[216:217]
  v_pk_fma_f32 v[90:91], v[90:91], v[210:211], v[218:219]
  v_pk_fma_f32 v[92:93], v[92:93], v[212:213], v[220:221]
  v_pk_fma_f32 v[94:95], v[94:95], v[214:215], v[222:223]
  v_cvt_pk_bf16_f32 v88, v88, v89
  v_cvt_pk_bf16_f32 v89, v90, v91
  v_cvt_pk_bf16_f32 v90, v92, v93
  v_cvt_pk_bf16_f32 v91, v94, v95
  ds_write_b128 v30, v[88:91] offset:28672
  buffer_load_dwordx4 a[236:239], v5, s[4:7], s47 offen offset:3072
  ds_read_b128 v[192:195], v31 offset:3328
  ds_read_b128 v[196:199], v31 offset:3344
  ds_read_b128 v[200:203], v31 offset:1280
  ds_read_b128 v[204:207], v31 offset:1296
  s_waitcnt lgkmcnt(10)
  v_pk_fma_f32 v[96:97], v[96:97], v[160:161], v[168:169]
  v_pk_fma_f32 v[98:99], v[98:99], v[162:163], v[170:171]
  v_pk_fma_f32 v[100:101], v[100:101], v[164:165], v[172:173]
  v_pk_fma_f32 v[102:103], v[102:103], v[166:167], v[174:175]
  v_cvt_pk_bf16_f32 v96, v96, v97
  v_cvt_pk_bf16_f32 v97, v98, v99
  v_cvt_pk_bf16_f32 v98, v100, v101
  v_cvt_pk_bf16_f32 v99, v102, v103
  ds_write_b128 v30, v[96:99] offset:32768
  ds_read_b128 v[208:211], v31 offset:3456
  ds_read_b128 v[212:215], v31 offset:3472
  ds_read_b128 v[216:219], v31 offset:1408
  ds_read_b128 v[220:223], v31 offset:1424
  s_waitcnt lgkmcnt(10)
  v_pk_fma_f32 v[104:105], v[104:105], v[176:177], v[184:185]
  v_pk_fma_f32 v[106:107], v[106:107], v[178:179], v[186:187]
  v_pk_fma_f32 v[108:109], v[108:109], v[180:181], v[188:189]
  v_pk_fma_f32 v[110:111], v[110:111], v[182:183], v[190:191]
  v_cvt_pk_bf16_f32 v104, v104, v105
  v_cvt_pk_bf16_f32 v105, v106, v107
  v_cvt_pk_bf16_f32 v106, v108, v109
  v_cvt_pk_bf16_f32 v107, v110, v111
  ds_write_b128 v30, v[104:107] offset:36864
  s_add_u32 s47, s40, 16
  s_mul_i32 s47, s47, s49
  buffer_load_dwordx4 a[236:239], v2, s[4:7], s47 offen offset:0
  ds_read_b128 v[160:163], v31 offset:3584
  ds_read_b128 v[164:167], v31 offset:3600
  ds_read_b128 v[168:171], v31 offset:1536
  ds_read_b128 v[172:175], v31 offset:1552
  s_waitcnt lgkmcnt(10)
  v_pk_fma_f32 v[112:113], v[112:113], v[192:193], v[200:201]
  v_pk_fma_f32 v[114:115], v[114:115], v[194:195], v[202:203]
  v_pk_fma_f32 v[116:117], v[116:117], v[196:197], v[204:205]
  v_pk_fma_f32 v[118:119], v[118:119], v[198:199], v[206:207]
  v_cvt_pk_bf16_f32 v112, v112, v113
  v_cvt_pk_bf16_f32 v113, v114, v115
  v_cvt_pk_bf16_f32 v114, v116, v117
  v_cvt_pk_bf16_f32 v115, v118, v119
  ds_write_b128 v30, v[112:115] offset:40960
  ds_read_b128 v[176:179], v31 offset:3712
  ds_read_b128 v[180:183], v31 offset:3728
  ds_read_b128 v[184:187], v31 offset:1664
  ds_read_b128 v[188:191], v31 offset:1680
  s_waitcnt lgkmcnt(10)
  v_pk_fma_f32 v[120:121], v[120:121], v[208:209], v[216:217]
  v_pk_fma_f32 v[122:123], v[122:123], v[210:211], v[218:219]
  v_pk_fma_f32 v[124:125], v[124:125], v[212:213], v[220:221]
  v_pk_fma_f32 v[126:127], v[126:127], v[214:215], v[222:223]
  v_cvt_pk_bf16_f32 v120, v120, v121
  v_cvt_pk_bf16_f32 v121, v122, v123
  v_cvt_pk_bf16_f32 v122, v124, v125
  v_cvt_pk_bf16_f32 v123, v126, v127
  ds_write_b128 v30, v[120:123] offset:45056
  buffer_load_dwordx4 a[236:239], v3, s[4:7], s47 offen offset:1024
  ds_read_b128 v[192:195], v31 offset:3840
  ds_read_b128 v[196:199], v31 offset:3856
  ds_read_b128 v[200:203], v31 offset:1792
  ds_read_b128 v[204:207], v31 offset:1808
  s_waitcnt lgkmcnt(10)
  v_pk_fma_f32 v[128:129], v[128:129], v[160:161], v[168:169]
  v_pk_fma_f32 v[130:131], v[130:131], v[162:163], v[170:171]
  v_pk_fma_f32 v[132:133], v[132:133], v[164:165], v[172:173]
  v_pk_fma_f32 v[134:135], v[134:135], v[166:167], v[174:175]
  v_cvt_pk_bf16_f32 v128, v128, v129
  v_cvt_pk_bf16_f32 v129, v130, v131
  v_cvt_pk_bf16_f32 v130, v132, v133
  v_cvt_pk_bf16_f32 v131, v134, v135
  ds_write_b128 v30, v[128:131] offset:49152
  ds_read_b128 v[208:211], v31 offset:3968
  ds_read_b128 v[212:215], v31 offset:3984
  ds_read_b128 v[216:219], v31 offset:1920
  ds_read_b128 v[220:223], v31 offset:1936
  s_waitcnt lgkmcnt(10)
  v_pk_fma_f32 v[136:137], v[136:137], v[176:177], v[184:185]
  v_pk_fma_f32 v[138:139], v[138:139], v[178:179], v[186:187]
  v_pk_fma_f32 v[140:141], v[140:141], v[180:181], v[188:189]
  v_pk_fma_f32 v[142:143], v[142:143], v[182:183], v[190:191]
  v_cvt_pk_bf16_f32 v136, v136, v137
  v_cvt_pk_bf16_f32 v137, v138, v139
  v_cvt_pk_bf16_f32 v138, v140, v141
  v_cvt_pk_bf16_f32 v139, v142, v143
  ds_write_b128 v30, v[136:139] offset:53248
  buffer_load_dwordx4 a[236:239], v4, s[4:7], s47 offen offset:2048
  s_waitcnt lgkmcnt(6)
  v_pk_fma_f32 v[144:145], v[144:145], v[192:193], v[200:201]
  v_pk_fma_f32 v[146:147], v[146:147], v[194:195], v[202:203]
  v_pk_fma_f32 v[148:149], v[148:149], v[196:197], v[204:205]
  v_pk_fma_f32 v[150:151], v[150:151], v[198:199], v[206:207]
  v_cvt_pk_bf16_f32 v144, v144, v145
  v_cvt_pk_bf16_f32 v145, v146, v147
  v_cvt_pk_bf16_f32 v146, v148, v149
  v_cvt_pk_bf16_f32 v147, v150, v151
  ds_write_b128 v30, v[144:147] offset:57344
  s_waitcnt lgkmcnt(2)
  v_pk_fma_f32 v[152:153], v[152:153], v[208:209], v[216:217]
  v_pk_fma_f32 v[154:155], v[154:155], v[210:211], v[218:219]
  v_pk_fma_f32 v[156:157], v[156:157], v[212:213], v[220:221]
  v_pk_fma_f32 v[158:159], v[158:159], v[214:215], v[222:223]
  v_cvt_pk_bf16_f32 v152, v152, v153
  v_cvt_pk_bf16_f32 v153, v154, v155
  v_cvt_pk_bf16_f32 v154, v156, v157
  v_cvt_pk_bf16_f32 v155, v158, v159
  ds_write_b128 v30, v[152:155] offset:61440
  buffer_load_dwordx4 a[236:239], v5, s[4:7], s47 offen offset:3072
  s_lshl_b32 s46, s32, 14
  v_add_u32 v30, s46, v10
  v_add_u32 v31, s46, v11
  s_lshl_b32 s46, s33, 8
  s_add_u32 s46, s46, 0x33000
  v_mov_b32 v224, s46
  s_and_b32 s47, s2, 7
  s_lshl_b32 s47, s47, 8
  s_add_u32 s47, s47, 0x33800
  v_mov_b32 v225, 1
  v_writelane_b32 v224, s47, 1
  s_waitcnt vmcnt(8) lgkmcnt(0)
  s_barrier
  s_cmp_lg_u32 s32, 0
  s_cbranch_scc1 K1_NOARR
  s_cmp_lt_u32 s3, 128
  s_cselect_b32 exec_lo, 3, 1
  s_mov_b32 exec_hi, 0
  global_atomic_add v224, v225, s[54:55]
  s_mov_b64 exec, -1
K1_NOARR:
K1_QSTART:
  v_min_u32 v208, 8, v1
  v_lshlrev_b32 v208, 8, v208
  v_add_u32 v208, 0x33700, v208
  s_lshl_b32 s46, s33, 8
  s_add_u32 s46, s46, 0x33000
  v_mov_b32 v210, 16
  v_writelane_b32 v208, s46, 0
  v_writelane_b32 v210, 32, 0
  s_waitcnt vmcnt(20)
  ds_read_b128 v[192:195], v10 offset:0
  ds_read_b128 v[196:199], v10 offset:1024
  ds_read_b64_tr_b16 v[160:161], v6 offset:0
  ds_read_b64_tr_b16 v[162:163], v6 offset:1024
  ds_read_b64_tr_b16 v[164:165], v7 offset:0
  ds_read_b64_tr_b16 v[166:167], v7 offset:1024
  ds_read_b64_tr_b16 v[168:169], v8 offset:0
  ds_read_b64_tr_b16 v[170:171], v8 offset:1024
  ds_read_b64_tr_b16 v[172:173], v9 offset:0
  ds_read_b64_tr_b16 v[174:175], v9 offset:1024
  s_waitcnt lgkmcnt(0)
  v_mfma_f32_32x32x16_bf16 v[32:47], v[160:163], v[192:195], 0
  s_waitcnt vmcnt(16)
  ds_read_b128 v[200:203], v11 offset:2048
  v_mfma_f32_32x32x16_bf16 v[48:63], v[160:163], v[196:199], 0
  ds_read_b128 v[204:207], v11 offset:3072
  ds_read_b64_tr_b16 v[176:177], v6 offset:4096
  ds_read_b64_tr_b16 v[178:179], v6 offset:5120
  v_mfma_f32_32x32x16_bf16 v[64:79], v[164:167], v[192:195], 0
  ds_read_b64_tr_b16 v[180:181], v7 offset:4096
  ds_read_b64_tr_b16 v[182:183], v7 offset:5120
  v_mfma_f32_32x32x16_bf16 v[80:95], v[164:167], v[196:199], 0
  ds_read_b64_tr_b16 v[184:185], v8 offset:4096
  ds_read_b64_tr_b16 v[186:187], v8 offset:5120
  v_mfma_f32_32x32x16_bf16 v[96:111], v[168:171], v[192:195], 0
  ds_read_b64_tr_b16 v[188:189], v9 offset:4096
  ds_read_b64_tr_b16 v[190:191], v9 offset:5120
  v_mfma_f32_32x32x16_bf16 v[112:127], v[168:171], v[196:199], 0
  s_add_u32 m0, s43, 0
  s_nop 0
  buffer_load_dwordx4 v2, s[4:7], s44 offen lds
  v_mfma_f32_32x32x16_bf16 v[128:143], v[172:175], v[192:195], 0
  buffer_load_dwordx4 v3, s[4:7], s44 offen offset:1024 lds
  buffer_load_dwordx4 v4, s[4:7], s44 offen offset:2048 lds
  v_mfma_f32_32x32x16_bf16 v[144:159], v[172:175], v[196:199], 0
  buffer_load_dwordx4 v5, s[4:7], s44 offen offset:3072 lds
  s_add_u32 s44, s44, s49
  s_waitcnt lgkmcnt(0)
  v_mfma_f32_32x32x16_bf16 v[32:47], v[176:179], v[200:203], v[32:47]
  s_waitcnt vmcnt(16)
  ds_read_b128 v[192:195], v10 offset:4096
  ds_read_b128 v[196:199], v10 offset:5120
  v_mfma_f32_32x32x16_bf16 v[48:63], v[176:179], v[204:207], v[48:63]
  ds_read_b64_tr_b16 v[160:161], v6 offset:8192
  ds_read_b64_tr_b16 v[162:163], v6 offset:9216
  ds_read_b64_tr_b16 v[164:165], v7 offset:8192
  ds_read_b64_tr_b16 v[166:167], v7 offset:9216
  v_mfma_f32_32x32x16_bf16 v[64:79], v[180:183], v[200:203], v[64:79]
  ds_read_b64_tr_b16 v[168:169], v8 offset:8192
  ds_read_b64_tr_b16 v[170:171], v8 offset:9216
  ds_read_b64_tr_b16 v[172:173], v9 offset:8192
  v_mfma_f32_32x32x16_bf16 v[80:95], v[180:183], v[204:207], v[80:95]
  ds_read_b64_tr_b16 v[174:175], v9 offset:9216
  s_add_u32 m0, s43, 4096
  s_nop 0
  buffer_load_dwordx4 v2, s[4:7], s44 offen lds
  v_mfma_f32_32x32x16_bf16 v[96:111], v[184:187], v[200:203], v[96:111]
  buffer_load_dwordx4 v3, s[4:7], s44 offen offset:1024 lds
  buffer_load_dwordx4 v4, s[4:7], s44 offen offset:2048 lds
  v_mfma_f32_32x32x16_bf16 v[112:127], v[184:187], v[204:207], v[112:127]
  buffer_load_dwordx4 v5, s[4:7], s44 offen offset:3072 lds
  s_add_u32 s44, s44, s49
  v_mfma_f32_32x32x16_bf16 v[128:143], v[188:191], v[200:203], v[128:143]
  s_lshl_b32 s47, s40, 1
  s_add_u32 s47, s47, 0
  s_and_b32 s46, s47, 3
  s_lshr_b32 s47, s47, 2
  s_lshl_b32 s47, s47, 4
  s_add_u32 s47, s47, s46
  s_lshl_b32 s47, s47, 10
  buffer_load_dwordx4 a[236:239], v24, s[8:11], s47 offen
  v_mfma_f32_32x32x16_bf16 v[144:159], v[188:191], v[204:207], v[144:159]
  s_waitcnt lgkmcnt(0)
  v_mfma_f32_32x32x16_bf16 v[32:47], v[160:163], v[192:195], v[32:47]
  s_waitcnt vmcnt(17)
  ds_read_b128 v[200:203], v11 offset:6144
  v_mfma_f32_32x32x16_bf16 v[48:63], v[160:163], v[196:199], v[48:63]
  ds_read_b128 v[204:207], v11 offset:7168
  ds_read_b64_tr_b16 v[176:177], v6 offset:12288
  ds_read_b64_tr_b16 v[178:179], v6 offset:13312
  v_mfma_f32_32x32x16_bf16 v[64:79], v[164:167], v[192:195], v[64:79]
  ds_read_b64_tr_b16 v[180:181], v7 offset:12288
  ds_read_b64_tr_b16 v[182:183], v7 offset:13312
  v_mfma_f32_32x32x16_bf16 v[80:95], v[164:167], v[196:199], v[80:95]
  ds_read_b64_tr_b16 v[184:185], v8 offset:12288
  ds_read_b64_tr_b16 v[186:187], v8 offset:13312
  v_mfma_f32_32x32x16_bf16 v[96:111], v[168:171], v[192:195], v[96:111]
  ds_read_b64_tr_b16 v[188:189], v9 offset:12288
  ds_read_b64_tr_b16 v[190:191], v9 offset:13312
  v_mfma_f32_32x32x16_bf16 v[112:127], v[168:171], v[196:199], v[112:127]
  s_add_u32 m0, s43, 8192
  s_nop 0
  buffer_load_dwordx4 v2, s[4:7], s44 offen lds
  v_mfma_f32_32x32x16_bf16 v[128:143], v[172:175], v[192:195], v[128:143]
  buffer_load_dwordx4 v3, s[4:7], s44 offen offset:1024 lds
  buffer_load_dwordx4 v4, s[4:7], s44 offen offset:2048 lds
  v_mfma_f32_32x32x16_bf16 v[144:159], v[172:175], v[196:199], v[144:159]
  buffer_load_dwordx4 v5, s[4:7], s44 offen offset:3072 lds
  s_add_u32 s44, s44, s49
  s_waitcnt lgkmcnt(0)
  v_mfma_f32_32x32x16_bf16 v[32:47], v[176:179], v[200:203], v[32:47]
  s_waitcnt vmcnt(9)
  ds_read_b128 v[192:195], v10 offset:8192
  ds_read_b128 v[196:199], v10 offset:9216
  v_mfma_f32_32x32x16_bf16 v[48:63], v[176:179], v[204:207], v[48:63]
  ds_read_b64_tr_b16 v[160:161], v6 offset:0
  ds_read_b64_tr_b16 v[162:163], v6 offset:1024
  ds_read_b64_tr_b16 v[164:165], v7 offset:0
  ds_read_b64_tr_b16 v[166:167], v7 offset:1024
  v_mfma_f32_32x32x16_bf16 v[64:79], v[180:183], v[200:203], v[64:79]
  ds_read_b64_tr_b16 v[168:169], v8 offset:0
  ds_read_b64_tr_b16 v[170:171], v8 offset:1024
  ds_read_b64_tr_b16 v[172:173], v9 offset:0
  v_mfma_f32_32x32x16_bf16 v[80:95], v[180:183], v[204:207], v[80:95]
  ds_read_b64_tr_b16 v[174:175], v9 offset:1024
  s_add_u32 m0, s43, 12288
  s_nop 0
  buffer_load_dwordx4 v2, s[4:7], s44 offen lds
  v_mfma_f32_32x32x16_bf16 v[96:111], v[184:187], v[200:203], v[96:111]
  buffer_load_dwordx4 v3, s[4:7], s44 offen offset:1024 lds
  buffer_load_dwordx4 v4, s[4:7], s44 offen offset:2048 lds
  v_mfma_f32_32x32x16_bf16 v[112:127], v[184:187], v[204:207], v[112:127]
  buffer_load_dwordx4 v5, s[4:7], s44 offen offset:3072 lds
  s_add_u32 s44, s44, s49
  v_mfma_f32_32x32x16_bf16 v[128:143], v[188:191], v[200:203], v[128:143]
  s_lshl_b32 s47, s40, 1
  s_add_u32 s47, s47, 1
  s_and_b32 s46, s47, 3
  s_lshr_b32 s47, s47, 2
  s_lshl_b32 s47, s47, 4
  s_add_u32 s47, s47, s46
  s_lshl_b32 s47, s47, 10
  buffer_load_dwordx4 a[236:239], v24, s[8:11], s47 offen
  v_mfma_f32_32x32x16_bf16 v[144:159], v[188:191], v[204:207], v[144:159]
  v_add_u32 v10, 8192, v10
  v_add_u32 v11, 8192, v11
  s_mov_b32 s45, 6
K1_QP_LOOP:
  s_waitcnt lgkmcnt(0)
  v_mfma_f32_32x32x16_bf16 v[32:47], v[160:163], v[192:195], v[32:47]
  s_waitcnt vmcnt(8)
  ds_read_b128 v[200:203], v11 offset:2048
  v_mfma_f32_32x32x16_bf16 v[48:63], v[160:163], v[196:199], v[48:63]
  ds_read_b128 v[204:207], v11 offset:3072
  ds_read_b64_tr_b16 v[176:177], v6 offset:4096
  ds_read_b64_tr_b16 v[178:179], v6 offset:5120
  v_mfma_f32_32x32x16_bf16 v[64:79], v[164:167], v[192:195], v[64:79]
  ds_read_b64_tr_b16 v[180:181], v7 offset:4096
  ds_read_b64_tr_b16 v[182:183], v7 offset:5120
  v_mfma_f32_32x32x16_bf16 v[80:95], v[164:167], v[196:199], v[80:95]
  ds_read_b64_tr_b16 v[184:185], v8 offset:4096
  ds_read_b64_tr_b16 v[186:187], v8 offset:5120
  v_mfma_f32_32x32x16_bf16 v[96:111], v[168:171], v[192:195], v[96:111]
  ds_read_b64_tr_b16 v[188:189], v9 offset:4096
  ds_read_b64_tr_b16 v[190:191], v9 offset:5120
  v_mfma_f32_32x32x16_bf16 v[112:127], v[168:171], v[196:199], v[112:127]
  s_add_u32 m0, s43, 0
  s_nop 0
  buffer_load_dwordx4 v2, s[4:7], s44 offen lds
  v_mfma_f32_32x32x16_bf16 v[128:143], v[172:175], v[192:195], v[128:143]
  buffer_load_dwordx4 v3, s[4:7], s44 offen offset:1024 lds
  buffer_load_dwordx4 v4, s[4:7], s44 offen offset:2048 lds
  v_mfma_f32_32x32x16_bf16 v[144:159], v[172:175], v[196:199], v[144:159]
  buffer_load_dwordx4 v5, s[4:7], s44 offen offset:3072 lds
  s_add_u32 s44, s44, s49
  s_waitcnt lgkmcnt(0)
  v_mfma_f32_32x32x16_bf16 v[32:47], v[176:179], v[200:203], v[32:47]
  s_waitcnt vmcnt(8)
  ds_read_b128 v[192:195], v10 offset:4096
  v_mfma_f32_32x32x16_bf16 v[48:63], v[176:179], v[204:207], v[48:63]
  ds_read_b128 v[196:199], v10 offset:5120
  ds_read_b64_tr_b16 v[160:161], v6 offset:8192
  ds_read_b64_tr_b16 v[162:163], v6 offset:9216
  v_mfma_f32_32x32x16_bf16 v[64:79], v[180:183], v[200:203], v[64:79]
  ds_read_b64_tr_b16 v[164:165], v7 offset:8192
  ds_read_b64_tr_b16 v[166:167], v7 offset:9216
  v_mfma_f32_32x32x16_bf16 v[80:95], v[180:183], v[204:207], v[80:95]
  ds_read_b64_tr_b16 v[168:169], v8 offset:8192
  ds_read_b64_tr_b16 v[170:171], v8 offset:9216
  v_mfma_f32_32x32x16_bf16 v[96:111], v[184:187], v[200:203], v[96:111]
  ds_read_b64_tr_b16 v[172:173], v9 offset:8192
  ds_read_b64_tr_b16 v[174:175], v9 offset:9216
  v_mfma_f32_32x32x16_bf16 v[112:127], v[184:187], v[204:207], v[112:127]
  s_add_u32 m0, s43, 4096
  s_nop 0
  buffer_load_dwordx4 v2, s[4:7], s44 offen lds
  v_mfma_f32_32x32x16_bf16 v[128:143], v[188:191], v[200:203], v[128:143]
  buffer_load_dwordx4 v3, s[4:7], s44 offen offset:1024 lds
  buffer_load_dwordx4 v4, s[4:7], s44 offen offset:2048 lds
  v_mfma_f32_32x32x16_bf16 v[144:159], v[188:191], v[204:207], v[144:159]
  buffer_load_dwordx4 v5, s[4:7], s44 offen offset:3072 lds
  s_add_u32 s44, s44, s49
  s_waitcnt lgkmcnt(0)
  v_mfma_f32_32x32x16_bf16 v[32:47], v[160:163], v[192:195], v[32:47]
  s_waitcnt vmcnt(8)
  ds_read_b128 v[200:203], v11 offset:6144
  v_mfma_f32_32x32x16_bf16 v[48:63], v[160:163], v[196:199], v[48:63]
  ds_read_b128 v[204:207], v11 offset:7168
  ds_read_b64_tr_b16 v[176:177], v6 offset:12288
  ds_read_b64_tr_b16 v[178:179], v6 offset:13312
  v_mfma_f32_32x32x16_bf16 v[64:79], v[164:167], v[192:195], v[64:79]
  ds_read_b64_tr_b16 v[180:181], v7 offset:12288
  ds_read_b64_tr_b16 v[182:183], v7 offset:13312
  v_mfma_f32_32x32x16_bf16 v[80:95], v[164:167], v[196:199], v[80:95]
  ds_read_b64_tr_b16 v[184:185], v8 offset:12288
  ds_read_b64_tr_b16 v[186:187], v8 offset:13312
  v_mfma_f32_32x32x16_bf16 v[96:111], v[168:171], v[192:195], v[96:111]
  ds_read_b64_tr_b16 v[188:189], v9 offset:12288
  ds_read_b64_tr_b16 v[190:191], v9 offset:13312
  v_mfma_f32_32x32x16_bf16 v[112:127], v[168:171], v[196:199], v[112:127]
  s_add_u32 m0, s43, 8192
  s_nop 0
  buffer_load_dwordx4 v2, s[4:7], s44 offen lds
  v_mfma_f32_32x32x16_bf16 v[128:143], v[172:175], v[192:195], v[128:143]
  buffer_load_dwordx4 v3, s[4:7], s44 offen offset:1024 lds
  buffer_load_dwordx4 v4, s[4:7], s44 offen offset:2048 lds
  v_mfma_f32_32x32x16_bf16 v[144:159], v[172:175], v[196:199], v[144:159]
  buffer_load_dwordx4 v5, s[4:7], s44 offen offset:3072 lds
  s_add_u32 s44, s44, s49
  s_waitcnt lgkmcnt(0)
  v_mfma_f32_32x32x16_bf16 v[32:47], v[176:179], v[200:203], v[32:47]
  s_waitcnt vmcnt(8)
  ds_read_b128 v[192:195], v10 offset:8192
  v_mfma_f32_32x32x16_bf16 v[48:63], v[176:179], v[204:207], v[48:63]
  ds_read_b128 v[196:199], v10 offset:9216
  ds_read_b64_tr_b16 v[160:161], v6 offset:0
  ds_read_b64_tr_b16 v[162:163], v6 offset:1024
  v_mfma_f32_32x32x16_bf16 v[64:79], v[180:183], v[200:203], v[64:79]
  ds_read_b64_tr_b16 v[164:165], v7 offset:0
  ds_read_b64_tr_b16 v[166:167], v7 offset:1024
  v_mfma_f32_32x32x16_bf16 v[80:95], v[180:183], v[204:207], v[80:95]
  ds_read_b64_tr_b16 v[168:169], v8 offset:0
  ds_read_b64_tr_b16 v[170:171], v8 offset:1024
  v_mfma_f32_32x32x16_bf16 v[96:111], v[184:187], v[200:203], v[96:111]
  ds_read_b64_tr_b16 v[172:173], v9 offset:0
  ds_read_b64_tr_b16 v[174:175], v9 offset:1024
  v_mfma_f32_32x32x16_bf16 v[112:127], v[184:187], v[204:207], v[112:127]
  s_add_u32 m0, s43, 12288
  s_nop 0
  buffer_load_dwordx4 v2, s[4:7], s44 offen lds
  v_mfma_f32_32x32x16_bf16 v[128:143], v[188:191], v[200:203], v[128:143]
  buffer_load_dwordx4 v3, s[4:7], s44 offen offset:1024 lds
  buffer_load_dwordx4 v4, s[4:7], s44 offen offset:2048 lds
  v_mfma_f32_32x32x16_bf16 v[144:159], v[188:191], v[204:207], v[144:159]
  buffer_load_dwordx4 v5, s[4:7], s44 offen offset:3072 lds
  s_add_u32 s44, s44, s49
  v_add_u32 v10, 8192, v10
  v_add_u32 v11, 8192, v11
  s_sub_u32 s45, s45, 1
  s_cmp_lg_u32 s45, 0
  s_cbranch_scc1 K1_QP_LOOP
  s_waitcnt lgkmcnt(0)
  v_mfma_f32_32x32x16_bf16 v[32:47], v[160:163], v[192:195], v[32:47]
  s_waitcnt vmcnt(8)
  ds_read_b128 v[200:203], v11 offset:2048
  v_mfma_f32_32x32x16_bf16 v[48:63], v[160:163], v[196:199], v[48:63]
  ds_read_b128 v[204:207], v11 offset:3072
  ds_read_b64_tr_b16 v[176:177], v6 offset:4096
  v_mfma_f32_32x32x16_bf16 v[64:79], v[164:167], v[192:195], v[64:79]
  ds_read_b64_tr_b16 v[178:179], v6 offset:5120
  ds_read_b64_tr_b16 v[180:181], v7 offset:4096
  v_mfma_f32_32x32x16_bf16 v[80:95], v[164:167], v[196:199], v[80:95]
  ds_read_b64_tr_b16 v[182:183], v7 offset:5120
  ds_read_b64_tr_b16 v[184:185], v8 offset:4096
  ds_read_b64_tr_b16 v[186:187], v8 offset:5120
  v_mfma_f32_32x32x16_bf16 v[96:111], v[168:171], v[192:195], v[96:111]
  ds_read_b64_tr_b16 v[188:189], v9 offset:4096
  ds_read_b64_tr_b16 v[190:191], v9 offset:5120
  v_mfma_f32_32x32x16_bf16 v[112:127], v[168:171], v[196:199], v[112:127]
  s_add_u32 m0, s48, 131072
  s_mov_b32 s46, 0
  buffer_load_dwordx4 v12, s[8:11], s46 offen offset:0 lds
  v_mfma_f32_32x32x16_bf16 v[128:143], v[172:175], v[192:195], v[128:143]
  buffer_load_dwordx4 v13, s[8:11], s46 offen offset:1024 lds
  v_mfma_f32_32x32x16_bf16 v[144:159], v[172:175], v[196:199], v[144:159]
  buffer_load_dwordx4 v14, s[8:11], s46 offen offset:2048 lds
  buffer_load_dwordx4 v15, s[8:11], s46 offen offset:3072 lds
  s_waitcnt lgkmcnt(0)
  v_mfma_f32_32x32x16_bf16 v[32:47], v[176:179], v[200:203], v[32:47]
  s_waitcnt vmcnt(8)
  ds_read_b128 v[192:195], v10 offset:4096
  v_mfma_f32_32x32x16_bf16 v[48:63], v[176:179], v[204:207], v[48:63]
  ds_read_b128 v[196:199], v10 offset:5120
  ds_read_b64_tr_b16 v[160:161], v6 offset:8192
  v_mfma_f32_32x32x16_bf16 v[64:79], v[180:183], v[200:203], v[64:79]
  ds_read_b64_tr_b16 v[162:163], v6 offset:9216
  ds_read_b64_tr_b16 v[164:165], v7 offset:8192
  v_mfma_f32_32x32x16_bf16 v[80:95], v[180:183], v[204:207], v[80:95]
  ds_read_b64_tr_b16 v[166:167], v7 offset:9216
  ds_read_b64_tr_b16 v[168:169], v8 offset:8192
  ds_read_b64_tr_b16 v[170:171], v8 offset:9216
  v_mfma_f32_32x32x16_bf16 v[96:111], v[184:187], v[200:203], v[96:111]
  ds_read_b64_tr_b16 v[172:173], v9 offset:8192
  ds_read_b64_tr_b16 v[174:175], v9 offset:9216
  v_mfma_f32_32x32x16_bf16 v[112:127], v[184:187], v[204:207], v[112:127]
  s_add_u32 m0, s48, 147456
  s_mov_b32 s46, 16384
  buffer_load_dwordx4 v12, s[8:11], s46 offen offset:0 lds
  v_mfma_f32_32x32x16_bf16 v[128:143], v[188:191], v[200:203], v[128:143]
  buffer_load_dwordx4 v13, s[8:11], s46 offen offset:1024 lds
  v_mfma_f32_32x32x16_bf16 v[144:159], v[188:191], v[204:207], v[144:159]
  buffer_load_dwordx4 v14, s[8:11], s46 offen offset:2048 lds
  buffer_load_dwordx4 v15, s[8:11], s46 offen offset:3072 lds
  s_waitcnt lgkmcnt(0)
  v_mfma_f32_32x32x16_bf16 v[32:47], v[160:163], v[192:195], v[32:47]
  s_waitcnt vmcnt(8)
  ds_read_b128 v[200:203], v11 offset:6144
  v_mfma_f32_32x32x16_bf16 v[48:63], v[160:163], v[196:199], v[48:63]
  ds_read_b128 v[204:207], v11 offset:7168
  v_mfma_f32_32x32x16_bf16 v[64:79], v[164:167], v[192:195], v[64:79]
  ds_read_b64_tr_b16 v[176:177], v6 offset:12288
  ds_read_b64_tr_b16 v[178:179], v6 offset:13312
  v_mfma_f32_32x32x16_bf16 v[80:95], v[164:167], v[196:199], v[80:95]
  ds_read_b64_tr_b16 v[180:181], v7 offset:12288
  v_mfma_f32_32x32x16_bf16 v[96:111], v[168:171], v[192:195], v[96:111]
  ds_read_b64_tr_b16 v[182:183], v7 offset:13312
  ds_read_b64_tr_b16 v[184:185], v8 offset:12288
  v_mfma_f32_32x32x16_bf16 v[112:127], v[168:171], v[196:199], v[112:127]
  ds_read_b64_tr_b16 v[186:187], v8 offset:13312
  v_mfma_f32_32x32x16_bf16 v[128:143], v[172:175], v[192:195], v[128:143]
  ds_read_b64_tr_b16 v[188:189], v9 offset:12288
  ds_read_b64_tr_b16 v[190:191], v9 offset:13312
  v_mfma_f32_32x32x16_bf16 v[144:159], v[172:175], v[196:199], v[144:159]
  global_load_dword v209, v208, s[54:55] sc1
  s_waitcnt lgkmcnt(0)
  v_mfma_f32_32x32x16_bf16 v[32:47], v[176:179], v[200:203], v[32:47]
  v_mfma_f32_32x32x16_bf16 v[48:63], v[176:179], v[204:207], v[48:63]
  v_mfma_f32_32x32x16_bf16 v[64:79], v[180:183], v[200:203], v[64:79]
  v_mfma_f32_32x32x16_bf16 v[80:95], v[180:183], v[204:207], v[80:95]
  v_mfma_f32_32x32x16_bf16 v[96:111], v[184:187], v[200:203], v[96:111]
  v_mfma_f32_32x32x16_bf16 v[112:127], v[184:187], v[204:207], v[112:127]
  v_mfma_f32_32x32x16_bf16 v[128:143], v[188:191], v[200:203], v[128:143]
  v_mfma_f32_32x32x16_bf16 v[144:159], v[188:191], v[204:207], v[144:159]
  s_waitcnt vmcnt(0)
  v_cmp_gt_u32 vcc, v210, v209
  s_nop 4
  s_cbranch_vccz K1_POLL2_OK
  s_mov_b32 s45, 0
K1_POLL2:
  global_load_dword v209, v208, s[54:55] sc1
  s_waitcnt vmcnt(0)
  v_cmp_gt_u32 vcc, v210, v209
  s_add_u32 s45, s45, 1
  s_nop 3
  s_cbranch_vccz K1_POLL2_OK
  s_cmp_lt_u32 s45, 0x100000
  s_cbranch_scc1 K1_POLL2
K1_POLL2_OK:
  s_waitcnt vmcnt(0)
  s_barrier
  ds_read_b128 a[64:67], v16 offset:0
  ds_read_b128 a[68:71], v17 offset:0
  ds_read_b128 a[72:75], v18 offset:0
  ds_read_b128 a[76:79], v19 offset:0
  ds_read_b128 a[80:83], v20 offset:0
  ds_read_b128 a[84:87], v21 offset:0
  ds_read_b128 a[88:91], v22 offset:0
  ds_read_b128 a[92:95], v23 offset:0
  v_cvt_pk_bf16_f32 v160, v32, v33
  v_accvgpr_write_b32 a0, v160
  v_cvt_pk_bf16_f32 v161, v34, v35
  v_accvgpr_write_b32 a1, v161
  v_cvt_pk_bf16_f32 v162, v36, v37
  v_accvgpr_write_b32 a2, v162
  v_cvt_pk_bf16_f32 v163, v38, v39
  v_accvgpr_write_b32 a3, v163
  v_cvt_pk_bf16_f32 v164, v40, v41
  v_accvgpr_write_b32 a8, v164
  v_cvt_pk_bf16_f32 v165, v42, v43
  v_accvgpr_write_b32 a9, v165
  v_cvt_pk_bf16_f32 v166, v44, v45
  v_accvgpr_write_b32 a10, v166
  v_cvt_pk_bf16_f32 v167, v46, v47
  v_accvgpr_write_b32 a11, v167
  s_add_u32 m0, s48, 65536
  s_mov_b32 s46, 32768
  buffer_load_dwordx4 v12, s[8:11], s46 offen offset:0 lds
  v_cvt_pk_bf16_f32 v168, v48, v49
  v_accvgpr_write_b32 a4, v168
  v_cvt_pk_bf16_f32 v169, v50, v51
  v_accvgpr_write_b32 a5, v169
  v_cvt_pk_bf16_f32 v170, v52, v53
  v_accvgpr_write_b32 a6, v170
  v_cvt_pk_bf16_f32 v171, v54, v55
  v_accvgpr_write_b32 a7, v171
  v_cvt_pk_bf16_f32 v172, v56, v57
  v_accvgpr_write_b32 a12, v172
  v_cvt_pk_bf16_f32 v173, v58, v59
  v_accvgpr_write_b32 a13, v173
  v_cvt_pk_bf16_f32 v174, v60, v61
  v_accvgpr_write_b32 a14, v174
  v_cvt_pk_bf16_f32 v175, v62, v63
  v_accvgpr_write_b32 a15, v175
  buffer_load_dwordx4 v13, s[8:11], s46 offen offset:1024 lds
  v_cvt_pk_bf16_f32 v160, v64, v65
  v_accvgpr_write_b32 a16, v160
  v_cvt_pk_bf16_f32 v161, v66, v67
  v_accvgpr_write_b32 a17, v161
  v_cvt_pk_bf16_f32 v162, v68, v69
  v_accvgpr_write_b32 a18, v162
  v_cvt_pk_bf16_f32 v163, v70, v71
  v_accvgpr_write_b32 a19, v163
  v_cvt_pk_bf16_f32 v164, v72, v73
  v_accvgpr_write_b32 a24, v164
  v_cvt_pk_bf16_f32 v165, v74, v75
  v_accvgpr_write_b32 a25, v165
  v_cvt_pk_bf16_f32 v166, v76, v77
  v_accvgpr_write_b32 a26, v166
  v_cvt_pk_bf16_f32 v167, v78, v79
  v_accvgpr_write_b32 a27, v167
  buffer_load_dwordx4 v14, s[8:11], s46 offen offset:2048 lds
  v_cvt_pk_bf16_f32 v168, v80, v81
  v_accvgpr_write_b32 a20, v168
  v_cvt_pk_bf16_f32 v169, v82, v83
  v_accvgpr_write_b32 a21, v169
  v_cvt_pk_bf16_f32 v170, v84, v85
  v_accvgpr_write_b32 a22, v170
  v_cvt_pk_bf16_f32 v171, v86, v87
  v_accvgpr_write_b32 a23, v171
  v_cvt_pk_bf16_f32 v172, v88, v89
  v_accvgpr_write_b32 a28, v172
  v_cvt_pk_bf16_f32 v173, v90, v91
  v_accvgpr_write_b32 a29, v173
  v_cvt_pk_bf16_f32 v174, v92, v93
  v_accvgpr_write_b32 a30, v174
  v_cvt_pk_bf16_f32 v175, v94, v95
  v_accvgpr_write_b32 a31, v175
  buffer_load_dwordx4 v15, s[8:11], s46 offen offset:3072 lds
  v_cvt_pk_bf16_f32 v160, v96, v97
  v_accvgpr_write_b32 a32, v160
  v_cvt_pk_bf16_f32 v161, v98, v99
  v_accvgpr_write_b32 a33, v161
  v_cvt_pk_bf16_f32 v162, v100, v101
  v_accvgpr_write_b32 a34, v162
  v_cvt_pk_bf16_f32 v163, v102, v103
  v_accvgpr_write_b32 a35, v163
  v_cvt_pk_bf16_f32 v164, v104, v105
  v_accvgpr_write_b32 a40, v164
  v_cvt_pk_bf16_f32 v165, v106, v107
  v_accvgpr_write_b32 a41, v165
  v_cvt_pk_bf16_f32 v166, v108, v109
  v_accvgpr_write_b32 a42, v166
  v_cvt_pk_bf16_f32 v167, v110, v111
  v_accvgpr_write_b32 a43, v167
  s_add_u32 m0, s48, 81920
  s_mov_b32 s46, 49152
  buffer_load_dwordx4 v12, s[8:11], s46 offen offset:0 lds
  v_cvt_pk_bf16_f32 v168, v112, v113
  v_accvgpr_write_b32 a36, v168
  v_cvt_pk_bf16_f32 v169, v114, v115
  v_accvgpr_write_b32 a37, v169
  v_cvt_pk_bf16_f32 v170, v116, v117
  v_accvgpr_write_b32 a38, v170
  v_cvt_pk_bf16_f32 v171, v118, v119
  v_accvgpr_write_b32 a39, v171
  v_cvt_pk_bf16_f32 v172, v120, v121
  v_accvgpr_write_b32 a44, v172
  v_cvt_pk_bf16_f32 v173, v122, v123
  v_accvgpr_write_b32 a45, v173
  v_cvt_pk_bf16_f32 v174, v124, v125
  v_accvgpr_write_b32 a46, v174
  v_cvt_pk_bf16_f32 v175, v126, v127
  v_accvgpr_write_b32 a47, v175
  buffer_load_dwordx4 v13, s[8:11], s46 offen offset:1024 lds
  v_cvt_pk_bf16_f32 v160, v128, v129
  v_accvgpr_write_b32 a48, v160
  v_cvt_pk_bf16_f32 v161, v130, v131
  v_accvgpr_write_b32 a49, v161
  v_cvt_pk_bf16_f32 v162, v132, v133
  v_accvgpr_write_b32 a50, v162
  v_cvt_pk_bf16_f32 v163, v134, v135
  v_accvgpr_write_b32 a51, v163
  v_cvt_pk_bf16_f32 v164, v136, v137
  v_accvgpr_write_b32 a56, v164
  v_cvt_pk_bf16_f32 v165, v138, v139
  v_accvgpr_write_b32 a57, v165
  v_cvt_pk_bf16_f32 v166, v140, v141
  v_accvgpr_write_b32 a58, v166
  v_cvt_pk_bf16_f32 v167, v142, v143
  v_accvgpr_write_b32 a59, v167
  buffer_load_dwordx4 v14, s[8:11], s46 offen offset:2048 lds
  v_cvt_pk_bf16_f32 v168, v144, v145
  v_accvgpr_write_b32 a52, v168
  v_cvt_pk_bf16_f32 v169, v146, v147
  v_accvgpr_write_b32 a53, v169
  v_cvt_pk_bf16_f32 v170, v148, v149
  v_accvgpr_write_b32 a54, v170
  v_cvt_pk_bf16_f32 v171, v150, v151
  v_accvgpr_write_b32 a55, v171
  v_cvt_pk_bf16_f32 v172, v152, v153
  v_accvgpr_write_b32 a60, v172
  v_cvt_pk_bf16_f32 v173, v154, v155
  v_accvgpr_write_b32 a61, v173
  v_cvt_pk_bf16_f32 v174, v156, v157
  v_accvgpr_write_b32 a62, v174
  v_cvt_pk_bf16_f32 v175, v158, v159
  v_accvgpr_write_b32 a63, v175
  buffer_load_dwordx4 v15, s[8:11], s46 offen offset:3072 lds
  s_waitcnt lgkmcnt(0)
  v_mfma_f32_32x32x16_bf16 v[32:47], a[64:67], a[0:3], 0
  ds_read_b128 a[96:99], v16 offset:8192
  v_mfma_f32_32x32x16_bf16 v[32:47], a[68:71], a[8:11], v[32:47]
  ds_read_b128 a[100:103], v17 offset:8192
  ds_read_b128 a[104:107], v18 offset:8192
  v_mfma_f32_32x32x16_bf16 v[32:47], a[72:75], a[16:19], v[32:47]
  ds_read_b128 a[108:111], v19 offset:8192
  v_mfma_f32_32x32x16_bf16 v[32:47], a[76:79], a[24:27], v[32:47]
  v_mfma_f32_32x32x16_bf16 v[32:47], a[80:83], a[32:35], v[32:47]
  s_add_u32 m0, s48, 98304
  s_mov_b32 s46, 65536
  buffer_load_dwordx4 v12, s[8:11], s46 offen offset:0 lds
  v_mfma_f32_32x32x16_bf16 v[32:47], a[84:87], a[40:43], v[32:47]
  buffer_load_dwordx4 v13, s[8:11], s46 offen offset:1024 lds
  v_mfma_f32_32x32x16_bf16 v[32:47], a[88:91], a[48:51], v[32:47]
  buffer_load_dwordx4 v14, s[8:11], s46 offen offset:2048 lds
  v_mfma_f32_32x32x16_bf16 v[32:47], a[92:95], a[56:59], v[32:47]
  buffer_load_dwordx4 v15, s[8:11], s46 offen offset:3072 lds
  v_mfma_f32_32x32x16_bf16 v[48:63], a[64:67], a[4:7], 0
  ds_read_b128 a[112:115], v20 offset:8192
  v_mfma_f32_32x32x16_bf16 v[48:63], a[68:71], a[12:15], v[48:63]
  ds_read_b128 a[116:119], v21 offset:8192
  ds_read_b128 a[120:123], v22 offset:8192
  v_mfma_f32_32x32x16_bf16 v[48:63], a[72:75], a[20:23], v[48:63]
  ds_read_b128 a[124:127], v23 offset:8192
  v_mfma_f32_32x32x16_bf16 v[48:63], a[76:79], a[28:31], v[48:63]
  v_mfma_f32_32x32x16_bf16 v[48:63], a[80:83], a[36:39], v[48:63]
  s_add_u32 m0, s48, 114688
  s_mov_b32 s46, 81920
  buffer_load_dwordx4 v12, s[8:11], s46 offen offset:0 lds
  v_mfma_f32_32x32x16_bf16 v[48:63], a[84:87], a[44:47], v[48:63]
  buffer_load_dwordx4 v13, s[8:11], s46 offen offset:1024 lds
  v_mfma_f32_32x32x16_bf16 v[48:63], a[88:91], a[52:55], v[48:63]
  buffer_load_dwordx4 v14, s[8:11], s46 offen offset:2048 lds
  v_mfma_f32_32x32x16_bf16 v[48:63], a[92:95], a[60:63], v[48:63]
  buffer_load_dwordx4 v15, s[8:11], s46 offen offset:3072 lds
  s_waitcnt lgkmcnt(0)
  v_mfma_f32_32x32x16_bf16 v[64:79], a[96:99], a[0:3], 0
  v_cvt_pk_f16_f32 v96, v32, v33
  v_cvt_pk_f16_f32 v97, v34, v35
  v_cvt_pk_f16_f32 v98, v36, v37
  v_mfma_f32_32x32x16_bf16 v[64:79], a[100:103], a[8:11], v[64:79]
  v_cvt_pk_f16_f32 v99, v38, v39
  v_pk_maximum3_f16 v26, v26, v96, v97
  v_cvt_pk_f16_f32 v100, v40, v41
  v_mfma_f32_32x32x16_bf16 v[64:79], a[104:107], a[16:19], v[64:79]
  v_cvt_pk_f16_f32 v101, v42, v43
  v_pk_maximum3_f16 v26, v26, v98, v99
  v_mfma_f32_32x32x16_bf16 v[64:79], a[108:111], a[24:27], v[64:79]
  v_cvt_pk_f16_f32 v102, v44, v45
  v_cvt_pk_f16_f32 v103, v46, v47
  v_pk_maximum3_f16 v26, v26, v100, v101
  v_mfma_f32_32x32x16_bf16 v[64:79], a[112:115], a[32:35], v[64:79]
  v_pk_maximum3_f16 v26, v26, v102, v103
  ds_read_b128 a[64:67], v16 offset:16384
  ds_read_b128 a[68:71], v17 offset:16384
  v_mfma_f32_32x32x16_bf16 v[64:79], a[116:119], a[40:43], v[64:79]
  ds_read_b128 a[72:75], v18 offset:16384
  ds_read_b128 a[76:79], v19 offset:16384
  v_mfma_f32_32x32x16_bf16 v[64:79], a[120:123], a[48:51], v[64:79]
  s_add_u32 m0, s48, 0
  s_mov_b32 s46, 98304
  buffer_load_dwordx4 v12, s[8:11], s46 offen offset:0 lds
  v_mfma_f32_32x32x16_bf16 v[64:79], a[124:127], a[56:59], v[64:79]
  buffer_load_dwordx4 v13, s[8:11], s46 offen offset:1024 lds
  buffer_load_dwordx4 v14, s[8:11], s46 offen offset:2048 lds
  buffer_load_dwordx4 v15, s[8:11], s46 offen offset:3072 lds
  v_mfma_f32_32x32x16_bf16 v[32:47], a[96:99], a[4:7], 0
  v_cvt_pk_f16_f32 v104, v48, v49
  v_cvt_pk_f16_f32 v105, v50, v51
  v_cvt_pk_f16_f32 v106, v52, v53
  v_mfma_f32_32x32x16_bf16 v[32:47], a[100:103], a[12:15], v[32:47]
  v_cvt_pk_f16_f32 v107, v54, v55
  v_pk_maximum3_f16 v27, v27, v104, v105
  v_cvt_pk_f16_f32 v108, v56, v57
  v_mfma_f32_32x32x16_bf16 v[32:47], a[104:107], a[20:23], v[32:47]
  v_cvt_pk_f16_f32 v109, v58, v59
  v_pk_maximum3_f16 v27, v27, v106, v107
  v_mfma_f32_32x32x16_bf16 v[32:47], a[108:111], a[28:31], v[32:47]
  v_cvt_pk_f16_f32 v110, v60, v61
  v_cvt_pk_f16_f32 v111, v62, v63
  v_pk_maximum3_f16 v27, v27, v108, v109
  v_mfma_f32_32x32x16_bf16 v[32:47], a[112:115], a[36:39], v[32:47]
  v_pk_maximum3_f16 v27, v27, v110, v111
  ds_read_b128 a[80:83], v20 offset:16384
  ds_read_b128 a[84:87], v21 offset:16384
  v_mfma_f32_32x32x16_bf16 v[32:47], a[116:119], a[44:47], v[32:47]
  ds_read_b128 a[88:91], v22 offset:16384
  ds_read_b128 a[92:95], v23 offset:16384
  v_mfma_f32_32x32x16_bf16 v[32:47], a[120:123], a[52:55], v[32:47]
  s_add_u32 m0, s48, 16384
  s_mov_b32 s46, 114688
  buffer_load_dwordx4 v12, s[8:11], s46 offen offset:0 lds
  v_mfma_f32_32x32x16_bf16 v[32:47], a[124:127], a[60:63], v[32:47]
  buffer_load_dwordx4 v13, s[8:11], s46 offen offset:1024 lds
  buffer_load_dwordx4 v14, s[8:11], s46 offen offset:2048 lds
  buffer_load_dwordx4 v15, s[8:11], s46 offen offset:3072 lds
  s_waitcnt lgkmcnt(0)
  v_mfma_f32_32x32x16_bf16 v[48:63], a[64:67], a[0:3], 0
  v_cvt_pk_f16_f32 v112, v64, v65
  v_cvt_pk_f16_f32 v113, v66, v67
  v_cvt_pk_f16_f32 v114, v68, v69
  v_mfma_f32_32x32x16_bf16 v[48:63], a[68:71], a[8:11], v[48:63]
  v_cvt_pk_f16_f32 v115, v70, v71
  v_pk_maximum3_f16 v26, v26, v112, v113
  v_cvt_pk_f16_f32 v116, v72, v73
  v_mfma_f32_32x32x16_bf16 v[48:63], a[72:75], a[16:19], v[48:63]
  v_cvt_pk_f16_f32 v117, v74, v75
  v_pk_maximum3_f16 v26, v26, v114, v115
  v_mfma_f32_32x32x16_bf16 v[48:63], a[76:79], a[24:27], v[48:63]
  v_cvt_pk_f16_f32 v118, v76, v77
  v_cvt_pk_f16_f32 v119, v78, v79
  v_pk_maximum3_f16 v26, v26, v116, v117
  v_mfma_f32_32x32x16_bf16 v[48:63], a[80:83], a[32:35], v[48:63]
  v_pk_maximum3_f16 v26, v26, v118, v119
  ds_read_b128 a[96:99], v16 offset:24576
  ds_read_b128 a[100:103], v17 offset:24576
  v_mfma_f32_32x32x16_bf16 v[48:63], a[84:87], a[40:43], v[48:63]
  ds_read_b128 a[104:107], v18 offset:24576
  ds_read_b128 a[108:111], v19 offset:24576
  v_mfma_f32_32x32x16_bf16 v[48:63], a[88:91], a[48:51], v[48:63]
  s_add_u32 m0, s48, 32768
  s_mov_b32 s46, 0
  buffer_load_dwordx4 v24, s[12:15], s46 offen offset:0 sc1 lds
  v_mfma_f32_32x32x16_bf16 v[48:63], a[92:95], a[56:59], v[48:63]
  buffer_load_dwordx4 v24, s[12:15], s46 offen offset:1024 sc1 lds
  buffer_load_dwordx4 v24, s[12:15], s46 offen offset:2048 sc1 lds
  buffer_load_dwordx4 v24, s[12:15], s46 offen offset:3072 sc1 lds
  v_mfma_f32_32x32x16_bf16 v[64:79], a[64:67], a[4:7], 0
  v_cvt_pk_f16_f32 v120, v32, v33
  v_cvt_pk_f16_f32 v121, v34, v35
  v_cvt_pk_f16_f32 v122, v36, v37
  v_mfma_f32_32x32x16_bf16 v[64:79], a[68:71], a[12:15], v[64:79]
  v_cvt_pk_f16_f32 v123, v38, v39
  v_pk_maximum3_f16 v27, v27, v120, v121
  v_cvt_pk_f16_f32 v124, v40, v41
  v_mfma_f32_32x32x16_bf16 v[64:79], a[72:75], a[20:23], v[64:79]
  v_cvt_pk_f16_f32 v125, v42, v43
  v_pk_maximum3_f16 v27, v27, v122, v123
  v_mfma_f32_32x32x16_bf16 v[64:79], a[76:79], a[28:31], v[64:79]
  v_cvt_pk_f16_f32 v126, v44, v45
  v_cvt_pk_f16_f32 v127, v46, v47
  v_pk_maximum3_f16 v27, v27, v124, v125
  v_mfma_f32_32x32x16_bf16 v[64:79], a[80:83], a[36:39], v[64:79]
  v_pk_maximum3_f16 v27, v27, v126, v127
  ds_read_b128 a[112:115], v20 offset:24576
  ds_read_b128 a[116:119], v21 offset:24576
  v_mfma_f32_32x32x16_bf16 v[64:79], a[84:87], a[44:47], v[64:79]
  ds_read_b128 a[120:123], v22 offset:24576
  ds_read_b128 a[124:127], v23 offset:24576
  v_mfma_f32_32x32x16_bf16 v[64:79], a[88:91], a[52:55], v[64:79]
  s_add_u32 m0, s48, 49152
  s_mov_b32 s46, 16384
  buffer_load_dwordx4 v24, s[12:15], s46 offen offset:0 sc1 lds
  v_mfma_f32_32x32x16_bf16 v[64:79], a[92:95], a[60:63], v[64:79]
  buffer_load_dwordx4 v24, s[12:15], s46 offen offset:1024 sc1 lds
  buffer_load_dwordx4 v24, s[12:15], s46 offen offset:2048 sc1 lds
  buffer_load_dwordx4 v24, s[12:15], s46 offen offset:3072 sc1 lds
  s_waitcnt lgkmcnt(0)
  v_mfma_f32_32x32x16_bf16 v[32:47], a[96:99], a[0:3], 0
  s_waitcnt vmcnt(28)
  s_barrier
  v_cvt_pk_f16_f32 v128, v48, v49
  v_cvt_pk_f16_f32 v129, v50, v51
  v_cvt_pk_f16_f32 v130, v52, v53
  v_mfma_f32_32x32x16_bf16 v[32:47], a[100:103], a[8:11], v[32:47]
  v_cvt_pk_f16_f32 v131, v54, v55
  v_pk_maximum3_f16 v26, v26, v128, v129
  v_cvt_pk_f16_f32 v132, v56, v57
  v_cvt_pk_f16_f32 v133, v58, v59
  v_pk_maximum3_f16 v26, v26, v130, v131
  v_cvt_pk_f16_f32 v134, v60, v61
  v_mfma_f32_32x32x16_bf16 v[32:47], a[104:107], a[16:19], v[32:47]
  v_cvt_pk_f16_f32 v135, v62, v63
  v_pk_maximum3_f16 v26, v26, v132, v133
  v_pk_maximum3_f16 v26, v26, v134, v135
  v_add_u32 v16, 0xffff0000, v16
  ds_read_b128 a[64:67], v16 offset:0
  v_mfma_f32_32x32x16_bf16 v[32:47], a[108:111], a[24:27], v[32:47]
  v_add_u32 v17, 0xffff0000, v17
  ds_read_b128 a[68:71], v17 offset:0
  v_add_u32 v18, 0xffff0000, v18
  ds_read_b128 a[72:75], v18 offset:0
  v_add_u32 v19, 0xffff0000, v19
  ds_read_b128 a[76:79], v19 offset:0
  v_mfma_f32_32x32x16_bf16 v[32:47], a[112:115], a[32:35], v[32:47]
  s_add_u32 m0, s48, 131072
  s_mov_b32 s46, 32768
  buffer_load_dwordx4 v24, s[12:15], s46 offen offset:0 sc1 lds
  buffer_load_dwordx4 v24, s[12:15], s46 offen offset:1024 sc1 lds
  v_mfma_f32_32x32x16_bf16 v[32:47], a[116:119], a[40:43], v[32:47]
  buffer_load_dwordx4 v24, s[12:15], s46 offen offset:2048 sc1 lds
  buffer_load_dwordx4 v24, s[12:15], s46 offen offset:3072 sc1 lds
  s_lshl_b32 s45, s33, 19
  s_lshl_b32 s47, s32, 8
  s_add_u32 s45, s45, s47
  v_mfma_f32_32x32x16_bf16 v[32:47], a[120:123], a[48:51], v[32:47]
  s_add_u32 s4, s50, s45
  s_addc_u32 s5, s51, 0
  s_mov_b32 s6, 523520
  s_mov_b32 s44, 0
  s_mov_b32 s49, 16384
  v_lshrrev_b32 v3, 4, v1
  v_mfma_f32_32x32x16_bf16 v[32:47], a[124:127], a[56:59], v[32:47]
  v_mul_u32_u24 v3, 7168, v3
  v_sub_u32 v2, v2, v3
  v_add_u32 v3, 3072, v2
  v_add_u32 v4, 6144, v2
  v_add_u32 v5, 9216, v2
  v_mfma_f32_32x32x16_bf16 v[48:63], a[96:99], a[4:7], 0
  v_cvt_pk_f16_f32 v136, v64, v65
  v_cvt_pk_f16_f32 v137, v66, v67
  v_cvt_pk_f16_f32 v138, v68, v69
  v_mfma_f32_32x32x16_bf16 v[48:63], a[100:103], a[12:15], v[48:63]
  v_cvt_pk_f16_f32 v139, v70, v71
  v_pk_maximum3_f16 v27, v27, v136, v137
  v_mfma_f32_32x32x16_bf16 v[48:63], a[104:107], a[20:23], v[48:63]
  v_cvt_pk_f16_f32 v140, v72, v73
  v_cvt_pk_f16_f32 v141, v74, v75
  v_pk_maximum3_f16 v27, v27, v138, v139
  v_mfma_f32_32x32x16_bf16 v[48:63], a[108:111], a[28:31], v[48:63]
  v_cvt_pk_f16_f32 v142, v76, v77
  v_cvt_pk_f16_f32 v143, v78, v79
  v_mfma_f32_32x32x16_bf16 v[48:63], a[112:115], a[36:39], v[48:63]
  v_pk_maximum3_f16 v27, v27, v140, v141
  v_pk_maximum3_f16 v27, v27, v142, v143
  v_mfma_f32_32x32x16_bf16 v[48:63], a[116:119], a[44:47], v[48:63]
  v_add_u32 v20, 0xffff0000, v20
  ds_read_b128 a[80:83], v20 offset:0
  v_add_u32 v21, 0xffff0000, v21
  ds_read_b128 a[84:87], v21 offset:0
  v_mfma_f32_32x32x16_bf16 v[48:63], a[120:123], a[52:55], v[48:63]
  v_add_u32 v22, 0xffff0000, v22
  ds_read_b128 a[88:91], v22 offset:0
  v_mfma_f32_32x32x16_bf16 v[48:63], a[124:127], a[60:63], v[48:63]
  v_add_u32 v23, 0xffff0000, v23
  ds_read_b128 a[92:95], v23 offset:0
  s_waitcnt lgkmcnt(0)
  v_mfma_f32_32x32x16_bf16 v[64:79], a[64:67], a[0:3], 0
  v_cvt_pk_f16_f32 v144, v32, v33
  v_cvt_pk_f16_f32 v145, v34, v35
  v_cvt_pk_f16_f32 v146, v36, v37
  v_mfma_f32_32x32x16_bf16 v[64:79], a[68:71], a[8:11], v[64:79]
  v_cvt_pk_f16_f32 v147, v38, v39
  v_pk_maximum3_f16 v26, v26, v144, v145
  v_mfma_f32_32x32x16_bf16 v[64:79], a[72:75], a[16:19], v[64:79]
  v_cvt_pk_f16_f32 v148, v40, v41
  v_cvt_pk_f16_f32 v149, v42, v43
  v_pk_maximum3_f16 v26, v26, v146, v147
  v_mfma_f32_32x32x16_bf16 v[64:79], a[76:79], a[24:27], v[64:79]
  v_cvt_pk_f16_f32 v150, v44, v45
  v_cvt_pk_f16_f32 v151, v46, v47
  v_mfma_f32_32x32x16_bf16 v[64:79], a[80:83], a[32:35], v[64:79]
  v_pk_maximum3_f16 v26, v26, v148, v149
  v_pk_maximum3_f16 v26, v26, v150, v151
  ds_read_b128 a[96:99], v16 offset:8192
  v_mfma_f32_32x32x16_bf16 v[64:79], a[84:87], a[40:43], v[64:79]
  ds_read_b128 a[100:103], v17 offset:8192
  ds_read_b128 a[104:107], v18 offset:8192
  v_mfma_f32_32x32x16_bf16 v[64:79], a[88:91], a[48:51], v[64:79]
  ds_read_b128 a[108:111], v19 offset:8192
  v_mfma_f32_32x32x16_bf16 v[64:79], a[92:95], a[56:59], v[64:79]
  s_lshl_b32 s47, s40, 1
  s_add_u32 s47, s47, 0
  s_mul_i32 s47, s47, s49
  buffer_load_dwordx4 a[236:239], v2, s[4:7], s47 offen offset:0
  v_mfma_f32_32x32x16_bf16 v[32:47], a[64:67], a[4:7], 0
  v_cvt_pk_f16_f32 v152, v48, v49
  v_cvt_pk_f16_f32 v153, v50, v51
  v_mfma_f32_32x32x16_bf16 v[32:47], a[68:71], a[12:15], v[32:47]
  v_cvt_pk_f16_f32 v154, v52, v53
  v_cvt_pk_f16_f32 v155, v54, v55
  v_mfma_f32_32x32x16_bf16 v[32:47], a[72:75], a[20:23], v[32:47]
  v_pk_maximum3_f16 v27, v27, v152, v153
  v_cvt_pk_f16_f32 v156, v56, v57
  v_mfma_f32_32x32x16_bf16 v[32:47], a[76:79], a[28:31], v[32:47]
  v_cvt_pk_f16_f32 v157, v58, v59
  v_pk_maximum3_f16 v27, v27, v154, v155
  v_mfma_f32_32x32x16_bf16 v[32:47], a[80:83], a[36:39], v[32:47]
  v_cvt_pk_f16_f32 v158, v60, v61
  v_cvt_pk_f16_f32 v159, v62, v63
  v_mfma_f32_32x32x16_bf16 v[32:47], a[84:87], a[44:47], v[32:47]
  v_pk_maximum3_f16 v27, v27, v156, v157
  v_pk_maximum3_f16 v27, v27, v158, v159
  v_mfma_f32_32x32x16_bf16 v[32:47], a[88:91], a[52:55], v[32:47]
  ds_read_b128 a[112:115], v20 offset:8192
  ds_read_b128 a[116:119], v21 offset:8192
  v_mfma_f32_32x32x16_bf16 v[32:47], a[92:95], a[60:63], v[32:47]
  ds_read_b128 a[120:123], v22 offset:8192
  ds_read_b128 a[124:127], v23 offset:8192
  s_waitcnt lgkmcnt(0)
  v_mfma_f32_32x32x16_bf16 v[48:63], a[96:99], a[0:3], 0
  s_waitcnt vmcnt(29)
  s_barrier
  v_cvt_pk_f16_f32 v160, v64, v65
  v_mfma_f32_32x32x16_bf16 v[48:63], a[100:103], a[8:11], v[48:63]
  v_cvt_pk_f16_f32 v161, v66, v67
  v_cvt_pk_f16_f32 v162, v68, v69
  v_cvt_pk_f16_f32 v163, v70, v71
  v_mfma_f32_32x32x16_bf16 v[48:63], a[104:107], a[16:19], v[48:63]
  v_pk_maximum3_f16 v26, v26, v160, v161
  v_cvt_pk_f16_f32 v164, v72, v73
  v_cvt_pk_f16_f32 v165, v74, v75
  v_mfma_f32_32x32x16_bf16 v[48:63], a[108:111], a[24:27], v[48:63]
  v_pk_maximum3_f16 v26, v26, v162, v163
  v_cvt_pk_f16_f32 v166, v76, v77
  v_cvt_pk_f16_f32 v167, v78, v79
  v_pk_maximum3_f16 v26, v26, v164, v165
  v_mfma_f32_32x32x16_bf16 v[48:63], a[112:115], a[32:35], v[48:63]
  v_pk_maximum3_f16 v26, v26, v166, v167
  ds_read_b128 a[64:67], v16 offset:16384
  ds_read_b128 a[68:71], v17 offset:16384
  v_mfma_f32_32x32x16_bf16 v[48:63], a[116:119], a[40:43], v[48:63]
  ds_read_b128 a[72:75], v18 offset:16384
  ds_read_b128 a[76:79], v19 offset:16384
  v_mfma_f32_32x32x16_bf16 v[48:63], a[120:123], a[48:51], v[48:63]
  s_add_u32 m0, s48, 147456
  s_mov_b32 s46, 49152
  buffer_load_dwordx4 v24, s[12:15], s46 offen offset:0 sc1 lds
  buffer_load_dwordx4 v24, s[12:15], s46 offen offset:1024 sc1 lds
  v_mfma_f32_32x32x16_bf16 v[48:63], a[124:127], a[56:59], v[48:63]
  buffer_load_dwordx4 v24, s[12:15], s46 offen offset:2048 sc1 lds
  buffer_load_dwordx4 v24, s[12:15], s46 offen offset:3072 sc1 lds
  buffer_load_dwordx4 a[236:239], v3, s[4:7], s47 offen offset:1024
  v_mfma_f32_32x32x16_bf16 v[64:79], a[96:99], a[4:7], 0
  v_cvt_pk_f16_f32 v168, v32, v33
  v_cvt_pk_f16_f32 v169, v34, v35
  v_mfma_f32_32x32x16_bf16 v[64:79], a[100:103], a[12:15], v[64:79]
  v_cvt_pk_f16_f32 v170, v36, v37
  v_cvt_pk_f16_f32 v171, v38, v39
  v_mfma_f32_32x32x16_bf16 v[64:79], a[104:107], a[20:23], v[64:79]
  v_pk_maximum3_f16 v27, v27, v168, v169
  v_cvt_pk_f16_f32 v172, v40, v41
  v_mfma_f32_32x32x16_bf16 v[64:79], a[108:111], a[28:31], v[64:79]
  v_cvt_pk_f16_f32 v173, v42, v43
  v_pk_maximum3_f16 v27, v27, v170, v171
  v_mfma_f32_32x32x16_bf16 v[64:79], a[112:115], a[36:39], v[64:79]
  v_cvt_pk_f16_f32 v174, v44, v45
  v_cvt_pk_f16_f32 v175, v46, v47
  v_mfma_f32_32x32x16_bf16 v[64:79], a[116:119], a[44:47], v[64:79]
  v_pk_maximum3_f16 v27, v27, v172, v173
  v_pk_maximum3_f16 v27, v27, v174, v175
  v_mfma_f32_32x32x16_bf16 v[64:79], a[120:123], a[52:55], v[64:79]
  ds_read_b128 a[80:83], v20 offset:16384
  ds_read_b128 a[84:87], v21 offset:16384
  v_mfma_f32_32x32x16_bf16 v[64:79], a[124:127], a[60:63], v[64:79]
  ds_read_b128 a[88:91], v22 offset:16384
  ds_read_b128 a[92:95], v23 offset:16384
  s_waitcnt lgkmcnt(0)
  v_mfma_f32_32x32x16_bf16 v[32:47], a[64:67], a[0:3], 0
  v_cvt_pk_f16_f32 v176, v48, v49
  v_cvt_pk_f16_f32 v177, v50, v51
  v_mfma_f32_32x32x16_bf16 v[32:47], a[68:71], a[8:11], v[32:47]
  v_cvt_pk_f16_f32 v178, v52, v53
  v_cvt_pk_f16_f32 v179, v54, v55
  v_mfma_f32_32x32x16_bf16 v[32:47], a[72:75], a[16:19], v[32:47]
  v_pk_maximum3_f16 v26, v26, v176, v177
  v_cvt_pk_f16_f32 v180, v56, v57
  v_mfma_f32_32x32x16_bf16 v[32:47], a[76:79], a[24:27], v[32:47]
  v_cvt_pk_f16_f32 v181, v58, v59
  v_pk_maximum3_f16 v26, v26, v178, v179
  v_cvt_pk_f16_f32 v182, v60, v61
  v_mfma_f32_32x32x16_bf16 v[32:47], a[80:83], a[32:35], v[32:47]
  v_cvt_pk_f16_f32 v183, v62, v63
  v_pk_maximum3_f16 v26, v26, v180, v181
  v_mfma_f32_32x32x16_bf16 v[32:47], a[84:87], a[40:43], v[32:47]
  v_pk_maximum3_f16 v26, v26, v182, v183
  ds_read_b128 a[96:99], v16 offset:24576
  v_mfma_f32_32x32x16_bf16 v[32:47], a[88:91], a[48:51], v[32:47]
  ds_read_b128 a[100:103], v17 offset:24576
  ds_read_b128 a[104:107], v18 offset:24576
  v_mfma_f32_32x32x16_bf16 v[32:47], a[92:95], a[56:59], v[32:47]
  ds_read_b128 a[108:111], v19 offset:24576
  buffer_load_dwordx4 a[236:239], v4, s[4:7], s47 offen offset:2048
  v_mfma_f32_32x32x16_bf16 v[48:63], a[64:67], a[4:7], 0
  v_cvt_pk_f16_f32 v184, v64, v65
  v_cvt_pk_f16_f32 v185, v66, v67
  v_mfma_f32_32x32x16_bf16 v[48:63], a[68:71], a[12:15], v[48:63]
  v_cvt_pk_f16_f32 v186, v68, v69
  v_cvt_pk_f16_f32 v187, v70, v71
  v_mfma_f32_32x32x16_bf16 v[48:63], a[72:75], a[20:23], v[48:63]
  v_pk_maximum3_f16 v27, v27, v184, v185
  v_cvt_pk_f16_f32 v188, v72, v73
  v_mfma_f32_32x32x16_bf16 v[48:63], a[76:79], a[28:31], v[48:63]
  v_cvt_pk_f16_f32 v189, v74, v75
  v_pk_maximum3_f16 v27, v27, v186, v187
  v_mfma_f32_32x32x16_bf16 v[48:63], a[80:83], a[36:39], v[48:63]
  v_cvt_pk_f16_f32 v190, v76, v77
  v_cvt_pk_f16_f32 v191, v78, v79
  v_mfma_f32_32x32x16_bf16 v[48:63], a[84:87], a[44:47], v[48:63]
  v_pk_maximum3_f16 v27, v27, v188, v189
  v_pk_maximum3_f16 v27, v27, v190, v191
  v_mfma_f32_32x32x16_bf16 v[48:63], a[88:91], a[52:55], v[48:63]
  ds_read_b128 a[112:115], v20 offset:24576
  ds_read_b128 a[116:119], v21 offset:24576
  v_mfma_f32_32x32x16_bf16 v[48:63], a[92:95], a[60:63], v[48:63]
  ds_read_b128 a[120:123], v22 offset:24576
  ds_read_b128 a[124:127], v23 offset:24576
  s_waitcnt lgkmcnt(0)
  v_mfma_f32_32x32x16_bf16 v[64:79], a[96:99], a[0:3], 0
  s_waitcnt vmcnt(31)
  s_barrier
  v_cvt_pk_f16_f32 v192, v32, v33
  v_mfma_f32_32x32x16_bf16 v[64:79], a[100:103], a[8:11], v[64:79]
  v_cvt_pk_f16_f32 v193, v34, v35
  v_cvt_pk_f16_f32 v194, v36, v37
  v_cvt_pk_f16_f32 v195, v38, v39
  v_mfma_f32_32x32x16_bf16 v[64:79], a[104:107], a[16:19], v[64:79]
  v_pk_maximum3_f16 v26, v26, v192, v193
  v_cvt_pk_f16_f32 v196, v40, v41
  v_cvt_pk_f16_f32 v197, v42, v43
  v_mfma_f32_32x32x16_bf16 v[64:79], a[108:111], a[24:27], v[64:79]
  v_pk_maximum3_f16 v26, v26, v194, v195
  v_cvt_pk_f16_f32 v198, v44, v45
  v_cvt_pk_f16_f32 v199, v46, v47
  v_pk_maximum3_f16 v26, v26, v196, v197
  v_mfma_f32_32x32x16_bf16 v[64:79], a[112:115], a[32:35], v[64:79]
  v_pk_maximum3_f16 v26, v26, v198, v199
  ds_read_b128 a[64:67], v16 offset:32768
  ds_read_b128 a[68:71], v17 offset:32768
  v_mfma_f32_32x32x16_bf16 v[64:79], a[116:119], a[40:43], v[64:79]
  ds_read_b128 a[72:75], v18 offset:32768
  ds_read_b128 a[76:79], v19 offset:32768
  v_mfma_f32_32x32x16_bf16 v[64:79], a[120:123], a[48:51], v[64:79]
  s_add_u32 m0, s48, 65536
  s_mov_b32 s46, 65536
  buffer_load_dwordx4 v24, s[12:15], s46 offen offset:0 sc1 lds
  buffer_load_dwordx4 v24, s[12:15], s46 offen offset:1024 sc1 lds
  v_mfma_f32_32x32x16_bf16 v[64:79], a[124:127], a[56:59], v[64:79]
  buffer_load_dwordx4 v24, s[12:15], s46 offen offset:2048 sc1 lds
  buffer_load_dwordx4 v24, s[12:15], s46 offen offset:3072 sc1 lds
  buffer_load_dwordx4 a[236:239], v5, s[4:7], s47 offen offset:3072
  v_mfma_f32_32x32x16_bf16 v[32:47], a[96:99], a[4:7], 0
  v_cvt_pk_f16_f32 v200, v48, v49
  v_cvt_pk_f16_f32 v201, v50, v51
  v_mfma_f32_32x32x16_bf16 v[32:47], a[100:103], a[12:15], v[32:47]
  v_cvt_pk_f16_f32 v202, v52, v53
  v_cvt_pk_f16_f32 v203, v54, v55
  v_mfma_f32_32x32x16_bf16 v[32:47], a[104:107], a[20:23], v[32:47]
  v_pk_maximum3_f16 v27, v27, v200, v201
  v_cvt_pk_f16_f32 v204, v56, v57
  v_mfma_f32_32x32x16_bf16 v[32:47], a[108:111], a[28:31], v[32:47]
  v_cvt_pk_f16_f32 v205, v58, v59
  v_pk_maximum3_f16 v27, v27, v202, v203
  v_mfma_f32_32x32x16_bf16 v[32:47], a[112:115], a[36:39], v[32:47]
  v_cvt_pk_f16_f32 v206, v60, v61
  v_cvt_pk_f16_f32 v207, v62, v63
  v_mfma_f32_32x32x16_bf16 v[32:47], a[116:119], a[44:47], v[32:47]
  v_pk_maximum3_f16 v27, v27, v204, v205
  v_pk_maximum3_f16 v27, v27, v206, v207
  v_mfma_f32_32x32x16_bf16 v[32:47], a[120:123], a[52:55], v[32:47]
  ds_read_b128 a[80:83], v20 offset:32768
  ds_read_b128 a[84:87], v21 offset:32768
  v_mfma_f32_32x32x16_bf16 v[32:47], a[124:127], a[60:63], v[32:47]
  ds_read_b128 a[88:91], v22 offset:32768
  ds_read_b128 a[92:95], v23 offset:32768
  s_waitcnt lgkmcnt(0)
  v_mfma_f32_32x32x16_bf16 v[48:63], a[64:67], a[0:3], 0
  v_cvt_pk_f16_f32 v208, v64, v65
  v_cvt_pk_f16_f32 v209, v66, v67
  v_cvt_pk_f16_f32 v210, v68, v69
  v_mfma_f32_32x32x16_bf16 v[48:63], a[68:71], a[8:11], v[48:63]
  v_cvt_pk_f16_f32 v211, v70, v71
  v_pk_maximum3_f16 v26, v26, v208, v209
  v_mfma_f32_32x32x16_bf16 v[48:63], a[72:75], a[16:19], v[48:63]
  v_cvt_pk_f16_f32 v212, v72, v73
  v_cvt_pk_f16_f32 v213, v74, v75
  v_pk_maximum3_f16 v26, v26, v210, v211
  v_mfma_f32_32x32x16_bf16 v[48:63], a[76:79], a[24:27], v[48:63]
  v_cvt_pk_f16_f32 v214, v76, v77
  v_cvt_pk_f16_f32 v215, v78, v79
  v_mfma_f32_32x32x16_bf16 v[48:63], a[80:83], a[32:35], v[48:63]
  v_pk_maximum3_f16 v26, v26, v212, v213
  v_pk_maximum3_f16 v26, v26, v214, v215
  ds_read_b128 a[96:99], v16 offset:40960
  v_mfma_f32_32x32x16_bf16 v[48:63], a[84:87], a[40:43], v[48:63]
  ds_read_b128 a[100:103], v17 offset:40960
  ds_read_b128 a[104:107], v18 offset:40960
  v_mfma_f32_32x32x16_bf16 v[48:63], a[88:91], a[48:51], v[48:63]
  ds_read_b128 a[108:111], v19 offset:40960
  v_mfma_f32_32x32x16_bf16 v[48:63], a[92:95], a[56:59], v[48:63]
  s_lshl_b32 s47, s40, 1
  s_add_u32 s47, s47, 1
  s_mul_i32 s47, s47, s49
  buffer_load_dwordx4 a[236:239], v2, s[4:7], s47 offen offset:0
  v_mfma_f32_32x32x16_bf16 v[64:79], a[64:67], a[4:7], 0
  v_cvt_pk_f16_f32 v216, v32, v33
  v_cvt_pk_f16_f32 v217, v34, v35
  v_mfma_f32_32x32x16_bf16 v[64:79], a[68:71], a[12:15], v[64:79]
  v_cvt_pk_f16_f32 v218, v36, v37
  v_cvt_pk_f16_f32 v219, v38, v39
  v_mfma_f32_32x32x16_bf16 v[64:79], a[72:75], a[20:23], v[64:79]
  v_pk_maximum3_f16 v27, v27, v216, v217
  v_cvt_pk_f16_f32 v220, v40, v41
  v_mfma_f32_32x32x16_bf16 v[64:79], a[76:79], a[28:31], v[64:79]
  v_cvt_pk_f16_f32 v221, v42, v43
  v_pk_maximum3_f16 v27, v27, v218, v219
  v_mfma_f32_32x32x16_bf16 v[64:79], a[80:83], a[36:39], v[64:79]
  v_cvt_pk_f16_f32 v222, v44, v45
  v_cvt_pk_f16_f32 v223, v46, v47
  v_mfma_f32_32x32x16_bf16 v[64:79], a[84:87], a[44:47], v[64:79]
  v_pk_maximum3_f16 v27, v27, v220, v221
  v_pk_maximum3_f16 v27, v27, v222, v223
  v_mfma_f32_32x32x16_bf16 v[64:79], a[88:91], a[52:55], v[64:79]
  ds_read_b128 a[112:115], v20 offset:40960
  ds_read_b128 a[116:119], v21 offset:40960
  v_mfma_f32_32x32x16_bf16 v[64:79], a[92:95], a[60:63], v[64:79]
  ds_read_b128 a[120:123], v22 offset:40960
  ds_read_b128 a[124:127], v23 offset:40960
  s_waitcnt lgkmcnt(0)
  v_mfma_f32_32x32x16_bf16 v[32:47], a[96:99], a[0:3], 0
  s_waitcnt vmcnt(33)
  s_barrier
  v_cvt_pk_f16_f32 v224, v48, v49
  v_mfma_f32_32x32x16_bf16 v[32:47], a[100:103], a[8:11], v[32:47]
  v_cvt_pk_f16_f32 v225, v50, v51
  v_cvt_pk_f16_f32 v226, v52, v53
  v_cvt_pk_f16_f32 v227, v54, v55
  v_mfma_f32_32x32x16_bf16 v[32:47], a[104:107], a[16:19], v[32:47]
  v_pk_maximum3_f16 v26, v26, v224, v225
  v_cvt_pk_f16_f32 v228, v56, v57
  v_cvt_pk_f16_f32 v229, v58, v59
  v_mfma_f32_32x32x16_bf16 v[32:47], a[108:111], a[24:27], v[32:47]
  v_pk_maximum3_f16 v26, v26, v226, v227
  v_cvt_pk_f16_f32 v230, v60, v61
  v_cvt_pk_f16_f32 v231, v62, v63
  v_pk_maximum3_f16 v26, v26, v228, v229
  v_mfma_f32_32x32x16_bf16 v[32:47], a[112:115], a[32:35], v[32:47]
  v_pk_maximum3_f16 v26, v26, v230, v231
  ds_read_b128 a[64:67], v16 offset:49152
  ds_read_b128 a[68:71], v17 offset:49152
  v_mfma_f32_32x32x16_bf16 v[32:47], a[116:119], a[40:43], v[32:47]
  ds_read_b128 a[72:75], v18 offset:49152
  ds_read_b128 a[76:79], v19 offset:49152
  v_mfma_f32_32x32x16_bf16 v[32:47], a[120:123], a[48:51], v[32:47]
  s_add_u32 m0, s48, 81920
  s_mov_b32 s46, 81920
  buffer_load_dwordx4 v24, s[12:15], s46 offen offset:0 sc1 lds
  buffer_load_dwordx4 v24, s[12:15], s46 offen offset:1024 sc1 lds
  v_mfma_f32_32x32x16_bf16 v[32:47], a[124:127], a[56:59], v[32:47]
  buffer_load_dwordx4 v24, s[12:15], s46 offen offset:2048 sc1 lds
  buffer_load_dwordx4 v24, s[12:15], s46 offen offset:3072 sc1 lds
  buffer_load_dwordx4 a[236:239], v3, s[4:7], s47 offen offset:1024
  v_mfma_f32_32x32x16_bf16 v[48:63], a[96:99], a[4:7], 0
  v_cvt_pk_f16_f32 v232, v64, v65
  v_cvt_pk_f16_f32 v233, v66, v67
  v_mfma_f32_32x32x16_bf16 v[48:63], a[100:103], a[12:15], v[48:63]
  v_cvt_pk_f16_f32 v234, v68, v69
  v_cvt_pk_f16_f32 v235, v70, v71
  v_mfma_f32_32x32x16_bf16 v[48:63], a[104:107], a[20:23], v[48:63]
  v_pk_maximum3_f16 v27, v27, v232, v233
  v_cvt_pk_f16_f32 v236, v72, v73
  v_mfma_f32_32x32x16_bf16 v[48:63], a[108:111], a[28:31], v[48:63]
  v_cvt_pk_f16_f32 v237, v74, v75
  v_pk_maximum3_f16 v27, v27, v234, v235
  v_mfma_f32_32x32x16_bf16 v[48:63], a[112:115], a[36:39], v[48:63]
  v_cvt_pk_f16_f32 v238, v76, v77
  v_cvt_pk_f16_f32 v239, v78, v79
  v_mfma_f32_32x32x16_bf16 v[48:63], a[116:119], a[44:47], v[48:63]
  v_pk_maximum3_f16 v27, v27, v236, v237
  v_pk_maximum3_f16 v27, v27, v238, v239
  v_mfma_f32_32x32x16_bf16 v[48:63], a[120:123], a[52:55], v[48:63]
  ds_read_b128 a[80:83], v20 offset:49152
  ds_read_b128 a[84:87], v21 offset:49152
  v_mfma_f32_32x32x16_bf16 v[48:63], a[124:127], a[60:63], v[48:63]
  ds_read_b128 a[88:91], v22 offset:49152
  ds_read_b128 a[92:95], v23 offset:49152
  s_waitcnt lgkmcnt(0)
  v_mfma_f32_32x32x16_bf16 v[64:79], a[64:67], a[0:3], 0
  v_cvt_pk_f16_f32 v240, v32, v33
  v_cvt_pk_f16_f32 v241, v34, v35
  v_mfma_f32_32x32x16_bf16 v[64:79], a[68:71], a[8:11], v[64:79]
  v_cvt_pk_f16_f32 v242, v36, v37
  v_cvt_pk_f16_f32 v243, v38, v39
  v_mfma_f32_32x32x16_bf16 v[64:79], a[72:75], a[16:19], v[64:79]
  v_pk_maximum3_f16 v26, v26, v240, v241
  v_cvt_pk_f16_f32 v244, v40, v41
  v_mfma_f32_32x32x16_bf16 v[64:79], a[76:79], a[24:27], v[64:79]
  v_cvt_pk_f16_f32 v245, v42, v43
  v_pk_maximum3_f16 v26, v26, v242, v243
  v_cvt_pk_f16_f32 v246, v44, v45
  v_mfma_f32_32x32x16_bf16 v[64:79], a[80:83], a[32:35], v[64:79]
  v_cvt_pk_f16_f32 v247, v46, v47
  v_pk_maximum3_f16 v26, v26, v244, v245
  v_mfma_f32_32x32x16_bf16 v[64:79], a[84:87], a[40:43], v[64:79]
  v_pk_maximum3_f16 v26, v26, v246, v247
  ds_read_b128 a[96:99], v16 offset:57344
  v_mfma_f32_32x32x16_bf16 v[64:79], a[88:91], a[48:51], v[64:79]
  ds_read_b128 a[100:103], v17 offset:57344
  ds_read_b128 a[104:107], v18 offset:57344
  v_mfma_f32_32x32x16_bf16 v[64:79], a[92:95], a[56:59], v[64:79]
  ds_read_b128 a[108:111], v19 offset:57344
  buffer_load_dwordx4 a[236:239], v4, s[4:7], s47 offen offset:2048
  v_mfma_f32_32x32x16_bf16 v[32:47], a[64:67], a[4:7], 0
  v_cvt_pk_f16_f32 v248, v48, v49
  v_cvt_pk_f16_f32 v249, v50, v51
  v_mfma_f32_32x32x16_bf16 v[32:47], a[68:71], a[12:15], v[32:47]
  v_cvt_pk_f16_f32 v250, v52, v53
  v_cvt_pk_f16_f32 v251, v54, v55
  v_mfma_f32_32x32x16_bf16 v[32:47], a[72:75], a[20:23], v[32:47]
  v_pk_maximum3_f16 v27, v27, v248, v249
  v_cvt_pk_f16_f32 v252, v56, v57
  v_mfma_f32_32x32x16_bf16 v[32:47], a[76:79], a[28:31], v[32:47]
  v_cvt_pk_f16_f32 v253, v58, v59
  v_pk_maximum3_f16 v27, v27, v250, v251
  v_mfma_f32_32x32x16_bf16 v[32:47], a[80:83], a[36:39], v[32:47]
  v_cvt_pk_f16_f32 v254, v60, v61
  v_cvt_pk_f16_f32 v255, v62, v63
  v_mfma_f32_32x32x16_bf16 v[32:47], a[84:87], a[44:47], v[32:47]
  v_pk_maximum3_f16 v27, v27, v252, v253
  v_pk_maximum3_f16 v27, v27, v254, v255
  v_mfma_f32_32x32x16_bf16 v[32:47], a[88:91], a[52:55], v[32:47]
  ds_read_b128 a[112:115], v20 offset:57344
  ds_read_b128 a[116:119], v21 offset:57344
  v_mfma_f32_32x32x16_bf16 v[32:47], a[92:95], a[60:63], v[32:47]
  ds_read_b128 a[120:123], v22 offset:57344
  ds_read_b128 a[124:127], v23 offset:57344
  s_waitcnt lgkmcnt(0)
  v_mfma_f32_32x32x16_bf16 v[48:63], a[96:99], a[0:3], 0
  s_waitcnt vmcnt(35)
  s_barrier
  v_cvt_pk_f16_f32 v80, v64, v65
  v_cvt_pk_f16_f32 v81, v66, v67
  v_cvt_pk_f16_f32 v82, v68, v69
  v_mfma_f32_32x32x16_bf16 v[48:63], a[100:103], a[8:11], v[48:63]
  v_cvt_pk_f16_f32 v83, v70, v71
  v_pk_maximum3_f16 v26, v26, v80, v81
  v_cvt_pk_f16_f32 v84, v72, v73
  v_cvt_pk_f16_f32 v85, v74, v75
  v_mfma_f32_32x32x16_bf16 v[48:63], a[104:107], a[16:19], v[48:63]
  v_pk_maximum3_f16 v26, v26, v82, v83
  v_cvt_pk_f16_f32 v86, v76, v77
  v_cvt_pk_f16_f32 v87, v78, v79
  v_pk_maximum3_f16 v26, v26, v84, v85
  v_pk_maximum3_f16 v26, v26, v86, v87
  v_mfma_f32_32x32x16_bf16 v[48:63], a[108:111], a[24:27], v[48:63]
  v_accvgpr_write_b32 a128, v80
  v_accvgpr_write_b32 a129, v81
  v_accvgpr_write_b32 a130, v82
  v_accvgpr_write_b32 a131, v83
  v_accvgpr_write_b32 a132, v84
  v_mfma_f32_32x32x16_bf16 v[48:63], a[112:115], a[32:35], v[48:63]
  v_accvgpr_write_b32 a133, v85
  v_accvgpr_write_b32 a134, v86
  v_accvgpr_write_b32 a135, v87
  v_add_u32 v16, 0xffff0000, v16
  ds_read_b128 a[64:67], v16 offset:0
  v_mfma_f32_32x32x16_bf16 v[48:63], a[116:119], a[40:43], v[48:63]
  v_add_u32 v17, 0xffff0000, v17
  ds_read_b128 a[68:71], v17 offset:0
  v_add_u32 v18, 0xffff0000, v18
  ds_read_b128 a[72:75], v18 offset:0
  v_mfma_f32_32x32x16_bf16 v[48:63], a[120:123], a[48:51], v[48:63]
  v_add_u32 v19, 0xffff0000, v19
  ds_read_b128 a[76:79], v19 offset:0
  s_add_u32 m0, s48, 98304
  s_mov_b32 s46, 98304
  buffer_load_dwordx4 v24, s[12:15], s46 offen offset:0 sc1 lds
  v_mfma_f32_32x32x16_bf16 v[48:63], a[124:127], a[56:59], v[48:63]
  buffer_load_dwordx4 v24, s[12:15], s46 offen offset:1024 sc1 lds
  buffer_load_dwordx4 v24, s[12:15], s46 offen offset:2048 sc1 lds
  buffer_load_dwordx4 v24, s[12:15], s46 offen offset:3072 sc1 lds
  buffer_load_dwordx4 a[236:239], v5, s[4:7], s47 offen offset:3072
  v_mfma_f32_32x32x16_bf16 v[64:79], a[96:99], a[4:7], 0
  v_cvt_pk_f16_f32 v88, v32, v33
  v_cvt_pk_f16_f32 v89, v34, v35
  v_cvt_pk_f16_f32 v90, v36, v37
  v_cvt_pk_f16_f32 v91, v38, v39
  v_mfma_f32_32x32x16_bf16 v[64:79], a[100:103], a[12:15], v[64:79]
  v_pk_maximum3_f16 v27, v27, v88, v89
  v_cvt_pk_f16_f32 v92, v40, v41
  v_cvt_pk_f16_f32 v93, v42, v43
  v_mfma_f32_32x32x16_bf16 v[64:79], a[104:107], a[20:23], v[64:79]
  v_pk_maximum3_f16 v27, v27, v90, v91
  v_cvt_pk_f16_f32 v94, v44, v45
  v_cvt_pk_f16_f32 v95, v46, v47
  v_pk_maximum3_f16 v27, v27, v92, v93
  v_mfma_f32_32x32x16_bf16 v[64:79], a[108:111], a[28:31], v[64:79]
  v_pk_maximum3_f16 v27, v27, v94, v95
  v_accvgpr_write_b32 a136, v88
  v_accvgpr_write_b32 a137, v89
  v_mfma_f32_32x32x16_bf16 v[64:79], a[112:115], a[36:39], v[64:79]
  v_accvgpr_write_b32 a138, v90
  v_accvgpr_write_b32 a139, v91
  v_accvgpr_write_b32 a140, v92
  v_accvgpr_write_b32 a141, v93
  v_mfma_f32_32x32x16_bf16 v[64:79], a[116:119], a[44:47], v[64:79]
  v_accvgpr_write_b32 a142, v94
  v_accvgpr_write_b32 a143, v95
  v_add_u32 v20, 0xffff0000, v20
  ds_read_b128 a[80:83], v20 offset:0
  v_mfma_f32_32x32x16_bf16 v[64:79], a[120:123], a[52:55], v[64:79]
  v_add_u32 v21, 0xffff0000, v21
  ds_read_b128 a[84:87], v21 offset:0
  v_mfma_f32_32x32x16_bf16 v[64:79], a[124:127], a[60:63], v[64:79]
  v_add_u32 v22, 0xffff0000, v22
  ds_read_b128 a[88:91], v22 offset:0
  v_add_u32 v23, 0xffff0000, v23
  ds_read_b128 a[92:95], v23 offset:0
  s_waitcnt lgkmcnt(0)
  v_mfma_f32_32x32x16_bf16 v[32:47], a[64:67], a[0:3], 0
  v_cvt_pk_f16_f32 v80, v48, v49
  v_cvt_pk_f16_f32 v81, v50, v51
  v_cvt_pk_f16_f32 v82, v52, v53
  v_mfma_f32_32x32x16_bf16 v[32:47], a[68:71], a[8:11], v[32:47]
  v_cvt_pk_f16_f32 v83, v54, v55
  v_pk_maximum3_f16 v26, v26, v80, v81
  v_cvt_pk_f16_f32 v84, v56, v57
  v_mfma_f32_32x32x16_bf16 v[32:47], a[72:75], a[16:19], v[32:47]
  v_cvt_pk_f16_f32 v85, v58, v59
  v_pk_maximum3_f16 v26, v26, v82, v83
  v_cvt_pk_f16_f32 v86, v60, v61
  v_mfma_f32_32x32x16_bf16 v[32:47], a[76:79], a[24:27], v[32:47]
  v_cvt_pk_f16_f32 v87, v62, v63
  v_pk_maximum3_f16 v26, v26, v84, v85
  v_pk_maximum3_f16 v26, v26, v86, v87
  v_mfma_f32_32x32x16_bf16 v[32:47], a[80:83], a[32:35], v[32:47]
  v_accvgpr_write_b32 a144, v80
  v_accvgpr_write_b32 a145, v81
  v_accvgpr_write_b32 a146, v82
  v_mfma_f32_32x32x16_bf16 v[32:47], a[84:87], a[40:43], v[32:47]
  v_accvgpr_write_b32 a147, v83
  v_accvgpr_write_b32 a148, v84
  v_accvgpr_write_b32 a149, v85
  v_mfma_f32_32x32x16_bf16 v[32:47], a[88:91], a[48:51], v[32:47]
  v_accvgpr_write_b32 a150, v86
  v_accvgpr_write_b32 a151, v87
  ds_read_b128 a[96:99], v16 offset:8192
  v_mfma_f32_32x32x16_bf16 v[32:47], a[92:95], a[56:59], v[32:47]
  ds_read_b128 a[100:103], v17 offset:8192
  ds_read_b128 a[104:107], v18 offset:8192
  ds_read_b128 a[108:111], v19 offset:8192
  v_mfma_f32_32x32x16_bf16 v[48:63], a[64:67], a[4:7], 0
  v_cvt_pk_f16_f32 v88, v64, v65
  v_cvt_pk_f16_f32 v89, v66, v67
  v_cvt_pk_f16_f32 v90, v68, v69
  v_mfma_f32_32x32x16_bf16 v[48:63], a[68:71], a[12:15], v[48:63]
  v_cvt_pk_f16_f32 v91, v70, v71
  v_pk_maximum3_f16 v27, v27, v88, v89
  v_cvt_pk_f16_f32 v92, v72, v73
  v_mfma_f32_32x32x16_bf16 v[48:63], a[72:75], a[20:23], v[48:63]
  v_cvt_pk_f16_f32 v93, v74, v75
  v_pk_maximum3_f16 v27, v27, v90, v91
  v_cvt_pk_f16_f32 v94, v76, v77
  v_mfma_f32_32x32x16_bf16 v[48:63], a[76:79], a[28:31], v[48:63]
  v_cvt_pk_f16_f32 v95, v78, v79
  v_pk_maximum3_f16 v27, v27, v92, v93
  v_pk_maximum3_f16 v27, v27, v94, v95
  v_mfma_f32_32x32x16_bf16 v[48:63], a[80:83], a[36:39], v[48:63]
  v_accvgpr_write_b32 a152, v88
  v_accvgpr_write_b32 a153, v89
  v_accvgpr_write_b32 a154, v90
  v_mfma_f32_32x32x16_bf16 v[48:63], a[84:87], a[44:47], v[48:63]
  v_accvgpr_write_b32 a155, v91
  v_accvgpr_write_b32 a156, v92
  v_accvgpr_write_b32 a157, v93
  v_mfma_f32_32x32x16_bf16 v[48:63], a[88:91], a[52:55], v[48:63]
  v_accvgpr_write_b32 a158, v94
  v_accvgpr_write_b32 a159, v95
  ds_read_b128 a[112:115], v20 offset:8192
  v_mfma_f32_32x32x16_bf16 v[48:63], a[92:95], a[60:63], v[48:63]
  ds_read_b128 a[116:119], v21 offset:8192
  ds_read_b128 a[120:123], v22 offset:8192
  ds_read_b128 a[124:127], v23 offset:8192
  s_waitcnt lgkmcnt(0)
  v_mfma_f32_32x32x16_bf16 v[64:79], a[96:99], a[0:3], 0
  s_waitcnt vmcnt(36)
  s_barrier
  v_cvt_pk_f16_f32 v80, v32, v33
  v_cvt_pk_f16_f32 v81, v34, v35
  v_mfma_f32_32x32x16_bf16 v[64:79], a[100:103], a[8:11], v[64:79]
  v_cvt_pk_f16_f32 v82, v36, v37
  v_cvt_pk_f16_f32 v83, v38, v39
  v_pk_maximum3_f16 v26, v26, v80, v81
  v_cvt_pk_f16_f32 v84, v40, v41
  v_mfma_f32_32x32x16_bf16 v[64:79], a[104:107], a[16:19], v[64:79]
  v_cvt_pk_f16_f32 v85, v42, v43
  v_pk_maximum3_f16 v26, v26, v82, v83
  v_cvt_pk_f16_f32 v86, v44, v45
  v_cvt_pk_f16_f32 v87, v46, v47
  v_mfma_f32_32x32x16_bf16 v[64:79], a[108:111], a[24:27], v[64:79]
  v_pk_maximum3_f16 v26, v26, v84, v85
  v_pk_maximum3_f16 v26, v26, v86, v87
  v_accvgpr_write_b32 a160, v80
  v_accvgpr_write_b32 a161, v81
  v_mfma_f32_32x32x16_bf16 v[64:79], a[112:115], a[32:35], v[64:79]
  v_accvgpr_write_b32 a162, v82
  v_accvgpr_write_b32 a163, v83
  v_accvgpr_write_b32 a164, v84
  v_accvgpr_write_b32 a165, v85
  v_mfma_f32_32x32x16_bf16 v[64:79], a[116:119], a[40:43], v[64:79]
  v_accvgpr_write_b32 a166, v86
  v_accvgpr_write_b32 a167, v87
  ds_read_b128 a[64:67], v16 offset:16384
  ds_read_b128 a[68:71], v17 offset:16384
  v_mfma_f32_32x32x16_bf16 v[64:79], a[120:123], a[48:51], v[64:79]
  ds_read_b128 a[72:75], v18 offset:16384
  ds_read_b128 a[76:79], v19 offset:16384
  s_add_u32 m0, s48, 114688
  s_mov_b32 s46, 114688
  buffer_load_dwordx4 v24, s[12:15], s46 offen offset:0 sc1 lds
  v_mfma_f32_32x32x16_bf16 v[64:79], a[124:127], a[56:59], v[64:79]
  buffer_load_dwordx4 v24, s[12:15], s46 offen offset:1024 sc1 lds
  buffer_load_dwordx4 v24, s[12:15], s46 offen offset:2048 sc1 lds
  buffer_load_dwordx4 v24, s[12:15], s46 offen offset:3072 sc1 lds
  v_mfma_f32_32x32x16_bf16 v[32:47], a[96:99], a[4:7], 0
  v_cvt_pk_f16_f32 v88, v48, v49
  v_cvt_pk_f16_f32 v89, v50, v51
  v_cvt_pk_f16_f32 v90, v52, v53
  v_mfma_f32_32x32x16_bf16 v[32:47], a[100:103], a[12:15], v[32:47]
  v_cvt_pk_f16_f32 v91, v54, v55
  v_pk_maximum3_f16 v27, v27, v88, v89
  v_cvt_pk_f16_f32 v92, v56, v57
  v_mfma_f32_32x32x16_bf16 v[32:47], a[104:107], a[20:23], v[32:47]
  v_cvt_pk_f16_f32 v93, v58, v59
  v_pk_maximum3_f16 v27, v27, v90, v91
  v_cvt_pk_f16_f32 v94, v60, v61
  v_mfma_f32_32x32x16_bf16 v[32:47], a[108:111], a[28:31], v[32:47]
  v_cvt_pk_f16_f32 v95, v62, v63
  v_pk_maximum3_f16 v27, v27, v92, v93
  v_pk_maximum3_f16 v27, v27, v94, v95
  v_mfma_f32_32x32x16_bf16 v[32:47], a[112:115], a[36:39], v[32:47]
  v_accvgpr_write_b32 a168, v88
  v_accvgpr_write_b32 a169, v89
  v_accvgpr_write_b32 a170, v90
  v_mfma_f32_32x32x16_bf16 v[32:47], a[116:119], a[44:47], v[32:47]
  v_accvgpr_write_b32 a171, v91
  v_accvgpr_write_b32 a172, v92
  v_accvgpr_write_b32 a173, v93
  v_mfma_f32_32x32x16_bf16 v[32:47], a[120:123], a[52:55], v[32:47]
  v_accvgpr_write_b32 a174, v94
  v_accvgpr_write_b32 a175, v95
  ds_read_b128 a[80:83], v20 offset:16384
  v_mfma_f32_32x32x16_bf16 v[32:47], a[124:127], a[60:63], v[32:47]
  ds_read_b128 a[84:87], v21 offset:16384
  ds_read_b128 a[88:91], v22 offset:16384
  ds_read_b128 a[92:95], v23 offset:16384
  s_waitcnt lgkmcnt(0)
  v_mfma_f32_32x32x16_bf16 v[48:63], a[64:67], a[0:3], 0
  v_cvt_pk_f16_f32 v80, v64, v65
  v_cvt_pk_f16_f32 v81, v66, v67
  v_cvt_pk_f16_f32 v82, v68, v69
  v_mfma_f32_32x32x16_bf16 v[48:63], a[68:71], a[8:11], v[48:63]
  v_cvt_pk_f16_f32 v83, v70, v71
  v_pk_maximum3_f16 v26, v26, v80, v81
  v_cvt_pk_f16_f32 v84, v72, v73
  v_mfma_f32_32x32x16_bf16 v[48:63], a[72:75], a[16:19], v[48:63]
  v_cvt_pk_f16_f32 v85, v74, v75
  v_pk_maximum3_f16 v26, v26, v82, v83
  v_cvt_pk_f16_f32 v86, v76, v77
  v_mfma_f32_32x32x16_bf16 v[48:63], a[76:79], a[24:27], v[48:63]
  v_cvt_pk_f16_f32 v87, v78, v79
  v_pk_maximum3_f16 v26, v26, v84, v85
  v_pk_maximum3_f16 v26, v26, v86, v87
  v_mfma_f32_32x32x16_bf16 v[48:63], a[80:83], a[32:35], v[48:63]
  v_accvgpr_write_b32 a176, v80
  v_accvgpr_write_b32 a177, v81
  v_accvgpr_write_b32 a178, v82
  v_mfma_f32_32x32x16_bf16 v[48:63], a[84:87], a[40:43], v[48:63]
  v_accvgpr_write_b32 a179, v83
  v_accvgpr_write_b32 a180, v84
  v_accvgpr_write_b32 a181, v85
  v_mfma_f32_32x32x16_bf16 v[48:63], a[88:91], a[48:51], v[48:63]
  v_accvgpr_write_b32 a182, v86
  v_accvgpr_write_b32 a183, v87
  ds_read_b128 a[96:99], v16 offset:24576
  v_mfma_f32_32x32x16_bf16 v[48:63], a[92:95], a[56:59], v[48:63]
  ds_read_b128 a[100:103], v17 offset:24576
  ds_read_b128 a[104:107], v18 offset:24576
  ds_read_b128 a[108:111], v19 offset:24576
  v_mfma_f32_32x32x16_bf16 v[64:79], a[64:67], a[4:7], 0
  v_cvt_pk_f16_f32 v88, v32, v33
  v_cvt_pk_f16_f32 v89, v34, v35
  v_cvt_pk_f16_f32 v90, v36, v37
  v_mfma_f32_32x32x16_bf16 v[64:79], a[68:71], a[12:15], v[64:79]
  v_cvt_pk_f16_f32 v91, v38, v39
  v_pk_maximum3_f16 v27, v27, v88, v89
  v_cvt_pk_f16_f32 v92, v40, v41
  v_mfma_f32_32x32x16_bf16 v[64:79], a[72:75], a[20:23], v[64:79]
  v_cvt_pk_f16_f32 v93, v42, v43
  v_pk_maximum3_f16 v27, v27, v90, v91
  v_cvt_pk_f16_f32 v94, v44, v45
  v_mfma_f32_32x32x16_bf16 v[64:79], a[76:79], a[28:31], v[64:79]
  v_cvt_pk_f16_f32 v95, v46, v47
  v_pk_maximum3_f16 v27, v27, v92, v93
  v_pk_maximum3_f16 v27, v27, v94, v95
  v_mfma_f32_32x32x16_bf16 v[64:79], a[80:83], a[36:39], v[64:79]
  v_accvgpr_write_b32 a184, v88
  v_accvgpr_write_b32 a185, v89
  v_accvgpr_write_b32 a186, v90
  v_mfma_f32_32x32x16_bf16 v[64:79], a[84:87], a[44:47], v[64:79]
  v_accvgpr_write_b32 a187, v91
  v_accvgpr_write_b32 a188, v92
  v_accvgpr_write_b32 a189, v93
  v_mfma_f32_32x32x16_bf16 v[64:79], a[88:91], a[52:55], v[64:79]
  v_accvgpr_write_b32 a190, v94
  v_accvgpr_write_b32 a191, v95
  ds_read_b128 a[112:115], v20 offset:24576
  v_mfma_f32_32x32x16_bf16 v[64:79], a[92:95], a[60:63], v[64:79]
  ds_read_b128 a[116:119], v21 offset:24576
  ds_read_b128 a[120:123], v22 offset:24576
  ds_read_b128 a[124:127], v23 offset:24576
  s_waitcnt lgkmcnt(0)
  v_mfma_f32_32x32x16_bf16 v[32:47], a[96:99], a[0:3], 0
  v_cvt_pk_f16_f32 v80, v48, v49
  v_cvt_pk_f16_f32 v81, v50, v51
  v_cvt_pk_f16_f32 v82, v52, v53
  v_mfma_f32_32x32x16_bf16 v[32:47], a[100:103], a[8:11], v[32:47]
  v_cvt_pk_f16_f32 v83, v54, v55
  v_pk_maximum3_f16 v26, v26, v80, v81
  v_mfma_f32_32x32x16_bf16 v[32:47], a[104:107], a[16:19], v[32:47]
  v_cvt_pk_f16_f32 v84, v56, v57
  v_cvt_pk_f16_f32 v85, v58, v59
  v_pk_maximum3_f16 v26, v26, v82, v83
  v_mfma_f32_32x32x16_bf16 v[32:47], a[108:111], a[24:27], v[32:47]
  v_cvt_pk_f16_f32 v86, v60, v61
  v_cvt_pk_f16_f32 v87, v62, v63
  v_mfma_f32_32x32x16_bf16 v[32:47], a[112:115], a[32:35], v[32:47]
  v_pk_maximum3_f16 v26, v26, v84, v85
  v_pk_maximum3_f16 v26, v26, v86, v87
  v_accvgpr_write_b32 a192, v80
  v_mfma_f32_32x32x16_bf16 v[32:47], a[116:119], a[40:43], v[32:47]
  v_accvgpr_write_b32 a193, v81
  v_accvgpr_write_b32 a194, v82
  v_mfma_f32_32x32x16_bf16 v[32:47], a[120:123], a[48:51], v[32:47]
  v_accvgpr_write_b32 a195, v83
  v_accvgpr_write_b32 a196, v84
  v_accvgpr_write_b32 a197, v85
  v_mfma_f32_32x32x16_bf16 v[32:47], a[124:127], a[56:59], v[32:47]
  v_accvgpr_write_b32 a198, v86
  v_accvgpr_write_b32 a199, v87
  v_mfma_f32_32x32x16_bf16 v[48:63], a[96:99], a[4:7], 0
  v_cvt_pk_f16_f32 v88, v64, v65
  v_cvt_pk_f16_f32 v89, v66, v67
  v_cvt_pk_f16_f32 v90, v68, v69
  v_mfma_f32_32x32x16_bf16 v[48:63], a[100:103], a[12:15], v[48:63]
  v_cvt_pk_f16_f32 v91, v70, v71
  v_pk_maximum3_f16 v27, v27, v88, v89
  v_mfma_f32_32x32x16_bf16 v[48:63], a[104:107], a[20:23], v[48:63]
  v_cvt_pk_f16_f32 v92, v72, v73
  v_cvt_pk_f16_f32 v93, v74, v75
  v_pk_maximum3_f16 v27, v27, v90, v91
  v_mfma_f32_32x32x16_bf16 v[48:63], a[108:111], a[28:31], v[48:63]
  v_cvt_pk_f16_f32 v94, v76, v77
  v_cvt_pk_f16_f32 v95, v78, v79
  v_mfma_f32_32x32x16_bf16 v[48:63], a[112:115], a[36:39], v[48:63]
  v_pk_maximum3_f16 v27, v27, v92, v93
  v_pk_maximum3_f16 v27, v27, v94, v95
  v_accvgpr_write_b32 a200, v88
  v_mfma_f32_32x32x16_bf16 v[48:63], a[116:119], a[44:47], v[48:63]
  v_accvgpr_write_b32 a201, v89
  v_accvgpr_write_b32 a202, v90
  v_mfma_f32_32x32x16_bf16 v[48:63], a[120:123], a[52:55], v[48:63]
  v_accvgpr_write_b32 a203, v91
  v_accvgpr_write_b32 a204, v92
  v_accvgpr_write_b32 a205, v93
  v_mfma_f32_32x32x16_bf16 v[48:63], a[124:127], a[60:63], v[48:63]
  v_accvgpr_write_b32 a206, v94
  v_accvgpr_write_b32 a207, v95
  s_waitcnt vmcnt(11)
  s_barrier
  v_add_u32 v16, 0x10000, v24
  v_add_u32 v17, 0x20000, v24
  v_cvt_pk_f16_f32 v80, v32, v33
  v_cvt_pk_f16_f32 v81, v34, v35
  v_cvt_pk_f16_f32 v82, v36, v37
  v_cvt_pk_f16_f32 v83, v38, v39
  v_pk_maximum3_f16 v26, v26, v80, v81
  v_cvt_pk_f16_f32 v84, v40, v41
  v_cvt_pk_f16_f32 v85, v42, v43
  v_pk_maximum3_f16 v26, v26, v82, v83
  v_cvt_pk_f16_f32 v86, v44, v45
  v_cvt_pk_f16_f32 v87, v46, v47
  v_pk_maximum3_f16 v26, v26, v84, v85
  v_pk_maximum3_f16 v26, v26, v86, v87
  v_accvgpr_write_b32 a208, v80
  v_accvgpr_write_b32 a209, v81
  v_accvgpr_write_b32 a210, v82
  v_accvgpr_write_b32 a211, v83
  v_accvgpr_write_b32 a212, v84
  v_accvgpr_write_b32 a213, v85
  v_accvgpr_write_b32 a214, v86
  v_accvgpr_write_b32 a215, v87
  v_cvt_pk_f16_f32 v88, v48, v49
  v_cvt_pk_f16_f32 v89, v50, v51
  v_cvt_pk_f16_f32 v90, v52, v53
  v_cvt_pk_f16_f32 v91, v54, v55
  v_pk_maximum3_f16 v27, v27, v88, v89
  v_cvt_pk_f16_f32 v92, v56, v57
  v_cvt_pk_f16_f32 v93, v58, v59
  v_pk_maximum3_f16 v27, v27, v90, v91
  v_cvt_pk_f16_f32 v94, v60, v61
  v_cvt_pk_f16_f32 v95, v62, v63
  v_pk_maximum3_f16 v27, v27, v92, v93
  v_pk_maximum3_f16 v27, v27, v94, v95
  v_accvgpr_write_b32 a216, v88
  v_accvgpr_write_b32 a217, v89
  v_accvgpr_write_b32 a218, v90
  v_accvgpr_write_b32 a219, v91
  v_accvgpr_write_b32 a220, v92
  v_accvgpr_write_b32 a221, v93
  v_accvgpr_write_b32 a222, v94
  v_accvgpr_write_b32 a223, v95
  ds_read_b128 v[32:35], v24 offset:32768
  ds_read_b128 v[36:39], v24 offset:33792
  ds_read_b128 v[40:43], v24 offset:34816
  ds_read_b128 v[44:47], v24 offset:35840
  v_pk_max_f16 v26, v26, v26 op_sel:[0,1] op_sel_hi:[1,0]
  v_pk_max_f16 v27, v27, v27 op_sel:[0,1] op_sel_hi:[1,0]
  v_cvt_f32_f16 v26, v26
  v_cvt_f32_f16 v27, v27
  v_mov_b32 v64, v26
  v_mov_b32 v65, v27
  s_nop 0
  v_permlane32_swap_b32 v26, v64
  v_permlane32_swap_b32 v27, v65
  v_max_f32 v26, v26, v64
  v_max_f32 v27, v27, v65
  v_mul_f32 v28, s41, v26
  v_mul_f32 v29, s41, v27
  v_fma_mix_f32 v80, v96, s41, -v28 op_sel:[0,0,0] op_sel_hi:[1,0,0]
  v_fma_mix_f32 v81, v96, s41, -v28 op_sel:[1,0,0] op_sel_hi:[1,0,0]
  v_exp_f32 v80, v80
  v_exp_f32 v81, v81
  v_fma_mix_f32 v82, v97, s41, -v28 op_sel:[0,0,0] op_sel_hi:[1,0,0]
  v_fma_mix_f32 v83, v97, s41, -v28 op_sel:[1,0,0] op_sel_hi:[1,0,0]
  v_exp_f32 v82, v82
  v_exp_f32 v83, v83
  v_cvt_pk_bf16_f32 v64, v80, v81
  v_fma_mix_f32 v84, v98, s41, -v28 op_sel:[0,0,0] op_sel_hi:[1,0,0]
  v_fma_mix_f32 v85, v98, s41, -v28 op_sel:[1,0,0] op_sel_hi:[1,0,0]
  v_exp_f32 v84, v84
  v_exp_f32 v85, v85
  v_cvt_pk_bf16_f32 v65, v82, v83
  v_fma_mix_f32 v86, v99, s41, -v28 op_sel:[0,0,0] op_sel_hi:[1,0,0]
  v_fma_mix_f32 v87, v99, s41, -v28 op_sel:[1,0,0] op_sel_hi:[1,0,0]
  v_exp_f32 v86, v86
  v_exp_f32 v87, v87
  v_cvt_pk_bf16_f32 v66, v84, v85
  v_fma_mix_f32 v88, v104, s41, -v29 op_sel:[0,0,0] op_sel_hi:[1,0,0]
  v_fma_mix_f32 v89, v104, s41, -v29 op_sel:[1,0,0] op_sel_hi:[1,0,0]
  v_cvt_pk_bf16_f32 v67, v86, v87
  v_exp_f32 v88, v88
  v_exp_f32 v89, v89
  v_fma_mix_f32 v90, v105, s41, -v29 op_sel:[0,0,0] op_sel_hi:[1,0,0]
  v_fma_mix_f32 v91, v105, s41, -v29 op_sel:[1,0,0] op_sel_hi:[1,0,0]
  v_exp_f32 v90, v90
  v_exp_f32 v91, v91
  v_cvt_pk_bf16_f32 v68, v88, v89
  v_fma_mix_f32 v92, v106, s41, -v29 op_sel:[0,0,0] op_sel_hi:[1,0,0]
  v_fma_mix_f32 v93, v106, s41, -v29 op_sel:[1,0,0] op_sel_hi:[1,0,0]
  v_exp_f32 v92, v92
  v_exp_f32 v93, v93
  v_cvt_pk_bf16_f32 v69, v90, v91
  v_fma_mix_f32 v94, v107, s41, -v29 op_sel:[0,0,0] op_sel_hi:[1,0,0]
  v_fma_mix_f32 v95, v107, s41, -v29 op_sel:[1,0,0] op_sel_hi:[1,0,0]
  v_exp_f32 v94, v94
  v_exp_f32 v95, v95
  v_cvt_pk_bf16_f32 v70, v92, v93
  s_waitcnt lgkmcnt(0)
  v_mfma_f32_32x32x16_bf16 a[0:15], v[32:35], v[64:67], 0
  v_cvt_pk_bf16_f32 v71, v94, v95
  ds_read_b128 v[48:51], v24 offset:36864
  ds_read_b128 v[52:55], v24 offset:37888
  ds_read_b128 v[56:59], v24 offset:38912
  ds_read_b128 v[60:63], v24 offset:39936
  s_xor_b32 s45, s32, 2
  s_lshr_b32 s46, s45, 1
  s_lshl_b32 s46, s46, 2
  s_and_b32 s45, s45, 1
  s_add_u32 s45, s45, s46
  s_add_u32 s45, s45, 4
  s_lshl_b32 s45, s45, 14
  s_sub_u32 s46, s45, s43
  s_mov_b32 s43, s45
  v_mfma_f32_32x32x16_bf16 a[32:47], v[36:39], v[64:67], 0
  v_add_u32 v6, s46, v6
  v_add_u32 v7, s46, v7
  v_add_u32 v8, s46, v8
  v_add_u32 v9, s46, v9
  v_fma_mix_f32 v80, v100, s41, -v28 op_sel:[0,0,0] op_sel_hi:[1,0,0]
  v_mfma_f32_16x16x32_bf16 a[224:227], a[232:235], v[64:67], 0
  v_mfma_f32_32x32x16_bf16 a[64:79], v[40:43], v[64:67], 0
  v_fma_mix_f32 v81, v100, s41, -v28 op_sel:[1,0,0] op_sel_hi:[1,0,0]
  v_exp_f32 v80, v80
  v_exp_f32 v81, v81
  v_fma_mix_f32 v82, v101, s41, -v28 op_sel:[0,0,0] op_sel_hi:[1,0,0]
  v_fma_mix_f32 v83, v101, s41, -v28 op_sel:[1,0,0] op_sel_hi:[1,0,0]
  v_exp_f32 v82, v82
  v_mfma_f32_32x32x16_bf16 a[96:111], v[44:47], v[64:67], 0
  v_exp_f32 v83, v83
  v_cvt_pk_bf16_f32 v72, v80, v81
  v_fma_mix_f32 v84, v102, s41, -v28 op_sel:[0,0,0] op_sel_hi:[1,0,0]
  v_fma_mix_f32 v85, v102, s41, -v28 op_sel:[1,0,0] op_sel_hi:[1,0,0]
  v_exp_f32 v84, v84
  v_exp_f32 v85, v85
  v_mfma_f32_32x32x16_bf16 a[16:31], v[32:35], v[68:71], 0
  v_cvt_pk_bf16_f32 v73, v82, v83
  v_fma_mix_f32 v86, v103, s41, -v28 op_sel:[0,0,0] op_sel_hi:[1,0,0]
  v_fma_mix_f32 v87, v103, s41, -v28 op_sel:[1,0,0] op_sel_hi:[1,0,0]
  v_exp_f32 v86, v86
  v_exp_f32 v87, v87
  v_cvt_pk_bf16_f32 v74, v84, v85
  v_fma_mix_f32 v88, v108, s41, -v29 op_sel:[0,0,0] op_sel_hi:[1,0,0]
  v_mfma_f32_32x32x16_bf16 a[48:63], v[36:39], v[68:71], 0
  v_fma_mix_f32 v89, v108, s41, -v29 op_sel:[1,0,0] op_sel_hi:[1,0,0]
  v_cvt_pk_bf16_f32 v75, v86, v87
  v_exp_f32 v88, v88
  v_exp_f32 v89, v89
  v_mfma_f32_16x16x32_bf16 a[228:231], a[232:235], v[68:71], 0
  v_fma_mix_f32 v90, v109, s41, -v29 op_sel:[0,0,0] op_sel_hi:[1,0,0]
  v_fma_mix_f32 v91, v109, s41, -v29 op_sel:[1,0,0] op_sel_hi:[1,0,0]
  v_exp_f32 v90, v90
  v_mfma_f32_32x32x16_bf16 a[80:95], v[40:43], v[68:71], 0
  v_exp_f32 v91, v91
  v_cvt_pk_bf16_f32 v76, v88, v89
  v_fma_mix_f32 v92, v110, s41, -v29 op_sel:[0,0,0] op_sel_hi:[1,0,0]
  v_fma_mix_f32 v93, v110, s41, -v29 op_sel:[1,0,0] op_sel_hi:[1,0,0]
  v_exp_f32 v92, v92
  v_exp_f32 v93, v93
  v_mfma_f32_32x32x16_bf16 a[112:127], v[44:47], v[68:71], 0
  v_cvt_pk_bf16_f32 v77, v90, v91
  v_fma_mix_f32 v94, v111, s41, -v29 op_sel:[0,0,0] op_sel_hi:[1,0,0]
  v_fma_mix_f32 v95, v111, s41, -v29 op_sel:[1,0,0] op_sel_hi:[1,0,0]
  v_exp_f32 v94, v94
  v_exp_f32 v95, v95
  v_cvt_pk_bf16_f32 v78, v92, v93
  s_waitcnt lgkmcnt(0)
  v_mfma_f32_32x32x16_bf16 a[0:15], v[48:51], v[72:75], a[0:15]
  v_cvt_pk_bf16_f32 v79, v94, v95
  ds_read_b128 v[32:35], v24 offset:40960
  ds_read_b128 v[36:39], v24 offset:41984
  ds_read_b128 v[40:43], v24 offset:43008
  ds_read_b128 v[44:47], v24 offset:44032
  v_fma_mix_f32 v80, v112, s41, -v28 op_sel:[0,0,0] op_sel_hi:[1,0,0]
  v_fma_mix_f32 v81, v112, s41, -v28 op_sel:[1,0,0] op_sel_hi:[1,0,0]
  v_exp_f32 v80, v80
  v_mfma_f32_32x32x16_bf16 a[32:47], v[52:55], v[72:75], a[32:47]
  v_exp_f32 v81, v81
  v_fma_mix_f32 v82, v113, s41, -v28 op_sel:[0,0,0] op_sel_hi:[1,0,0]
  v_fma_mix_f32 v83, v113, s41, -v28 op_sel:[1,0,0] op_sel_hi:[1,0,0]
  v_exp_f32 v82, v82
  v_mfma_f32_16x16x32_bf16 a[224:227], a[232:235], v[72:75], a[224:227]
  v_exp_f32 v83, v83
  v_mfma_f32_32x32x16_bf16 a[64:79], v[56:59], v[72:75], a[64:79]
  v_cvt_pk_bf16_f32 v64, v80, v81
  v_fma_mix_f32 v84, v114, s41, -v28 op_sel:[0,0,0] op_sel_hi:[1,0,0]
  v_fma_mix_f32 v85, v114, s41, -v28 op_sel:[1,0,0] op_sel_hi:[1,0,0]
  v_exp_f32 v84, v84
  v_exp_f32 v85, v85
  v_cvt_pk_bf16_f32 v65, v82, v83
  v_mfma_f32_32x32x16_bf16 a[96:111], v[60:63], v[72:75], a[96:111]
  v_fma_mix_f32 v86, v115, s41, -v28 op_sel:[0,0,0] op_sel_hi:[1,0,0]
  v_fma_mix_f32 v87, v115, s41, -v28 op_sel:[1,0,0] op_sel_hi:[1,0,0]
  v_exp_f32 v86, v86
  v_exp_f32 v87, v87
  v_cvt_pk_bf16_f32 v66, v84, v85
  v_fma_mix_f32 v88, v120, s41, -v29 op_sel:[0,0,0] op_sel_hi:[1,0,0]
  v_fma_mix_f32 v89, v120, s41, -v29 op_sel:[1,0,0] op_sel_hi:[1,0,0]
  v_mfma_f32_32x32x16_bf16 a[16:31], v[48:51], v[76:79], a[16:31]
  v_cvt_pk_bf16_f32 v67, v86, v87
  v_exp_f32 v88, v88
  v_exp_f32 v89, v89
  v_fma_mix_f32 v90, v121, s41, -v29 op_sel:[0,0,0] op_sel_hi:[1,0,0]
  v_fma_mix_f32 v91, v121, s41, -v29 op_sel:[1,0,0] op_sel_hi:[1,0,0]
  v_mfma_f32_32x32x16_bf16 a[48:63], v[52:55], v[76:79], a[48:63]
  v_exp_f32 v90, v90
  v_exp_f32 v91, v91
  v_cvt_pk_bf16_f32 v68, v88, v89
  v_fma_mix_f32 v92, v122, s41, -v29 op_sel:[0,0,0] op_sel_hi:[1,0,0]
  v_mfma_f32_16x16x32_bf16 a[228:231], a[232:235], v[76:79], a[228:231]
  v_fma_mix_f32 v93, v122, s41, -v29 op_sel:[1,0,0] op_sel_hi:[1,0,0]
  v_exp_f32 v92, v92
  v_mfma_f32_32x32x16_bf16 a[80:95], v[56:59], v[76:79], a[80:95]
  v_exp_f32 v93, v93
  v_cvt_pk_bf16_f32 v69, v90, v91
  v_fma_mix_f32 v94, v123, s41, -v29 op_sel:[0,0,0] op_sel_hi:[1,0,0]
  v_fma_mix_f32 v95, v123, s41, -v29 op_sel:[1,0,0] op_sel_hi:[1,0,0]
  v_exp_f32 v94, v94
  v_mfma_f32_32x32x16_bf16 a[112:127], v[60:63], v[76:79], a[112:127]
  v_exp_f32 v95, v95
  v_cvt_pk_bf16_f32 v70, v92, v93
  s_mov_b32 s16, s62
  s_mov_b32 s17, s63
  s_mov_b32 s18, 0x800000
  s_lshl_b32 s46, s2, 15
  s_lshl_b32 s47, s32, 13
  s_add_u32 s46, s46, s47
  s_waitcnt lgkmcnt(0)
  v_mfma_f32_32x32x16_bf16 a[0:15], v[32:35], v[64:67], a[0:15]
  v_cvt_pk_bf16_f32 v71, v94, v95
  ds_read_b128 v[48:51], v24 offset:45056
  ds_read_b128 v[52:55], v24 offset:46080
  ds_read_b128 v[56:59], v24 offset:47104
  ds_read_b128 v[60:63], v24 offset:48128
  v_fma_mix_f32 v80, v116, s41, -v28 op_sel:[0,0,0] op_sel_hi:[1,0,0]
  v_fma_mix_f32 v81, v116, s41, -v28 op_sel:[1,0,0] op_sel_hi:[1,0,0]
  v_exp_f32 v80, v80
  v_mfma_f32_32x32x16_bf16 a[32:47], v[36:39], v[64:67], a[32:47]
  v_exp_f32 v81, v81
  v_fma_mix_f32 v82, v117, s41, -v28 op_sel:[0,0,0] op_sel_hi:[1,0,0]
  v_fma_mix_f32 v83, v117, s41, -v28 op_sel:[1,0,0] op_sel_hi:[1,0,0]
  v_exp_f32 v82, v82
  v_mfma_f32_16x16x32_bf16 a[224:227], a[232:235], v[64:67], a[224:227]
  v_exp_f32 v83, v83
  v_mfma_f32_32x32x16_bf16 a[64:79], v[40:43], v[64:67], a[64:79]
  v_cvt_pk_bf16_f32 v72, v80, v81
  v_fma_mix_f32 v84, v118, s41, -v28 op_sel:[0,0,0] op_sel_hi:[1,0,0]
  v_fma_mix_f32 v85, v118, s41, -v28 op_sel:[1,0,0] op_sel_hi:[1,0,0]
  v_exp_f32 v84, v84
  v_exp_f32 v85, v85
  v_mfma_f32_32x32x16_bf16 a[96:111], v[44:47], v[64:67], a[96:111]
  v_cvt_pk_bf16_f32 v73, v82, v83
  v_fma_mix_f32 v86, v119, s41, -v28 op_sel:[0,0,0] op_sel_hi:[1,0,0]
  v_fma_mix_f32 v87, v119, s41, -v28 op_sel:[1,0,0] op_sel_hi:[1,0,0]
  v_exp_f32 v86, v86
  v_exp_f32 v87, v87
  v_mfma_f32_32x32x16_bf16 a[16:31], v[32:35], v[68:71], a[16:31]
  v_cvt_pk_bf16_f32 v74, v84, v85
  v_fma_mix_f32 v88, v124, s41, -v29 op_sel:[0,0,0] op_sel_hi:[1,0,0]
  v_fma_mix_f32 v89, v124, s41, -v29 op_sel:[1,0,0] op_sel_hi:[1,0,0]
  v_cvt_pk_bf16_f32 v75, v86, v87
  v_exp_f32 v88, v88
  v_exp_f32 v89, v89
  v_mfma_f32_32x32x16_bf16 a[48:63], v[36:39], v[68:71], a[48:63]
  v_fma_mix_f32 v90, v125, s41, -v29 op_sel:[0,0,0] op_sel_hi:[1,0,0]
  v_fma_mix_f32 v91, v125, s41, -v29 op_sel:[1,0,0] op_sel_hi:[1,0,0]
  v_exp_f32 v90, v90
  v_exp_f32 v91, v91
  v_mfma_f32_16x16x32_bf16 a[228:231], a[232:235], v[68:71], a[228:231]
  v_cvt_pk_bf16_f32 v76, v88, v89
  v_mfma_f32_32x32x16_bf16 a[80:95], v[40:43], v[68:71], a[80:95]
  v_fma_mix_f32 v92, v126, s41, -v29 op_sel:[0,0,0] op_sel_hi:[1,0,0]
  v_fma_mix_f32 v93, v126, s41, -v29 op_sel:[1,0,0] op_sel_hi:[1,0,0]
  v_exp_f32 v92, v92
  v_exp_f32 v93, v93
  v_cvt_pk_bf16_f32 v77, v90, v91
  v_fma_mix_f32 v94, v127, s41, -v29 op_sel:[0,0,0] op_sel_hi:[1,0,0]
  v_mfma_f32_32x32x16_bf16 a[112:127], v[44:47], v[68:71], a[112:127]
  v_fma_mix_f32 v95, v127, s41, -v29 op_sel:[1,0,0] op_sel_hi:[1,0,0]
  v_exp_f32 v94, v94
  v_exp_f32 v95, v95
  v_cvt_pk_bf16_f32 v78, v92, v93
  buffer_load_dwordx4 a[236:239], v24, s[16:19], s46 offen offset:0
  s_waitcnt lgkmcnt(0)
  v_mfma_f32_32x32x16_bf16 a[0:15], v[48:51], v[72:75], a[0:15]
  v_cvt_pk_bf16_f32 v79, v94, v95
  ds_read_b128 v[32:35], v24 offset:49152
  ds_read_b128 v[36:39], v24 offset:50176
  ds_read_b128 v[40:43], v24 offset:51200
  ds_read_b128 v[44:47], v24 offset:52224
  v_fma_mix_f32 v80, v128, s41, -v28 op_sel:[0,0,0] op_sel_hi:[1,0,0]
  v_fma_mix_f32 v81, v128, s41, -v28 op_sel:[1,0,0] op_sel_hi:[1,0,0]
  v_exp_f32 v80, v80
  v_mfma_f32_32x32x16_bf16 a[32:47], v[52:55], v[72:75], a[32:47]
  v_exp_f32 v81, v81
  v_fma_mix_f32 v82, v129, s41, -v28 op_sel:[0,0,0] op_sel_hi:[1,0,0]
  v_fma_mix_f32 v83, v129, s41, -v28 op_sel:[1,0,0] op_sel_hi:[1,0,0]
  v_exp_f32 v82, v82
  v_mfma_f32_16x16x32_bf16 a[224:227], a[232:235], v[72:75], a[224:227]
  v_exp_f32 v83, v83
  v_mfma_f32_32x32x16_bf16 a[64:79], v[56:59], v[72:75], a[64:79]
  v_cvt_pk_bf16_f32 v64, v80, v81
  v_fma_mix_f32 v84, v130, s41, -v28 op_sel:[0,0,0] op_sel_hi:[1,0,0]
  v_fma_mix_f32 v85, v130, s41, -v28 op_sel:[1,0,0] op_sel_hi:[1,0,0]
  v_exp_f32 v84, v84
  v_exp_f32 v85, v85
  v_mfma_f32_32x32x16_bf16 a[96:111], v[60:63], v[72:75], a[96:111]
  v_cvt_pk_bf16_f32 v65, v82, v83
  v_fma_mix_f32 v86, v131, s41, -v28 op_sel:[0,0,0] op_sel_hi:[1,0,0]
  v_fma_mix_f32 v87, v131, s41, -v28 op_sel:[1,0,0] op_sel_hi:[1,0,0]
  v_exp_f32 v86, v86
  v_exp_f32 v87, v87
  v_mfma_f32_32x32x16_bf16 a[16:31], v[48:51], v[76:79], a[16:31]
  v_cvt_pk_bf16_f32 v66, v84, v85
  v_fma_mix_f32 v88, v136, s41, -v29 op_sel:[0,0,0] op_sel_hi:[1,0,0]
  v_fma_mix_f32 v89, v136, s41, -v29 op_sel:[1,0,0] op_sel_hi:[1,0,0]
  v_cvt_pk_bf16_f32 v67, v86, v87
  v_exp_f32 v88, v88
  v_exp_f32 v89, v89
  v_mfma_f32_32x32x16_bf16 a[48:63], v[52:55], v[76:79], a[48:63]
  v_fma_mix_f32 v90, v137, s41, -v29 op_sel:[0,0,0] op_sel_hi:[1,0,0]
  v_fma_mix_f32 v91, v137, s41, -v29 op_sel:[1,0,0] op_sel_hi:[1,0,0]
  v_exp_f32 v90, v90
  v_exp_f32 v91, v91
  v_mfma_f32_16x16x32_bf16 a[228:231], a[232:235], v[76:79], a[228:231]
  v_cvt_pk_bf16_f32 v68, v88, v89
  v_mfma_f32_32x32x16_bf16 a[80:95], v[56:59], v[76:79], a[80:95]
  v_fma_mix_f32 v92, v138, s41, -v29 op_sel:[0,0,0] op_sel_hi:[1,0,0]
  v_fma_mix_f32 v93, v138, s41, -v29 op_sel:[1,0,0] op_sel_hi:[1,0,0]
  v_exp_f32 v92, v92
  v_exp_f32 v93, v93
  v_cvt_pk_bf16_f32 v69, v90, v91
  v_fma_mix_f32 v94, v139, s41, -v29 op_sel:[0,0,0] op_sel_hi:[1,0,0]
  v_mfma_f32_32x32x16_bf16 a[112:127], v[60:63], v[76:79], a[112:127]
  v_fma_mix_f32 v95, v139, s41, -v29 op_sel:[1,0,0] op_sel_hi:[1,0,0]
  v_exp_f32 v94, v94
  v_exp_f32 v95, v95
  v_cvt_pk_bf16_f32 v70, v92, v93
  buffer_load_dwordx4 a[236:239], v24, s[16:19], s46 offen offset:1024
  s_waitcnt lgkmcnt(0)
  v_mfma_f32_32x32x16_bf16 a[0:15], v[32:35], v[64:67], a[0:15]
  v_cvt_pk_bf16_f32 v71, v94, v95
  ds_read_b128 v[48:51], v24 offset:53248
  ds_read_b128 v[52:55], v24 offset:54272
  ds_read_b128 v[56:59], v24 offset:55296
  ds_read_b128 v[60:63], v24 offset:56320
  v_fma_mix_f32 v80, v132, s41, -v28 op_sel:[0,0,0] op_sel_hi:[1,0,0]
  v_fma_mix_f32 v81, v132, s41, -v28 op_sel:[1,0,0] op_sel_hi:[1,0,0]
  v_exp_f32 v80, v80
  v_mfma_f32_32x32x16_bf16 a[32:47], v[36:39], v[64:67], a[32:47]
  v_exp_f32 v81, v81
  v_fma_mix_f32 v82, v133, s41, -v28 op_sel:[0,0,0] op_sel_hi:[1,0,0]
  v_fma_mix_f32 v83, v133, s41, -v28 op_sel:[1,0,0] op_sel_hi:[1,0,0]
  v_exp_f32 v82, v82
  v_mfma_f32_16x16x32_bf16 a[224:227], a[232:235], v[64:67], a[224:227]
  v_exp_f32 v83, v83
  v_mfma_f32_32x32x16_bf16 a[64:79], v[40:43], v[64:67], a[64:79]
  v_cvt_pk_bf16_f32 v72, v80, v81
  v_fma_mix_f32 v84, v134, s41, -v28 op_sel:[0,0,0] op_sel_hi:[1,0,0]
  v_fma_mix_f32 v85, v134, s41, -v28 op_sel:[1,0,0] op_sel_hi:[1,0,0]
  v_exp_f32 v84, v84
  v_exp_f32 v85, v85
  v_mfma_f32_32x32x16_bf16 a[96:111], v[44:47], v[64:67], a[96:111]
  v_cvt_pk_bf16_f32 v73, v82, v83
  v_fma_mix_f32 v86, v135, s41, -v28 op_sel:[0,0,0] op_sel_hi:[1,0,0]
  v_fma_mix_f32 v87, v135, s41, -v28 op_sel:[1,0,0] op_sel_hi:[1,0,0]
  v_exp_f32 v86, v86
  v_exp_f32 v87, v87
  v_mfma_f32_32x32x16_bf16 a[16:31], v[32:35], v[68:71], a[16:31]
  v_cvt_pk_bf16_f32 v74, v84, v85
  v_fma_mix_f32 v88, v140, s41, -v29 op_sel:[0,0,0] op_sel_hi:[1,0,0]
  v_fma_mix_f32 v89, v140, s41, -v29 op_sel:[1,0,0] op_sel_hi:[1,0,0]
  v_cvt_pk_bf16_f32 v75, v86, v87
  v_exp_f32 v88, v88
  v_exp_f32 v89, v89
  v_mfma_f32_32x32x16_bf16 a[48:63], v[36:39], v[68:71], a[48:63]
  v_fma_mix_f32 v90, v141, s41, -v29 op_sel:[0,0,0] op_sel_hi:[1,0,0]
  v_fma_mix_f32 v91, v141, s41, -v29 op_sel:[1,0,0] op_sel_hi:[1,0,0]
  v_exp_f32 v90, v90
  v_exp_f32 v91, v91
  v_mfma_f32_16x16x32_bf16 a[228:231], a[232:235], v[68:71], a[228:231]
  v_cvt_pk_bf16_f32 v76, v88, v89
  v_mfma_f32_32x32x16_bf16 a[80:95], v[40:43], v[68:71], a[80:95]
  v_fma_mix_f32 v92, v142, s41, -v29 op_sel:[0,0,0] op_sel_hi:[1,0,0]
  v_fma_mix_f32 v93, v142, s41, -v29 op_sel:[1,0,0] op_sel_hi:[1,0,0]
  v_exp_f32 v92, v92
  v_exp_f32 v93, v93
  v_cvt_pk_bf16_f32 v77, v90, v91
  v_fma_mix_f32 v94, v143, s41, -v29 op_sel:[0,0,0] op_sel_hi:[1,0,0]
  v_mfma_f32_32x32x16_bf16 a[112:127], v[44:47], v[68:71], a[112:127]
  v_fma_mix_f32 v95, v143, s41, -v29 op_sel:[1,0,0] op_sel_hi:[1,0,0]
  v_exp_f32 v94, v94
  v_exp_f32 v95, v95
  v_cvt_pk_bf16_f32 v78, v92, v93
  buffer_load_dwordx4 a[236:239], v24, s[16:19], s46 offen offset:2048
  s_waitcnt lgkmcnt(0)
  v_mfma_f32_32x32x16_bf16 a[0:15], v[48:51], v[72:75], a[0:15]
  v_cvt_pk_bf16_f32 v79, v94, v95
  ds_read_b128 v[32:35], v24 offset:57344
  ds_read_b128 v[36:39], v24 offset:58368
  ds_read_b128 v[40:43], v24 offset:59392
  ds_read_b128 v[44:47], v24 offset:60416
  v_fma_mix_f32 v80, v144, s41, -v28 op_sel:[0,0,0] op_sel_hi:[1,0,0]
  v_fma_mix_f32 v81, v144, s41, -v28 op_sel:[1,0,0] op_sel_hi:[1,0,0]
  v_exp_f32 v80, v80
  v_mfma_f32_32x32x16_bf16 a[32:47], v[52:55], v[72:75], a[32:47]
  v_exp_f32 v81, v81
  v_fma_mix_f32 v82, v145, s41, -v28 op_sel:[0,0,0] op_sel_hi:[1,0,0]
  v_fma_mix_f32 v83, v145, s41, -v28 op_sel:[1,0,0] op_sel_hi:[1,0,0]
  v_exp_f32 v82, v82
  v_mfma_f32_16x16x32_bf16 a[224:227], a[232:235], v[72:75], a[224:227]
  v_exp_f32 v83, v83
  v_mfma_f32_32x32x16_bf16 a[64:79], v[56:59], v[72:75], a[64:79]
  v_cvt_pk_bf16_f32 v64, v80, v81
  v_fma_mix_f32 v84, v146, s41, -v28 op_sel:[0,0,0] op_sel_hi:[1,0,0]
  v_fma_mix_f32 v85, v146, s41, -v28 op_sel:[1,0,0] op_sel_hi:[1,0,0]
  v_exp_f32 v84, v84
  v_exp_f32 v85, v85
  v_mfma_f32_32x32x16_bf16 a[96:111], v[60:63], v[72:75], a[96:111]
  v_cvt_pk_bf16_f32 v65, v82, v83
  v_fma_mix_f32 v86, v147, s41, -v28 op_sel:[0,0,0] op_sel_hi:[1,0,0]
  v_fma_mix_f32 v87, v147, s41, -v28 op_sel:[1,0,0] op_sel_hi:[1,0,0]
  v_exp_f32 v86, v86
  v_exp_f32 v87, v87
  v_mfma_f32_32x32x16_bf16 a[16:31], v[48:51], v[76:79], a[16:31]
  v_cvt_pk_bf16_f32 v66, v84, v85
  v_fma_mix_f32 v88, v152, s41, -v29 op_sel:[0,0,0] op_sel_hi:[1,0,0]
  v_fma_mix_f32 v89, v152, s41, -v29 op_sel:[1,0,0] op_sel_hi:[1,0,0]
  v_cvt_pk_bf16_f32 v67, v86, v87
  v_exp_f32 v88, v88
  v_exp_f32 v89, v89
  v_mfma_f32_32x32x16_bf16 a[48:63], v[52:55], v[76:79], a[48:63]
  v_fma_mix_f32 v90, v153, s41, -v29 op_sel:[0,0,0] op_sel_hi:[1,0,0]
  v_fma_mix_f32 v91, v153, s41, -v29 op_sel:[1,0,0] op_sel_hi:[1,0,0]
  v_exp_f32 v90, v90
  v_exp_f32 v91, v91
  v_mfma_f32_16x16x32_bf16 a[228:231], a[232:235], v[76:79], a[228:231]
  v_cvt_pk_bf16_f32 v68, v88, v89
  v_mfma_f32_32x32x16_bf16 a[80:95], v[56:59], v[76:79], a[80:95]
  v_fma_mix_f32 v92, v154, s41, -v29 op_sel:[0,0,0] op_sel_hi:[1,0,0]
  v_fma_mix_f32 v93, v154, s41, -v29 op_sel:[1,0,0] op_sel_hi:[1,0,0]
  v_exp_f32 v92, v92
  v_exp_f32 v93, v93
  v_cvt_pk_bf16_f32 v69, v90, v91
  v_fma_mix_f32 v94, v155, s41, -v29 op_sel:[0,0,0] op_sel_hi:[1,0,0]
  v_mfma_f32_32x32x16_bf16 a[112:127], v[60:63], v[76:79], a[112:127]
  v_fma_mix_f32 v95, v155, s41, -v29 op_sel:[1,0,0] op_sel_hi:[1,0,0]
  v_exp_f32 v94, v94
  v_exp_f32 v95, v95
  v_cvt_pk_bf16_f32 v70, v92, v93
  buffer_load_dwordx4 a[236:239], v24, s[16:19], s46 offen offset:3072
  s_waitcnt lgkmcnt(0)
  v_mfma_f32_32x32x16_bf16 a[0:15], v[32:35], v[64:67], a[0:15]
  v_cvt_pk_bf16_f32 v71, v94, v95
  ds_read_b128 v[48:51], v24 offset:61440
  ds_read_b128 v[52:55], v24 offset:62464
  ds_read_b128 v[56:59], v24 offset:63488
  ds_read_b128 v[60:63], v24 offset:64512
  v_fma_mix_f32 v80, v148, s41, -v28 op_sel:[0,0,0] op_sel_hi:[1,0,0]
  v_fma_mix_f32 v81, v148, s41, -v28 op_sel:[1,0,0] op_sel_hi:[1,0,0]
  v_exp_f32 v80, v80
  v_mfma_f32_32x32x16_bf16 a[32:47], v[36:39], v[64:67], a[32:47]
  v_exp_f32 v81, v81
  v_fma_mix_f32 v82, v149, s41, -v28 op_sel:[0,0,0] op_sel_hi:[1,0,0]
  v_fma_mix_f32 v83, v149, s41, -v28 op_sel:[1,0,0] op_sel_hi:[1,0,0]
  v_exp_f32 v82, v82
  v_mfma_f32_16x16x32_bf16 a[224:227], a[232:235], v[64:67], a[224:227]
  v_exp_f32 v83, v83
  v_mfma_f32_32x32x16_bf16 a[64:79], v[40:43], v[64:67], a[64:79]
  v_cvt_pk_bf16_f32 v72, v80, v81
  v_fma_mix_f32 v84, v150, s41, -v28 op_sel:[0,0,0] op_sel_hi:[1,0,0]
  v_fma_mix_f32 v85, v150, s41, -v28 op_sel:[1,0,0] op_sel_hi:[1,0,0]
  v_exp_f32 v84, v84
  v_exp_f32 v85, v85
  v_mfma_f32_32x32x16_bf16 a[96:111], v[44:47], v[64:67], a[96:111]
  v_cvt_pk_bf16_f32 v73, v82, v83
  v_fma_mix_f32 v86, v151, s41, -v28 op_sel:[0,0,0] op_sel_hi:[1,0,0]
  v_fma_mix_f32 v87, v151, s41, -v28 op_sel:[1,0,0] op_sel_hi:[1,0,0]
  v_exp_f32 v86, v86
  v_exp_f32 v87, v87
  v_cvt_pk_bf16_f32 v74, v84, v85
  v_mfma_f32_32x32x16_bf16 a[16:31], v[32:35], v[68:71], a[16:31]
  v_fma_mix_f32 v88, v156, s41, -v29 op_sel:[0,0,0] op_sel_hi:[1,0,0]
  v_fma_mix_f32 v89, v156, s41, -v29 op_sel:[1,0,0] op_sel_hi:[1,0,0]
  v_cvt_pk_bf16_f32 v75, v86, v87
  v_exp_f32 v88, v88
  v_exp_f32 v89, v89
  v_mfma_f32_32x32x16_bf16 a[48:63], v[36:39], v[68:71], a[48:63]
  v_fma_mix_f32 v90, v157, s41, -v29 op_sel:[0,0,0] op_sel_hi:[1,0,0]
  v_fma_mix_f32 v91, v157, s41, -v29 op_sel:[1,0,0] op_sel_hi:[1,0,0]
  v_exp_f32 v90, v90
  v_exp_f32 v91, v91
  v_mfma_f32_16x16x32_bf16 a[228:231], a[232:235], v[68:71], a[228:231]
  v_cvt_pk_bf16_f32 v76, v88, v89
  v_fma_mix_f32 v92, v158, s41, -v29 op_sel:[0,0,0] op_sel_hi:[1,0,0]
  v_mfma_f32_32x32x16_bf16 a[80:95], v[40:43], v[68:71], a[80:95]
  v_fma_mix_f32 v93, v158, s41, -v29 op_sel:[1,0,0] op_sel_hi:[1,0,0]
  v_exp_f32 v92, v92
  v_exp_f32 v93, v93
  v_cvt_pk_bf16_f32 v77, v90, v91
  v_fma_mix_f32 v94, v159, s41, -v29 op_sel:[0,0,0] op_sel_hi:[1,0,0]
  v_mfma_f32_32x32x16_bf16 a[112:127], v[44:47], v[68:71], a[112:127]
  v_fma_mix_f32 v95, v159, s41, -v29 op_sel:[1,0,0] op_sel_hi:[1,0,0]
  v_exp_f32 v94, v94
  v_exp_f32 v95, v95
  v_cvt_pk_bf16_f32 v78, v92, v93
  s_add_u32 s46, s46, 4096
  buffer_load_dwordx4 a[236:239], v24, s[16:19], s46 offen offset:0
  s_waitcnt lgkmcnt(0)
  v_mfma_f32_32x32x16_bf16 a[0:15], v[48:51], v[72:75], a[0:15]
  v_cvt_pk_bf16_f32 v79, v94, v95
  ds_read_b128 v[32:35], v17 offset:0
  ds_read_b128 v[36:39], v17 offset:1024
  ds_read_b128 v[40:43], v17 offset:2048
  ds_read_b128 v[44:47], v17 offset:3072
  v_fma_mix_f32 v80, v160, s41, -v28 op_sel:[0,0,0] op_sel_hi:[1,0,0]
  v_fma_mix_f32 v81, v160, s41, -v28 op_sel:[1,0,0] op_sel_hi:[1,0,0]
  v_exp_f32 v80, v80
  v_mfma_f32_32x32x16_bf16 a[32:47], v[52:55], v[72:75], a[32:47]
  v_exp_f32 v81, v81
  v_fma_mix_f32 v82, v161, s41, -v28 op_sel:[0,0,0] op_sel_hi:[1,0,0]
  v_fma_mix_f32 v83, v161, s41, -v28 op_sel:[1,0,0] op_sel_hi:[1,0,0]
  v_exp_f32 v82, v82
  v_mfma_f32_16x16x32_bf16 a[224:227], a[232:235], v[72:75], a[224:227]
  v_exp_f32 v83, v83
  v_mfma_f32_32x32x16_bf16 a[64:79], v[56:59], v[72:75], a[64:79]
  v_cvt_pk_bf16_f32 v64, v80, v81
  v_fma_mix_f32 v84, v162, s41, -v28 op_sel:[0,0,0] op_sel_hi:[1,0,0]
  v_fma_mix_f32 v85, v162, s41, -v28 op_sel:[1,0,0] op_sel_hi:[1,0,0]
  v_exp_f32 v84, v84
  v_exp_f32 v85, v85
  v_mfma_f32_32x32x16_bf16 a[96:111], v[60:63], v[72:75], a[96:111]
  v_cvt_pk_bf16_f32 v65, v82, v83
  v_fma_mix_f32 v86, v163, s41, -v28 op_sel:[0,0,0] op_sel_hi:[1,0,0]
  v_fma_mix_f32 v87, v163, s41, -v28 op_sel:[1,0,0] op_sel_hi:[1,0,0]
  v_exp_f32 v86, v86
  v_exp_f32 v87, v87
  v_mfma_f32_32x32x16_bf16 a[16:31], v[48:51], v[76:79], a[16:31]
  v_cvt_pk_bf16_f32 v66, v84, v85
  v_fma_mix_f32 v88, v168, s41, -v29 op_sel:[0,0,0] op_sel_hi:[1,0,0]
  v_fma_mix_f32 v89, v168, s41, -v29 op_sel:[1,0,0] op_sel_hi:[1,0,0]
  v_cvt_pk_bf16_f32 v67, v86, v87
  v_exp_f32 v88, v88
  v_exp_f32 v89, v89
  v_mfma_f32_32x32x16_bf16 a[48:63], v[52:55], v[76:79], a[48:63]
  v_fma_mix_f32 v90, v169, s41, -v29 op_sel:[0,0,0] op_sel_hi:[1,0,0]
  v_fma_mix_f32 v91, v169, s41, -v29 op_sel:[1,0,0] op_sel_hi:[1,0,0]
  v_exp_f32 v90, v90
  v_exp_f32 v91, v91
  v_mfma_f32_16x16x32_bf16 a[228:231], a[232:235], v[76:79], a[228:231]
  v_cvt_pk_bf16_f32 v68, v88, v89
  v_mfma_f32_32x32x16_bf16 a[80:95], v[56:59], v[76:79], a[80:95]
  v_fma_mix_f32 v92, v170, s41, -v29 op_sel:[0,0,0] op_sel_hi:[1,0,0]
  v_fma_mix_f32 v93, v170, s41, -v29 op_sel:[1,0,0] op_sel_hi:[1,0,0]
  v_exp_f32 v92, v92
  v_exp_f32 v93, v93
  v_cvt_pk_bf16_f32 v69, v90, v91
  v_fma_mix_f32 v94, v171, s41, -v29 op_sel:[0,0,0] op_sel_hi:[1,0,0]
  v_mfma_f32_32x32x16_bf16 a[112:127], v[60:63], v[76:79], a[112:127]
  v_fma_mix_f32 v95, v171, s41, -v29 op_sel:[1,0,0] op_sel_hi:[1,0,0]
  v_exp_f32 v94, v94
  v_exp_f32 v95, v95
  v_cvt_pk_bf16_f32 v70, v92, v93
  buffer_load_dwordx4 a[236:239], v24, s[16:19], s46 offen offset:1024
  s_waitcnt lgkmcnt(0)
  v_mfma_f32_32x32x16_bf16 a[0:15], v[32:35], v[64:67], a[0:15]
  v_cvt_pk_bf16_f32 v71, v94, v95
  ds_read_b128 v[48:51], v17 offset:4096
  ds_read_b128 v[52:55], v17 offset:5120
  ds_read_b128 v[56:59], v17 offset:6144
  ds_read_b128 v[60:63], v17 offset:7168
  v_fma_mix_f32 v80, v164, s41, -v28 op_sel:[0,0,0] op_sel_hi:[1,0,0]
  v_fma_mix_f32 v81, v164, s41, -v28 op_sel:[1,0,0] op_sel_hi:[1,0,0]
  v_exp_f32 v80, v80
  v_mfma_f32_32x32x16_bf16 a[32:47], v[36:39], v[64:67], a[32:47]
  v_exp_f32 v81, v81
  v_fma_mix_f32 v82, v165, s41, -v28 op_sel:[0,0,0] op_sel_hi:[1,0,0]
  v_fma_mix_f32 v83, v165, s41, -v28 op_sel:[1,0,0] op_sel_hi:[1,0,0]
  v_exp_f32 v82, v82
  v_mfma_f32_16x16x32_bf16 a[224:227], a[232:235], v[64:67], a[224:227]
  v_exp_f32 v83, v83
  v_mfma_f32_32x32x16_bf16 a[64:79], v[40:43], v[64:67], a[64:79]
  v_cvt_pk_bf16_f32 v72, v80, v81
  v_fma_mix_f32 v84, v166, s41, -v28 op_sel:[0,0,0] op_sel_hi:[1,0,0]
  v_fma_mix_f32 v85, v166, s41, -v28 op_sel:[1,0,0] op_sel_hi:[1,0,0]
  v_exp_f32 v84, v84
  v_exp_f32 v85, v85
  v_mfma_f32_32x32x16_bf16 a[96:111], v[44:47], v[64:67], a[96:111]
  v_cvt_pk_bf16_f32 v73, v82, v83
  v_fma_mix_f32 v86, v167, s41, -v28 op_sel:[0,0,0] op_sel_hi:[1,0,0]
  v_fma_mix_f32 v87, v167, s41, -v28 op_sel:[1,0,0] op_sel_hi:[1,0,0]
  v_exp_f32 v86, v86
  v_exp_f32 v87, v87
  v_mfma_f32_32x32x16_bf16 a[16:31], v[32:35], v[68:71], a[16:31]
  v_cvt_pk_bf16_f32 v74, v84, v85
  v_fma_mix_f32 v88, v172, s41, -v29 op_sel:[0,0,0] op_sel_hi:[1,0,0]
  v_fma_mix_f32 v89, v172, s41, -v29 op_sel:[1,0,0] op_sel_hi:[1,0,0]
  v_cvt_pk_bf16_f32 v75, v86, v87
  v_exp_f32 v88, v88
  v_exp_f32 v89, v89
  v_mfma_f32_32x32x16_bf16 a[48:63], v[36:39], v[68:71], a[48:63]
  v_fma_mix_f32 v90, v173, s41, -v29 op_sel:[0,0,0] op_sel_hi:[1,0,0]
  v_fma_mix_f32 v91, v173, s41, -v29 op_sel:[1,0,0] op_sel_hi:[1,0,0]
  v_exp_f32 v90, v90
  v_exp_f32 v91, v91
  v_mfma_f32_16x16x32_bf16 a[228:231], a[232:235], v[68:71], a[228:231]
  v_cvt_pk_bf16_f32 v76, v88, v89
  v_mfma_f32_32x32x16_bf16 a[80:95], v[40:43], v[68:71], a[80:95]
  v_fma_mix_f32 v92, v174, s41, -v29 op_sel:[0,0,0] op_sel_hi:[1,0,0]
  v_fma_mix_f32 v93, v174, s41, -v29 op_sel:[1,0,0] op_sel_hi:[1,0,0]
  v_exp_f32 v92, v92
  v_exp_f32 v93, v93
  v_cvt_pk_bf16_f32 v77, v90, v91
  v_fma_mix_f32 v94, v175, s41, -v29 op_sel:[0,0,0] op_sel_hi:[1,0,0]
  v_mfma_f32_32x32x16_bf16 a[112:127], v[44:47], v[68:71], a[112:127]
  v_fma_mix_f32 v95, v175, s41, -v29 op_sel:[1,0,0] op_sel_hi:[1,0,0]
  v_exp_f32 v94, v94
  v_exp_f32 v95, v95
  v_cvt_pk_bf16_f32 v78, v92, v93
  buffer_load_dwordx4 a[236:239], v24, s[16:19], s46 offen offset:2048
  s_waitcnt lgkmcnt(0)
  v_mfma_f32_32x32x16_bf16 a[0:15], v[48:51], v[72:75], a[0:15]
  v_cvt_pk_bf16_f32 v79, v94, v95
  ds_read_b128 v[32:35], v17 offset:8192
  ds_read_b128 v[36:39], v17 offset:9216
  ds_read_b128 v[40:43], v17 offset:10240
  ds_read_b128 v[44:47], v17 offset:11264
  v_fma_mix_f32 v80, v176, s41, -v28 op_sel:[0,0,0] op_sel_hi:[1,0,0]
  v_fma_mix_f32 v81, v176, s41, -v28 op_sel:[1,0,0] op_sel_hi:[1,0,0]
  v_exp_f32 v80, v80
  v_mfma_f32_32x32x16_bf16 a[32:47], v[52:55], v[72:75], a[32:47]
  v_exp_f32 v81, v81
  v_fma_mix_f32 v82, v177, s41, -v28 op_sel:[0,0,0] op_sel_hi:[1,0,0]
  v_fma_mix_f32 v83, v177, s41, -v28 op_sel:[1,0,0] op_sel_hi:[1,0,0]
  v_exp_f32 v82, v82
  v_mfma_f32_16x16x32_bf16 a[224:227], a[232:235], v[72:75], a[224:227]
  v_exp_f32 v83, v83
  v_mfma_f32_32x32x16_bf16 a[64:79], v[56:59], v[72:75], a[64:79]
  v_cvt_pk_bf16_f32 v64, v80, v81
  v_fma_mix_f32 v84, v178, s41, -v28 op_sel:[0,0,0] op_sel_hi:[1,0,0]
  v_fma_mix_f32 v85, v178, s41, -v28 op_sel:[1,0,0] op_sel_hi:[1,0,0]
  v_exp_f32 v84, v84
  v_exp_f32 v85, v85
  v_mfma_f32_32x32x16_bf16 a[96:111], v[60:63], v[72:75], a[96:111]
  v_cvt_pk_bf16_f32 v65, v82, v83
  v_fma_mix_f32 v86, v179, s41, -v28 op_sel:[0,0,0] op_sel_hi:[1,0,0]
  v_fma_mix_f32 v87, v179, s41, -v28 op_sel:[1,0,0] op_sel_hi:[1,0,0]
  v_exp_f32 v86, v86
  v_exp_f32 v87, v87
  v_mfma_f32_32x32x16_bf16 a[16:31], v[48:51], v[76:79], a[16:31]
  v_cvt_pk_bf16_f32 v66, v84, v85
  v_fma_mix_f32 v88, v184, s41, -v29 op_sel:[0,0,0] op_sel_hi:[1,0,0]
  v_fma_mix_f32 v89, v184, s41, -v29 op_sel:[1,0,0] op_sel_hi:[1,0,0]
  v_cvt_pk_bf16_f32 v67, v86, v87
  v_exp_f32 v88, v88
  v_exp_f32 v89, v89
  v_mfma_f32_32x32x16_bf16 a[48:63], v[52:55], v[76:79], a[48:63]
  v_fma_mix_f32 v90, v185, s41, -v29 op_sel:[0,0,0] op_sel_hi:[1,0,0]
  v_fma_mix_f32 v91, v185, s41, -v29 op_sel:[1,0,0] op_sel_hi:[1,0,0]
  v_exp_f32 v90, v90
  v_exp_f32 v91, v91
  v_mfma_f32_16x16x32_bf16 a[228:231], a[232:235], v[76:79], a[228:231]
  v_cvt_pk_bf16_f32 v68, v88, v89
  v_mfma_f32_32x32x16_bf16 a[80:95], v[56:59], v[76:79], a[80:95]
  v_fma_mix_f32 v92, v186, s41, -v29 op_sel:[0,0,0] op_sel_hi:[1,0,0]
  v_fma_mix_f32 v93, v186, s41, -v29 op_sel:[1,0,0] op_sel_hi:[1,0,0]
  v_exp_f32 v92, v92
  v_exp_f32 v93, v93
  v_cvt_pk_bf16_f32 v69, v90, v91
  v_fma_mix_f32 v94, v187, s41, -v29 op_sel:[0,0,0] op_sel_hi:[1,0,0]
  v_mfma_f32_32x32x16_bf16 a[112:127], v[60:63], v[76:79], a[112:127]
  v_fma_mix_f32 v95, v187, s41, -v29 op_sel:[1,0,0] op_sel_hi:[1,0,0]
  v_exp_f32 v94, v94
  v_exp_f32 v95, v95
  v_cvt_pk_bf16_f32 v70, v92, v93
  buffer_load_dwordx4 a[236:239], v24, s[16:19], s46 offen offset:3072
  s_waitcnt lgkmcnt(0)
  v_mfma_f32_32x32x16_bf16 a[0:15], v[32:35], v[64:67], a[0:15]
  v_cvt_pk_bf16_f32 v71, v94, v95
  ds_read_b128 v[48:51], v17 offset:12288
  ds_read_b128 v[52:55], v17 offset:13312
  ds_read_b128 v[56:59], v17 offset:14336
  ds_read_b128 v[60:63], v17 offset:15360
  v_fma_mix_f32 v80, v180, s41, -v28 op_sel:[0,0,0] op_sel_hi:[1,0,0]
  v_fma_mix_f32 v81, v180, s41, -v28 op_sel:[1,0,0] op_sel_hi:[1,0,0]
  v_exp_f32 v80, v80
  v_mfma_f32_32x32x16_bf16 a[32:47], v[36:39], v[64:67], a[32:47]
  v_exp_f32 v81, v81
  v_fma_mix_f32 v82, v181, s41, -v28 op_sel:[0,0,0] op_sel_hi:[1,0,0]
  v_fma_mix_f32 v83, v181, s41, -v28 op_sel:[1,0,0] op_sel_hi:[1,0,0]
  v_exp_f32 v82, v82
  v_mfma_f32_16x16x32_bf16 a[224:227], a[232:235], v[64:67], a[224:227]
  v_exp_f32 v83, v83
  v_mfma_f32_32x32x16_bf16 a[64:79], v[40:43], v[64:67], a[64:79]
  v_cvt_pk_bf16_f32 v72, v80, v81
  v_fma_mix_f32 v84, v182, s41, -v28 op_sel:[0,0,0] op_sel_hi:[1,0,0]
  v_fma_mix_f32 v85, v182, s41, -v28 op_sel:[1,0,0] op_sel_hi:[1,0,0]
  v_exp_f32 v84, v84
  v_exp_f32 v85, v85
  v_cvt_pk_bf16_f32 v73, v82, v83
  v_mfma_f32_32x32x16_bf16 a[96:111], v[44:47], v[64:67], a[96:111]
  v_fma_mix_f32 v86, v183, s41, -v28 op_sel:[0,0,0] op_sel_hi:[1,0,0]
  v_fma_mix_f32 v87, v183, s41, -v28 op_sel:[1,0,0] op_sel_hi:[1,0,0]
  v_exp_f32 v86, v86
  v_exp_f32 v87, v87
  v_cvt_pk_bf16_f32 v74, v84, v85
  v_fma_mix_f32 v88, v188, s41, -v29 op_sel:[0,0,0] op_sel_hi:[1,0,0]
  v_fma_mix_f32 v89, v188, s41, -v29 op_sel:[1,0,0] op_sel_hi:[1,0,0]
  v_mfma_f32_32x32x16_bf16 a[16:31], v[32:35], v[68:71], a[16:31]
  v_cvt_pk_bf16_f32 v75, v86, v87
  v_exp_f32 v88, v88
  v_exp_f32 v89, v89
  v_fma_mix_f32 v90, v189, s41, -v29 op_sel:[0,0,0] op_sel_hi:[1,0,0]
  v_fma_mix_f32 v91, v189, s41, -v29 op_sel:[1,0,0] op_sel_hi:[1,0,0]
  v_mfma_f32_32x32x16_bf16 a[48:63], v[36:39], v[68:71], a[48:63]
  v_exp_f32 v90, v90
  v_exp_f32 v91, v91
  v_cvt_pk_bf16_f32 v76, v88, v89
  v_fma_mix_f32 v92, v190, s41, -v29 op_sel:[0,0,0] op_sel_hi:[1,0,0]
  v_mfma_f32_16x16x32_bf16 a[228:231], a[232:235], v[68:71], a[228:231]
  v_fma_mix_f32 v93, v190, s41, -v29 op_sel:[1,0,0] op_sel_hi:[1,0,0]
  v_exp_f32 v92, v92
  v_mfma_f32_32x32x16_bf16 a[80:95], v[40:43], v[68:71], a[80:95]
  v_exp_f32 v93, v93
  v_cvt_pk_bf16_f32 v77, v90, v91
  v_fma_mix_f32 v94, v191, s41, -v29 op_sel:[0,0,0] op_sel_hi:[1,0,0]
  v_fma_mix_f32 v95, v191, s41, -v29 op_sel:[1,0,0] op_sel_hi:[1,0,0]
  v_exp_f32 v94, v94
  v_mfma_f32_32x32x16_bf16 a[112:127], v[44:47], v[68:71], a[112:127]
  v_exp_f32 v95, v95
  v_cvt_pk_bf16_f32 v78, v92, v93
  s_mov_b32 s16, s36
  s_mov_b32 s17, s37
  s_mov_b32 s18, 0xe0000
  s_lshl_b32 s46, s2, 12
  s_lshl_b32 s47, s32, 10
  s_add_u32 s46, s46, s47
  s_waitcnt lgkmcnt(0)
  v_mfma_f32_32x32x16_bf16 a[0:15], v[48:51], v[72:75], a[0:15]
  v_cvt_pk_bf16_f32 v79, v94, v95
  ds_read_b128 v[32:35], v17 offset:16384
  ds_read_b128 v[36:39], v17 offset:17408
  ds_read_b128 v[40:43], v17 offset:18432
  ds_read_b128 v[44:47], v17 offset:19456
  v_fma_mix_f32 v80, v192, s41, -v28 op_sel:[0,0,0] op_sel_hi:[1,0,0]
  v_fma_mix_f32 v81, v192, s41, -v28 op_sel:[1,0,0] op_sel_hi:[1,0,0]
  v_exp_f32 v80, v80
  v_mfma_f32_32x32x16_bf16 a[32:47], v[52:55], v[72:75], a[32:47]
  v_exp_f32 v81, v81
  v_fma_mix_f32 v82, v193, s41, -v28 op_sel:[0,0,0] op_sel_hi:[1,0,0]
  v_fma_mix_f32 v83, v193, s41, -v28 op_sel:[1,0,0] op_sel_hi:[1,0,0]
  v_exp_f32 v82, v82
  v_mfma_f32_16x16x32_bf16 a[224:227], a[232:235], v[72:75], a[224:227]
  v_exp_f32 v83, v83
  v_mfma_f32_32x32x16_bf16 a[64:79], v[56:59], v[72:75], a[64:79]
  v_cvt_pk_bf16_f32 v64, v80, v81
  v_fma_mix_f32 v84, v194, s41, -v28 op_sel:[0,0,0] op_sel_hi:[1,0,0]
  v_fma_mix_f32 v85, v194, s41, -v28 op_sel:[1,0,0] op_sel_hi:[1,0,0]
  v_exp_f32 v84, v84
  v_exp_f32 v85, v85
  v_mfma_f32_32x32x16_bf16 a[96:111], v[60:63], v[72:75], a[96:111]
  v_cvt_pk_bf16_f32 v65, v82, v83
  v_fma_mix_f32 v86, v195, s41, -v28 op_sel:[0,0,0] op_sel_hi:[1,0,0]
  v_fma_mix_f32 v87, v195, s41, -v28 op_sel:[1,0,0] op_sel_hi:[1,0,0]
  v_exp_f32 v86, v86
  v_exp_f32 v87, v87
  v_mfma_f32_32x32x16_bf16 a[16:31], v[48:51], v[76:79], a[16:31]
  v_cvt_pk_bf16_f32 v66, v84, v85
  v_fma_mix_f32 v88, v200, s41, -v29 op_sel:[0,0,0] op_sel_hi:[1,0,0]
  v_fma_mix_f32 v89, v200, s41, -v29 op_sel:[1,0,0] op_sel_hi:[1,0,0]
  v_cvt_pk_bf16_f32 v67, v86, v87
  v_exp_f32 v88, v88
  v_exp_f32 v89, v89
  v_mfma_f32_32x32x16_bf16 a[48:63], v[52:55], v[76:79], a[48:63]
  v_fma_mix_f32 v90, v201, s41, -v29 op_sel:[0,0,0] op_sel_hi:[1,0,0]
  v_fma_mix_f32 v91, v201, s41, -v29 op_sel:[1,0,0] op_sel_hi:[1,0,0]
  v_exp_f32 v90, v90
  v_exp_f32 v91, v91
  v_mfma_f32_16x16x32_bf16 a[228:231], a[232:235], v[76:79], a[228:231]
  v_cvt_pk_bf16_f32 v68, v88, v89
  v_mfma_f32_32x32x16_bf16 a[80:95], v[56:59], v[76:79], a[80:95]
  v_fma_mix_f32 v92, v202, s41, -v29 op_sel:[0,0,0] op_sel_hi:[1,0,0]
  v_fma_mix_f32 v93, v202, s41, -v29 op_sel:[1,0,0] op_sel_hi:[1,0,0]
  v_exp_f32 v92, v92
  v_exp_f32 v93, v93
  v_cvt_pk_bf16_f32 v69, v90, v91
  v_fma_mix_f32 v94, v203, s41, -v29 op_sel:[0,0,0] op_sel_hi:[1,0,0]
  v_mfma_f32_32x32x16_bf16 a[112:127], v[60:63], v[76:79], a[112:127]
  v_fma_mix_f32 v95, v203, s41, -v29 op_sel:[1,0,0] op_sel_hi:[1,0,0]
  v_exp_f32 v94, v94
  v_exp_f32 v95, v95
  v_cvt_pk_bf16_f32 v70, v92, v93
  buffer_load_dwordx4 a[236:239], v24, s[16:19], s46 offen offset:0
  s_waitcnt lgkmcnt(0)
  v_mfma_f32_32x32x16_bf16 a[0:15], v[32:35], v[64:67], a[0:15]
  v_cvt_pk_bf16_f32 v71, v94, v95
  ds_read_b128 v[48:51], v17 offset:20480
  ds_read_b128 v[52:55], v17 offset:21504
  ds_read_b128 v[56:59], v17 offset:22528
  ds_read_b128 v[60:63], v17 offset:23552
  v_fma_mix_f32 v80, v196, s41, -v28 op_sel:[0,0,0] op_sel_hi:[1,0,0]
  v_fma_mix_f32 v81, v196, s41, -v28 op_sel:[1,0,0] op_sel_hi:[1,0,0]
  v_exp_f32 v80, v80
  v_mfma_f32_32x32x16_bf16 a[32:47], v[36:39], v[64:67], a[32:47]
  v_exp_f32 v81, v81
  v_fma_mix_f32 v82, v197, s41, -v28 op_sel:[0,0,0] op_sel_hi:[1,0,0]
  v_fma_mix_f32 v83, v197, s41, -v28 op_sel:[1,0,0] op_sel_hi:[1,0,0]
  v_exp_f32 v82, v82
  v_mfma_f32_16x16x32_bf16 a[224:227], a[232:235], v[64:67], a[224:227]
  v_exp_f32 v83, v83
  v_cvt_pk_bf16_f32 v72, v80, v81
  v_mfma_f32_32x32x16_bf16 a[64:79], v[40:43], v[64:67], a[64:79]
  v_fma_mix_f32 v84, v198, s41, -v28 op_sel:[0,0,0] op_sel_hi:[1,0,0]
  v_fma_mix_f32 v85, v198, s41, -v28 op_sel:[1,0,0] op_sel_hi:[1,0,0]
  v_exp_f32 v84, v84
  v_exp_f32 v85, v85
  v_cvt_pk_bf16_f32 v73, v82, v83
  v_fma_mix_f32 v86, v199, s41, -v28 op_sel:[0,0,0] op_sel_hi:[1,0,0]
  v_fma_mix_f32 v87, v199, s41, -v28 op_sel:[1,0,0] op_sel_hi:[1,0,0]
  v_mfma_f32_32x32x16_bf16 a[96:111], v[44:47], v[64:67], a[96:111]
  v_exp_f32 v86, v86
  v_exp_f32 v87, v87
  v_cvt_pk_bf16_f32 v74, v84, v85
  v_fma_mix_f32 v88, v204, s41, -v29 op_sel:[0,0,0] op_sel_hi:[1,0,0]
  v_fma_mix_f32 v89, v204, s41, -v29 op_sel:[1,0,0] op_sel_hi:[1,0,0]
  v_cvt_pk_bf16_f32 v75, v86, v87
  v_mfma_f32_32x32x16_bf16 a[16:31], v[32:35], v[68:71], a[16:31]
  v_exp_f32 v88, v88
  v_exp_f32 v89, v89
  v_fma_mix_f32 v90, v205, s41, -v29 op_sel:[0,0,0] op_sel_hi:[1,0,0]
  v_fma_mix_f32 v91, v205, s41, -v29 op_sel:[1,0,0] op_sel_hi:[1,0,0]
  v_exp_f32 v90, v90
  v_exp_f32 v91, v91
  v_mfma_f32_32x32x16_bf16 a[48:63], v[36:39], v[68:71], a[48:63]
  v_cvt_pk_bf16_f32 v76, v88, v89
  v_fma_mix_f32 v92, v206, s41, -v29 op_sel:[0,0,0] op_sel_hi:[1,0,0]
  v_fma_mix_f32 v93, v206, s41, -v29 op_sel:[1,0,0] op_sel_hi:[1,0,0]
  v_exp_f32 v92, v92
  v_exp_f32 v93, v93
  v_mfma_f32_16x16x32_bf16 a[228:231], a[232:235], v[68:71], a[228:231]
  v_cvt_pk_bf16_f32 v77, v90, v91
  v_mfma_f32_32x32x16_bf16 a[80:95], v[40:43], v[68:71], a[80:95]
  v_fma_mix_f32 v94, v207, s41, -v29 op_sel:[0,0,0] op_sel_hi:[1,0,0]
  v_fma_mix_f32 v95, v207, s41, -v29 op_sel:[1,0,0] op_sel_hi:[1,0,0]
  v_exp_f32 v94, v94
  v_exp_f32 v95, v95
  v_cvt_pk_bf16_f32 v78, v92, v93
  v_mfma_f32_32x32x16_bf16 a[112:127], v[44:47], v[68:71], a[112:127]
  s_mov_b32 s16, s60
  s_mov_b32 s17, s61
  s_mov_b32 s18, 0x1c0000
  s_lshr_b32 s46, s2, 3
  s_lshl_b32 s46, s46, 2
  s_add_u32 s46, s46, s32
  s_mul_i32 s46, s46, 14336
  s_and_b32 s47, s2, 1
  s_mul_i32 s47, s47, 1792
  s_add_u32 s46, s46, s47
  s_waitcnt lgkmcnt(0)
  v_mfma_f32_32x32x16_bf16 a[0:15], v[48:51], v[72:75], a[0:15]
  v_cvt_pk_bf16_f32 v79, v94, v95
  ds_read_b128 v[32:35], v17 offset:24576
  ds_read_b128 v[36:39], v17 offset:25600
  ds_read_b128 v[40:43], v17 offset:26624
  ds_read_b128 v[44:47], v17 offset:27648
  v_fma_mix_f32 v80, v208, s41, -v28 op_sel:[0,0,0] op_sel_hi:[1,0,0]
  v_fma_mix_f32 v81, v208, s41, -v28 op_sel:[1,0,0] op_sel_hi:[1,0,0]
  v_exp_f32 v80, v80
  v_mfma_f32_32x32x16_bf16 a[32:47], v[52:55], v[72:75], a[32:47]
  v_exp_f32 v81, v81
  v_fma_mix_f32 v82, v209, s41, -v28 op_sel:[0,0,0] op_sel_hi:[1,0,0]
  v_fma_mix_f32 v83, v209, s41, -v28 op_sel:[1,0,0] op_sel_hi:[1,0,0]
  v_exp_f32 v82, v82
  v_mfma_f32_16x16x32_bf16 a[224:227], a[232:235], v[72:75], a[224:227]
  v_exp_f32 v83, v83
  v_mfma_f32_32x32x16_bf16 a[64:79], v[56:59], v[72:75], a[64:79]
  v_cvt_pk_bf16_f32 v64, v80, v81
  v_fma_mix_f32 v84, v210, s41, -v28 op_sel:[0,0,0] op_sel_hi:[1,0,0]
  v_fma_mix_f32 v85, v210, s41, -v28 op_sel:[1,0,0] op_sel_hi:[1,0,0]
  v_exp_f32 v84, v84
  v_exp_f32 v85, v85
  v_mfma_f32_32x32x16_bf16 a[96:111], v[60:63], v[72:75], a[96:111]
  v_cvt_pk_bf16_f32 v65, v82, v83
  v_fma_mix_f32 v86, v211, s41, -v28 op_sel:[0,0,0] op_sel_hi:[1,0,0]
  v_fma_mix_f32 v87, v211, s41, -v28 op_sel:[1,0,0] op_sel_hi:[1,0,0]
  v_exp_f32 v86, v86
  v_exp_f32 v87, v87
  v_mfma_f32_32x32x16_bf16 a[16:31], v[48:51], v[76:79], a[16:31]
  v_cvt_pk_bf16_f32 v66, v84, v85
  v_fma_mix_f32 v88, v216, s41, -v29 op_sel:[0,0,0] op_sel_hi:[1,0,0]
  v_fma_mix_f32 v89, v216, s41, -v29 op_sel:[1,0,0] op_sel_hi:[1,0,0]
  v_cvt_pk_bf16_f32 v67, v86, v87
  v_exp_f32 v88, v88
  v_exp_f32 v89, v89
  v_mfma_f32_32x32x16_bf16 a[48:63], v[52:55], v[76:79], a[48:63]
  v_fma_mix_f32 v90, v217, s41, -v29 op_sel:[0,0,0] op_sel_hi:[1,0,0]
  v_fma_mix_f32 v91, v217, s41, -v29 op_sel:[1,0,0] op_sel_hi:[1,0,0]
  v_exp_f32 v90, v90
  v_exp_f32 v91, v91
  v_mfma_f32_16x16x32_bf16 a[228:231], a[232:235], v[76:79], a[228:231]
  v_cvt_pk_bf16_f32 v68, v88, v89
  v_mfma_f32_32x32x16_bf16 a[80:95], v[56:59], v[76:79], a[80:95]
  v_fma_mix_f32 v92, v218, s41, -v29 op_sel:[0,0,0] op_sel_hi:[1,0,0]
  v_fma_mix_f32 v93, v218, s41, -v29 op_sel:[1,0,0] op_sel_hi:[1,0,0]
  v_exp_f32 v92, v92
  v_exp_f32 v93, v93
  v_cvt_pk_bf16_f32 v69, v90, v91
  v_fma_mix_f32 v94, v219, s41, -v29 op_sel:[0,0,0] op_sel_hi:[1,0,0]
  v_mfma_f32_32x32x16_bf16 a[112:127], v[60:63], v[76:79], a[112:127]
  v_fma_mix_f32 v95, v219, s41, -v29 op_sel:[1,0,0] op_sel_hi:[1,0,0]
  v_exp_f32 v94, v94
  v_exp_f32 v95, v95
  v_cvt_pk_bf16_f32 v70, v92, v93
  buffer_load_dwordx4 a[236:239], v24, s[16:19], s46 offen offset:0
  s_waitcnt lgkmcnt(0)
  v_mfma_f32_32x32x16_bf16 a[0:15], v[32:35], v[64:67], a[0:15]
  v_cvt_pk_bf16_f32 v71, v94, v95
  ds_read_b128 v[48:51], v17 offset:28672
  ds_read_b128 v[52:55], v17 offset:29696
  ds_read_b128 v[56:59], v17 offset:30720
  ds_read_b128 v[60:63], v17 offset:31744
  v_fma_mix_f32 v80, v212, s41, -v28 op_sel:[0,0,0] op_sel_hi:[1,0,0]
  v_fma_mix_f32 v81, v212, s41, -v28 op_sel:[1,0,0] op_sel_hi:[1,0,0]
  v_exp_f32 v80, v80
  v_mfma_f32_32x32x16_bf16 a[32:47], v[36:39], v[64:67], a[32:47]
  v_exp_f32 v81, v81
  v_fma_mix_f32 v82, v213, s41, -v28 op_sel:[0,0,0] op_sel_hi:[1,0,0]
  v_fma_mix_f32 v83, v213, s41, -v28 op_sel:[1,0,0] op_sel_hi:[1,0,0]
  v_exp_f32 v82, v82
  v_mfma_f32_16x16x32_bf16 a[224:227], a[232:235], v[64:67], a[224:227]
  v_exp_f32 v83, v83
  v_mfma_f32_32x32x16_bf16 a[64:79], v[40:43], v[64:67], a[64:79]
  v_cvt_pk_bf16_f32 v72, v80, v81
  v_fma_mix_f32 v84, v214, s41, -v28 op_sel:[0,0,0] op_sel_hi:[1,0,0]
  v_fma_mix_f32 v85, v214, s41, -v28 op_sel:[1,0,0] op_sel_hi:[1,0,0]
  v_exp_f32 v84, v84
  v_exp_f32 v85, v85
  v_mfma_f32_32x32x16_bf16 a[96:111], v[44:47], v[64:67], a[96:111]
  v_cvt_pk_bf16_f32 v73, v82, v83
  v_fma_mix_f32 v86, v215, s41, -v28 op_sel:[0,0,0] op_sel_hi:[1,0,0]
  v_fma_mix_f32 v87, v215, s41, -v28 op_sel:[1,0,0] op_sel_hi:[1,0,0]
  v_exp_f32 v86, v86
  v_exp_f32 v87, v87
  v_cvt_pk_bf16_f32 v74, v84, v85
  v_mfma_f32_32x32x16_bf16 a[16:31], v[32:35], v[68:71], a[16:31]
  v_fma_mix_f32 v88, v220, s41, -v29 op_sel:[0,0,0] op_sel_hi:[1,0,0]
  v_fma_mix_f32 v89, v220, s41, -v29 op_sel:[1,0,0] op_sel_hi:[1,0,0]
  v_cvt_pk_bf16_f32 v75, v86, v87
  v_exp_f32 v88, v88
  v_exp_f32 v89, v89
  v_mfma_f32_32x32x16_bf16 a[48:63], v[36:39], v[68:71], a[48:63]
  v_fma_mix_f32 v90, v221, s41, -v29 op_sel:[0,0,0] op_sel_hi:[1,0,0]
  v_fma_mix_f32 v91, v221, s41, -v29 op_sel:[1,0,0] op_sel_hi:[1,0,0]
  v_exp_f32 v90, v90
  v_exp_f32 v91, v91
  v_mfma_f32_16x16x32_bf16 a[228:231], a[232:235], v[68:71], a[228:231]
  v_cvt_pk_bf16_f32 v76, v88, v89
  v_fma_mix_f32 v92, v222, s41, -v29 op_sel:[0,0,0] op_sel_hi:[1,0,0]
  v_mfma_f32_32x32x16_bf16 a[80:95], v[40:43], v[68:71], a[80:95]
  v_fma_mix_f32 v93, v222, s41, -v29 op_sel:[1,0,0] op_sel_hi:[1,0,0]
  v_exp_f32 v92, v92
  v_exp_f32 v93, v93
  v_cvt_pk_bf16_f32 v77, v90, v91
  v_fma_mix_f32 v94, v223, s41, -v29 op_sel:[0,0,0] op_sel_hi:[1,0,0]
  v_mfma_f32_32x32x16_bf16 a[112:127], v[44:47], v[68:71], a[112:127]
  v_fma_mix_f32 v95, v223, s41, -v29 op_sel:[1,0,0] op_sel_hi:[1,0,0]
  v_exp_f32 v94, v94
  v_exp_f32 v95, v95
  v_cvt_pk_bf16_f32 v78, v92, v93
  buffer_load_dwordx4 a[236:239], v24, s[16:19], s46 offen offset:1024
  s_add_u32 s46, s46, 3584
  s_waitcnt lgkmcnt(0)
  v_mfma_f32_32x32x16_bf16 a[0:15], v[48:51], v[72:75], a[0:15]
  v_cvt_pk_bf16_f32 v79, v94, v95
  ds_read_b128 v[32:35], v16 offset:0
  ds_read_b128 v[36:39], v16 offset:1024
  ds_read_b128 v[40:43], v16 offset:2048
  ds_read_b128 v[44:47], v16 offset:3072
  v_fma_mix_f32 v80, v224, s41, -v28 op_sel:[0,0,0] op_sel_hi:[1,0,0]
  v_fma_mix_f32 v81, v224, s41, -v28 op_sel:[1,0,0] op_sel_hi:[1,0,0]
  v_exp_f32 v80, v80
  v_mfma_f32_32x32x16_bf16 a[32:47], v[52:55], v[72:75], a[32:47]
  v_exp_f32 v81, v81
  v_fma_mix_f32 v82, v225, s41, -v28 op_sel:[0,0,0] op_sel_hi:[1,0,0]
  v_fma_mix_f32 v83, v225, s41, -v28 op_sel:[1,0,0] op_sel_hi:[1,0,0]
  v_exp_f32 v82, v82
  v_mfma_f32_16x16x32_bf16 a[224:227], a[232:235], v[72:75], a[224:227]
  v_exp_f32 v83, v83
  v_mfma_f32_32x32x16_bf16 a[64:79], v[56:59], v[72:75], a[64:79]
  v_cvt_pk_bf16_f32 v64, v80, v81
  v_fma_mix_f32 v84, v226, s41, -v28 op_sel:[0,0,0] op_sel_hi:[1,0,0]
  v_fma_mix_f32 v85, v226, s41, -v28 op_sel:[1,0,0] op_sel_hi:[1,0,0]
  v_exp_f32 v84, v84
  v_exp_f32 v85, v85
  v_mfma_f32_32x32x16_bf16 a[96:111], v[60:63], v[72:75], a[96:111]
  v_cvt_pk_bf16_f32 v65, v82, v83
  v_fma_mix_f32 v86, v227, s41, -v28 op_sel:[0,0,0] op_sel_hi:[1,0,0]
  v_fma_mix_f32 v87, v227, s41, -v28 op_sel:[1,0,0] op_sel_hi:[1,0,0]
  v_exp_f32 v86, v86
  v_exp_f32 v87, v87
  v_mfma_f32_32x32x16_bf16 a[16:31], v[48:51], v[76:79], a[16:31]
  v_cvt_pk_bf16_f32 v66, v84, v85
  v_fma_mix_f32 v88, v232, s41, -v29 op_sel:[0,0,0] op_sel_hi:[1,0,0]
  v_fma_mix_f32 v89, v232, s41, -v29 op_sel:[1,0,0] op_sel_hi:[1,0,0]
  v_cvt_pk_bf16_f32 v67, v86, v87
  v_exp_f32 v88, v88
  v_exp_f32 v89, v89
  v_mfma_f32_32x32x16_bf16 a[48:63], v[52:55], v[76:79], a[48:63]
  v_fma_mix_f32 v90, v233, s41, -v29 op_sel:[0,0,0] op_sel_hi:[1,0,0]
  v_fma_mix_f32 v91, v233, s41, -v29 op_sel:[1,0,0] op_sel_hi:[1,0,0]
  v_exp_f32 v90, v90
  v_exp_f32 v91, v91
  v_mfma_f32_16x16x32_bf16 a[228:231], a[232:235], v[76:79], a[228:231]
  v_cvt_pk_bf16_f32 v68, v88, v89
  v_mfma_f32_32x32x16_bf16 a[80:95], v[56:59], v[76:79], a[80:95]
  v_fma_mix_f32 v92, v234, s41, -v29 op_sel:[0,0,0] op_sel_hi:[1,0,0]
  v_fma_mix_f32 v93, v234, s41, -v29 op_sel:[1,0,0] op_sel_hi:[1,0,0]
  v_exp_f32 v92, v92
  v_exp_f32 v93, v93
  v_cvt_pk_bf16_f32 v69, v90, v91
  v_fma_mix_f32 v94, v235, s41, -v29 op_sel:[0,0,0] op_sel_hi:[1,0,0]
  v_mfma_f32_32x32x16_bf16 a[112:127], v[60:63], v[76:79], a[112:127]
  v_fma_mix_f32 v95, v235, s41, -v29 op_sel:[1,0,0] op_sel_hi:[1,0,0]
  v_exp_f32 v94, v94
  v_exp_f32 v95, v95
  v_cvt_pk_bf16_f32 v70, v92, v93
  buffer_load_dwordx4 a[236:239], v24, s[16:19], s46 offen offset:0
  s_waitcnt lgkmcnt(0)
  v_mfma_f32_32x32x16_bf16 a[0:15], v[32:35], v[64:67], a[0:15]
  v_cvt_pk_bf16_f32 v71, v94, v95
  ds_read_b128 v[48:51], v16 offset:4096
  ds_read_b128 v[52:55], v16 offset:5120
  ds_read_b128 v[56:59], v16 offset:6144
  ds_read_b128 v[60:63], v16 offset:7168
  v_fma_mix_f32 v80, v228, s41, -v28 op_sel:[0,0,0] op_sel_hi:[1,0,0]
  v_fma_mix_f32 v81, v228, s41, -v28 op_sel:[1,0,0] op_sel_hi:[1,0,0]
  v_exp_f32 v80, v80
  v_mfma_f32_32x32x16_bf16 a[32:47], v[36:39], v[64:67], a[32:47]
  v_exp_f32 v81, v81
  v_fma_mix_f32 v82, v229, s41, -v28 op_sel:[0,0,0] op_sel_hi:[1,0,0]
  v_fma_mix_f32 v83, v229, s41, -v28 op_sel:[1,0,0] op_sel_hi:[1,0,0]
  v_exp_f32 v82, v82
  v_mfma_f32_16x16x32_bf16 a[224:227], a[232:235], v[64:67], a[224:227]
  v_exp_f32 v83, v83
  v_mfma_f32_32x32x16_bf16 a[64:79], v[40:43], v[64:67], a[64:79]
  v_cvt_pk_bf16_f32 v72, v80, v81
  v_fma_mix_f32 v84, v230, s41, -v28 op_sel:[0,0,0] op_sel_hi:[1,0,0]
  v_fma_mix_f32 v85, v230, s41, -v28 op_sel:[1,0,0] op_sel_hi:[1,0,0]
  v_exp_f32 v84, v84
  v_exp_f32 v85, v85
  v_mfma_f32_32x32x16_bf16 a[96:111], v[44:47], v[64:67], a[96:111]
  v_cvt_pk_bf16_f32 v73, v82, v83
  v_fma_mix_f32 v86, v231, s41, -v28 op_sel:[0,0,0] op_sel_hi:[1,0,0]
  v_fma_mix_f32 v87, v231, s41, -v28 op_sel:[1,0,0] op_sel_hi:[1,0,0]
  v_exp_f32 v86, v86
  v_exp_f32 v87, v87
  v_cvt_pk_bf16_f32 v74, v84, v85
  v_mfma_f32_32x32x16_bf16 a[16:31], v[32:35], v[68:71], a[16:31]
  v_fma_mix_f32 v88, v236, s41, -v29 op_sel:[0,0,0] op_sel_hi:[1,0,0]
  v_fma_mix_f32 v89, v236, s41, -v29 op_sel:[1,0,0] op_sel_hi:[1,0,0]
  v_cvt_pk_bf16_f32 v75, v86, v87
  v_exp_f32 v88, v88
  v_exp_f32 v89, v89
  v_mfma_f32_32x32x16_bf16 a[48:63], v[36:39], v[68:71], a[48:63]
  v_fma_mix_f32 v90, v237, s41, -v29 op_sel:[0,0,0] op_sel_hi:[1,0,0]
  v_fma_mix_f32 v91, v237, s41, -v29 op_sel:[1,0,0] op_sel_hi:[1,0,0]
  v_exp_f32 v90, v90
  v_exp_f32 v91, v91
  v_mfma_f32_16x16x32_bf16 a[228:231], a[232:235], v[68:71], a[228:231]
  v_cvt_pk_bf16_f32 v76, v88, v89
  v_fma_mix_f32 v92, v238, s41, -v29 op_sel:[0,0,0] op_sel_hi:[1,0,0]
  v_mfma_f32_32x32x16_bf16 a[80:95], v[40:43], v[68:71], a[80:95]
  v_fma_mix_f32 v93, v238, s41, -v29 op_sel:[1,0,0] op_sel_hi:[1,0,0]
  v_exp_f32 v92, v92
  v_exp_f32 v93, v93
  v_cvt_pk_bf16_f32 v77, v90, v91
  v_fma_mix_f32 v94, v239, s41, -v29 op_sel:[0,0,0] op_sel_hi:[1,0,0]
  v_mfma_f32_32x32x16_bf16 a[112:127], v[44:47], v[68:71], a[112:127]
  v_fma_mix_f32 v95, v239, s41, -v29 op_sel:[1,0,0] op_sel_hi:[1,0,0]
  v_exp_f32 v94, v94
  v_exp_f32 v95, v95
  v_cvt_pk_bf16_f32 v78, v92, v93
  buffer_load_dwordx4 a[236:239], v24, s[16:19], s46 offen offset:1024
  s_add_u32 s46, s46, 3584
  s_waitcnt lgkmcnt(0)
  v_mfma_f32_32x32x16_bf16 a[0:15], v[48:51], v[72:75], a[0:15]
  v_cvt_pk_bf16_f32 v79, v94, v95
  ds_read_b128 v[32:35], v16 offset:8192
  ds_read_b128 v[36:39], v16 offset:9216
  ds_read_b128 v[40:43], v16 offset:10240
  ds_read_b128 v[44:47], v16 offset:11264
  v_fma_mix_f32 v80, v240, s41, -v28 op_sel:[0,0,0] op_sel_hi:[1,0,0]
  v_fma_mix_f32 v81, v240, s41, -v28 op_sel:[1,0,0] op_sel_hi:[1,0,0]
  v_exp_f32 v80, v80
  v_mfma_f32_32x32x16_bf16 a[32:47], v[52:55], v[72:75], a[32:47]
  v_exp_f32 v81, v81
  v_fma_mix_f32 v82, v241, s41, -v28 op_sel:[0,0,0] op_sel_hi:[1,0,0]
  v_fma_mix_f32 v83, v241, s41, -v28 op_sel:[1,0,0] op_sel_hi:[1,0,0]
  v_exp_f32 v82, v82
  v_mfma_f32_16x16x32_bf16 a[224:227], a[232:235], v[72:75], a[224:227]
  v_exp_f32 v83, v83
  v_mfma_f32_32x32x16_bf16 a[64:79], v[56:59], v[72:75], a[64:79]
  v_cvt_pk_bf16_f32 v64, v80, v81
  v_fma_mix_f32 v84, v242, s41, -v28 op_sel:[0,0,0] op_sel_hi:[1,0,0]
  v_fma_mix_f32 v85, v242, s41, -v28 op_sel:[1,0,0] op_sel_hi:[1,0,0]
  v_exp_f32 v84, v84
  v_exp_f32 v85, v85
  v_mfma_f32_32x32x16_bf16 a[96:111], v[60:63], v[72:75], a[96:111]
  v_cvt_pk_bf16_f32 v65, v82, v83
  v_fma_mix_f32 v86, v243, s41, -v28 op_sel:[0,0,0] op_sel_hi:[1,0,0]
  v_fma_mix_f32 v87, v243, s41, -v28 op_sel:[1,0,0] op_sel_hi:[1,0,0]
  v_exp_f32 v86, v86
  v_exp_f32 v87, v87
  v_mfma_f32_32x32x16_bf16 a[16:31], v[48:51], v[76:79], a[16:31]
  v_cvt_pk_bf16_f32 v66, v84, v85
  v_fma_mix_f32 v88, v248, s41, -v29 op_sel:[0,0,0] op_sel_hi:[1,0,0]
  v_fma_mix_f32 v89, v248, s41, -v29 op_sel:[1,0,0] op_sel_hi:[1,0,0]
  v_cvt_pk_bf16_f32 v67, v86, v87
  v_exp_f32 v88, v88
  v_exp_f32 v89, v89
  v_mfma_f32_32x32x16_bf16 a[48:63], v[52:55], v[76:79], a[48:63]
  v_fma_mix_f32 v90, v249, s41, -v29 op_sel:[0,0,0] op_sel_hi:[1,0,0]
  v_fma_mix_f32 v91, v249, s41, -v29 op_sel:[1,0,0] op_sel_hi:[1,0,0]
  v_exp_f32 v90, v90
  v_exp_f32 v91, v91
  v_mfma_f32_16x16x32_bf16 a[228:231], a[232:235], v[76:79], a[228:231]
  v_cvt_pk_bf16_f32 v68, v88, v89
  v_mfma_f32_32x32x16_bf16 a[80:95], v[56:59], v[76:79], a[80:95]
  v_fma_mix_f32 v92, v250, s41, -v29 op_sel:[0,0,0] op_sel_hi:[1,0,0]
  v_fma_mix_f32 v93, v250, s41, -v29 op_sel:[1,0,0] op_sel_hi:[1,0,0]
  v_exp_f32 v92, v92
  v_exp_f32 v93, v93
  v_cvt_pk_bf16_f32 v69, v90, v91
  v_fma_mix_f32 v94, v251, s41, -v29 op_sel:[0,0,0] op_sel_hi:[1,0,0]
  v_mfma_f32_32x32x16_bf16 a[112:127], v[60:63], v[76:79], a[112:127]
  v_fma_mix_f32 v95, v251, s41, -v29 op_sel:[1,0,0] op_sel_hi:[1,0,0]
  v_exp_f32 v94, v94
  v_exp_f32 v95, v95
  v_cvt_pk_bf16_f32 v70, v92, v93
  buffer_load_dwordx4 a[236:239], v24, s[16:19], s46 offen offset:0
  s_waitcnt lgkmcnt(0)
  v_mfma_f32_32x32x16_bf16 a[0:15], v[32:35], v[64:67], a[0:15]
  v_cvt_pk_bf16_f32 v71, v94, v95
  ds_read_b128 v[48:51], v16 offset:12288
  ds_read_b128 v[52:55], v16 offset:13312
  ds_read_b128 v[56:59], v16 offset:14336
  ds_read_b128 v[60:63], v16 offset:15360
  v_fma_mix_f32 v80, v244, s41, -v28 op_sel:[0,0,0] op_sel_hi:[1,0,0]
  v_fma_mix_f32 v81, v244, s41, -v28 op_sel:[1,0,0] op_sel_hi:[1,0,0]
  v_exp_f32 v80, v80
  v_mfma_f32_32x32x16_bf16 a[32:47], v[36:39], v[64:67], a[32:47]
  v_exp_f32 v81, v81
  v_fma_mix_f32 v82, v245, s41, -v28 op_sel:[0,0,0] op_sel_hi:[1,0,0]
  v_fma_mix_f32 v83, v245, s41, -v28 op_sel:[1,0,0] op_sel_hi:[1,0,0]
  v_exp_f32 v82, v82
  v_mfma_f32_16x16x32_bf16 a[224:227], a[232:235], v[64:67], a[224:227]
  v_exp_f32 v83, v83
  v_mfma_f32_32x32x16_bf16 a[64:79], v[40:43], v[64:67], a[64:79]
  v_cvt_pk_bf16_f32 v72, v80, v81
  v_fma_mix_f32 v84, v246, s41, -v28 op_sel:[0,0,0] op_sel_hi:[1,0,0]
  v_fma_mix_f32 v85, v246, s41, -v28 op_sel:[1,0,0] op_sel_hi:[1,0,0]
  v_exp_f32 v84, v84
  v_exp_f32 v85, v85
  v_mfma_f32_32x32x16_bf16 a[96:111], v[44:47], v[64:67], a[96:111]
  v_cvt_pk_bf16_f32 v73, v82, v83
  v_fma_mix_f32 v86, v247, s41, -v28 op_sel:[0,0,0] op_sel_hi:[1,0,0]
  v_fma_mix_f32 v87, v247, s41, -v28 op_sel:[1,0,0] op_sel_hi:[1,0,0]
  v_exp_f32 v86, v86
  v_exp_f32 v87, v87
  v_cvt_pk_bf16_f32 v74, v84, v85
  v_mfma_f32_32x32x16_bf16 a[16:31], v[32:35], v[68:71], a[16:31]
  v_fma_mix_f32 v88, v252, s41, -v29 op_sel:[0,0,0] op_sel_hi:[1,0,0]
  v_fma_mix_f32 v89, v252, s41, -v29 op_sel:[1,0,0] op_sel_hi:[1,0,0]
  v_cvt_pk_bf16_f32 v75, v86, v87
  v_exp_f32 v88, v88
  v_exp_f32 v89, v89
  v_mfma_f32_32x32x16_bf16 a[48:63], v[36:39], v[68:71], a[48:63]
  v_fma_mix_f32 v90, v253, s41, -v29 op_sel:[0,0,0] op_sel_hi:[1,0,0]
  v_fma_mix_f32 v91, v253, s41, -v29 op_sel:[1,0,0] op_sel_hi:[1,0,0]
  v_exp_f32 v90, v90
  v_exp_f32 v91, v91
  v_mfma_f32_16x16x32_bf16 a[228:231], a[232:235], v[68:71], a[228:231]
  v_cvt_pk_bf16_f32 v76, v88, v89
  v_fma_mix_f32 v92, v254, s41, -v29 op_sel:[0,0,0] op_sel_hi:[1,0,0]
  v_mfma_f32_32x32x16_bf16 a[80:95], v[40:43], v[68:71], a[80:95]
  v_fma_mix_f32 v93, v254, s41, -v29 op_sel:[1,0,0] op_sel_hi:[1,0,0]
  v_exp_f32 v92, v92
  v_exp_f32 v93, v93
  v_cvt_pk_bf16_f32 v77, v90, v91
  v_fma_mix_f32 v94, v255, s41, -v29 op_sel:[0,0,0] op_sel_hi:[1,0,0]
  v_mfma_f32_32x32x16_bf16 a[112:127], v[44:47], v[68:71], a[112:127]
  v_fma_mix_f32 v95, v255, s41, -v29 op_sel:[1,0,0] op_sel_hi:[1,0,0]
  v_exp_f32 v94, v94
  v_exp_f32 v95, v95
  v_cvt_pk_bf16_f32 v78, v92, v93
  buffer_load_dwordx4 a[236:239], v24, s[16:19], s46 offen offset:1024
  s_add_u32 s46, s46, 3584
  s_waitcnt lgkmcnt(0)
  v_mfma_f32_32x32x16_bf16 a[0:15], v[48:51], v[72:75], a[0:15]
  v_cvt_pk_bf16_f32 v79, v94, v95
  ds_read_b128 v[32:35], v16 offset:16384
  ds_read_b128 v[36:39], v16 offset:17408
  ds_read_b128 v[40:43], v16 offset:18432
  ds_read_b128 v[44:47], v16 offset:19456
  v_accvgpr_read_b32 v81, a128
  v_fma_mix_f32 v80, v81, s41, -v28 op_sel:[0,0,0] op_sel_hi:[1,0,0]
  v_fma_mix_f32 v81, v81, s41, -v28 op_sel:[1,0,0] op_sel_hi:[1,0,0]
  v_exp_f32 v80, v80
  v_mfma_f32_32x32x16_bf16 a[32:47], v[52:55], v[72:75], a[32:47]
  v_exp_f32 v81, v81
  v_accvgpr_read_b32 v83, a129
  v_fma_mix_f32 v82, v83, s41, -v28 op_sel:[0,0,0] op_sel_hi:[1,0,0]
  v_fma_mix_f32 v83, v83, s41, -v28 op_sel:[1,0,0] op_sel_hi:[1,0,0]
  v_exp_f32 v82, v82
  v_mfma_f32_16x16x32_bf16 a[224:227], a[232:235], v[72:75], a[224:227]
  v_exp_f32 v83, v83
  v_mfma_f32_32x32x16_bf16 a[64:79], v[56:59], v[72:75], a[64:79]
  v_cvt_pk_bf16_f32 v64, v80, v81
  v_accvgpr_read_b32 v85, a130
  v_fma_mix_f32 v84, v85, s41, -v28 op_sel:[0,0,0] op_sel_hi:[1,0,0]
  v_fma_mix_f32 v85, v85, s41, -v28 op_sel:[1,0,0] op_sel_hi:[1,0,0]
  v_exp_f32 v84, v84
  v_exp_f32 v85, v85
  v_mfma_f32_32x32x16_bf16 a[96:111], v[60:63], v[72:75], a[96:111]
  v_cvt_pk_bf16_f32 v65, v82, v83
  v_accvgpr_read_b32 v87, a131
  v_fma_mix_f32 v86, v87, s41, -v28 op_sel:[0,0,0] op_sel_hi:[1,0,0]
  v_fma_mix_f32 v87, v87, s41, -v28 op_sel:[1,0,0] op_sel_hi:[1,0,0]
  v_exp_f32 v86, v86
  v_exp_f32 v87, v87
  v_mfma_f32_32x32x16_bf16 a[16:31], v[48:51], v[76:79], a[16:31]
  v_cvt_pk_bf16_f32 v66, v84, v85
  v_accvgpr_read_b32 v89, a136
  v_fma_mix_f32 v88, v89, s41, -v29 op_sel:[0,0,0] op_sel_hi:[1,0,0]
  v_cvt_pk_bf16_f32 v67, v86, v87
  v_fma_mix_f32 v89, v89, s41, -v29 op_sel:[1,0,0] op_sel_hi:[1,0,0]
  v_exp_f32 v88, v88
  v_exp_f32 v89, v89
  v_mfma_f32_32x32x16_bf16 a[48:63], v[52:55], v[76:79], a[48:63]
  v_accvgpr_read_b32 v91, a137
  v_fma_mix_f32 v90, v91, s41, -v29 op_sel:[0,0,0] op_sel_hi:[1,0,0]
  v_fma_mix_f32 v91, v91, s41, -v29 op_sel:[1,0,0] op_sel_hi:[1,0,0]
  v_exp_f32 v90, v90
  v_exp_f32 v91, v91
  v_mfma_f32_16x16x32_bf16 a[228:231], a[232:235], v[76:79], a[228:231]
  v_cvt_pk_bf16_f32 v68, v88, v89
  v_mfma_f32_32x32x16_bf16 a[80:95], v[56:59], v[76:79], a[80:95]
  v_accvgpr_read_b32 v93, a138
  v_fma_mix_f32 v92, v93, s41, -v29 op_sel:[0,0,0] op_sel_hi:[1,0,0]
  v_fma_mix_f32 v93, v93, s41, -v29 op_sel:[1,0,0] op_sel_hi:[1,0,0]
  v_exp_f32 v92, v92
  v_exp_f32 v93, v93
  v_cvt_pk_bf16_f32 v69, v90, v91
  v_accvgpr_read_b32 v95, a139
  v_mfma_f32_32x32x16_bf16 a[112:127], v[60:63], v[76:79], a[112:127]
  v_fma_mix_f32 v94, v95, s41, -v29 op_sel:[0,0,0] op_sel_hi:[1,0,0]
  v_fma_mix_f32 v95, v95, s41, -v29 op_sel:[1,0,0] op_sel_hi:[1,0,0]
  v_exp_f32 v94, v94
  v_exp_f32 v95, v95
  v_cvt_pk_bf16_f32 v70, v92, v93
  buffer_load_dwordx4 a[236:239], v24, s[16:19], s46 offen offset:0
  s_waitcnt lgkmcnt(0)
  v_mfma_f32_32x32x16_bf16 a[0:15], v[32:35], v[64:67], a[0:15]
  v_cvt_pk_bf16_f32 v71, v94, v95
  ds_read_b128 v[48:51], v16 offset:20480
  ds_read_b128 v[52:55], v16 offset:21504
  ds_read_b128 v[56:59], v16 offset:22528
  ds_read_b128 v[60:63], v16 offset:23552
  v_accvgpr_read_b32 v81, a132
  v_fma_mix_f32 v80, v81, s41, -v28 op_sel:[0,0,0] op_sel_hi:[1,0,0]
  v_fma_mix_f32 v81, v81, s41, -v28 op_sel:[1,0,0] op_sel_hi:[1,0,0]
  v_exp_f32 v80, v80
  v_mfma_f32_32x32x16_bf16 a[32:47], v[36:39], v[64:67], a[32:47]
  v_exp_f32 v81, v81
  v_accvgpr_read_b32 v83, a133
  v_fma_mix_f32 v82, v83, s41, -v28 op_sel:[0,0,0] op_sel_hi:[1,0,0]
  v_fma_mix_f32 v83, v83, s41, -v28 op_sel:[1,0,0] op_sel_hi:[1,0,0]
  v_exp_f32 v82, v82
  v_mfma_f32_16x16x32_bf16 a[224:227], a[232:235], v[64:67], a[224:227]
  v_exp_f32 v83, v83
  v_mfma_f32_32x32x16_bf16 a[64:79], v[40:43], v[64:67], a[64:79]
  v_cvt_pk_bf16_f32 v72, v80, v81
  v_accvgpr_read_b32 v85, a134
  v_fma_mix_f32 v84, v85, s41, -v28 op_sel:[0,0,0] op_sel_hi:[1,0,0]
  v_fma_mix_f32 v85, v85, s41, -v28 op_sel:[1,0,0] op_sel_hi:[1,0,0]
  v_exp_f32 v84, v84
  v_exp_f32 v85, v85
  v_mfma_f32_32x32x16_bf16 a[96:111], v[44:47], v[64:67], a[96:111]
  v_cvt_pk_bf16_f32 v73, v82, v83
  v_accvgpr_read_b32 v87, a135
  v_fma_mix_f32 v86, v87, s41, -v28 op_sel:[0,0,0] op_sel_hi:[1,0,0]
  v_fma_mix_f32 v87, v87, s41, -v28 op_sel:[1,0,0] op_sel_hi:[1,0,0]
  v_exp_f32 v86, v86
  v_exp_f32 v87, v87
  v_cvt_pk_bf16_f32 v74, v84, v85
  v_mfma_f32_32x32x16_bf16 a[16:31], v[32:35], v[68:71], a[16:31]
  v_accvgpr_read_b32 v89, a140
  v_fma_mix_f32 v88, v89, s41, -v29 op_sel:[0,0,0] op_sel_hi:[1,0,0]
  v_cvt_pk_bf16_f32 v75, v86, v87
  v_fma_mix_f32 v89, v89, s41, -v29 op_sel:[1,0,0] op_sel_hi:[1,0,0]
  v_exp_f32 v88, v88
  v_exp_f32 v89, v89
  v_mfma_f32_32x32x16_bf16 a[48:63], v[36:39], v[68:71], a[48:63]
  v_accvgpr_read_b32 v91, a141
  v_fma_mix_f32 v90, v91, s41, -v29 op_sel:[0,0,0] op_sel_hi:[1,0,0]
  v_fma_mix_f32 v91, v91, s41, -v29 op_sel:[1,0,0] op_sel_hi:[1,0,0]
  v_exp_f32 v90, v90
  v_exp_f32 v91, v91
  v_mfma_f32_16x16x32_bf16 a[228:231], a[232:235], v[68:71], a[228:231]
  v_cvt_pk_bf16_f32 v76, v88, v89
  v_accvgpr_read_b32 v93, a142
  v_mfma_f32_32x32x16_bf16 a[80:95], v[40:43], v[68:71], a[80:95]
  v_fma_mix_f32 v92, v93, s41, -v29 op_sel:[0,0,0] op_sel_hi:[1,0,0]
  v_fma_mix_f32 v93, v93, s41, -v29 op_sel:[1,0,0] op_sel_hi:[1,0,0]
  v_exp_f32 v92, v92
  v_exp_f32 v93, v93
  v_cvt_pk_bf16_f32 v77, v90, v91
  v_accvgpr_read_b32 v95, a143
  v_mfma_f32_32x32x16_bf16 a[112:127], v[44:47], v[68:71], a[112:127]
  v_fma_mix_f32 v94, v95, s41, -v29 op_sel:[0,0,0] op_sel_hi:[1,0,0]
  v_fma_mix_f32 v95, v95, s41, -v29 op_sel:[1,0,0] op_sel_hi:[1,0,0]
  v_exp_f32 v94, v94
  v_exp_f32 v95, v95
  v_cvt_pk_bf16_f32 v78, v92, v93
  buffer_load_dwordx4 a[236:239], v24, s[16:19], s46 offen offset:1024
  s_add_u32 s46, s46, 3584
  s_waitcnt lgkmcnt(0)
  v_mfma_f32_32x32x16_bf16 a[0:15], v[48:51], v[72:75], a[0:15]
  v_cvt_pk_bf16_f32 v79, v94, v95
  ds_read_b128 v[32:35], v16 offset:24576
  ds_read_b128 v[36:39], v16 offset:25600
  ds_read_b128 v[40:43], v16 offset:26624
  ds_read_b128 v[44:47], v16 offset:27648
  v_accvgpr_read_b32 v81, a144
  v_fma_mix_f32 v80, v81, s41, -v28 op_sel:[0,0,0] op_sel_hi:[1,0,0]
  v_fma_mix_f32 v81, v81, s41, -v28 op_sel:[1,0,0] op_sel_hi:[1,0,0]
  v_exp_f32 v80, v80
  v_mfma_f32_32x32x16_bf16 a[32:47], v[52:55], v[72:75], a[32:47]
  v_exp_f32 v81, v81
  v_accvgpr_read_b32 v83, a145
  v_fma_mix_f32 v82, v83, s41, -v28 op_sel:[0,0,0] op_sel_hi:[1,0,0]
  v_fma_mix_f32 v83, v83, s41, -v28 op_sel:[1,0,0] op_sel_hi:[1,0,0]
  v_exp_f32 v82, v82
  v_mfma_f32_16x16x32_bf16 a[224:227], a[232:235], v[72:75], a[224:227]
  v_exp_f32 v83, v83
  v_cvt_pk_bf16_f32 v64, v80, v81
  v_mfma_f32_32x32x16_bf16 a[64:79], v[56:59], v[72:75], a[64:79]
  v_accvgpr_read_b32 v85, a146
  v_fma_mix_f32 v84, v85, s41, -v28 op_sel:[0,0,0] op_sel_hi:[1,0,0]
  v_fma_mix_f32 v85, v85, s41, -v28 op_sel:[1,0,0] op_sel_hi:[1,0,0]
  v_exp_f32 v84, v84
  v_exp_f32 v85, v85
  v_cvt_pk_bf16_f32 v65, v82, v83
  v_accvgpr_read_b32 v87, a147
  v_fma_mix_f32 v86, v87, s41, -v28 op_sel:[0,0,0] op_sel_hi:[1,0,0]
  v_mfma_f32_32x32x16_bf16 a[96:111], v[60:63], v[72:75], a[96:111]
  v_fma_mix_f32 v87, v87, s41, -v28 op_sel:[1,0,0] op_sel_hi:[1,0,0]
  v_exp_f32 v86, v86
  v_exp_f32 v87, v87
  v_cvt_pk_bf16_f32 v66, v84, v85
  v_accvgpr_read_b32 v89, a152
  v_fma_mix_f32 v88, v89, s41, -v29 op_sel:[0,0,0] op_sel_hi:[1,0,0]
  v_cvt_pk_bf16_f32 v67, v86, v87
  v_fma_mix_f32 v89, v89, s41, -v29 op_sel:[1,0,0] op_sel_hi:[1,0,0]
  v_mfma_f32_32x32x16_bf16 a[16:31], v[48:51], v[76:79], a[16:31]
  v_exp_f32 v88, v88
  v_exp_f32 v89, v89
  v_accvgpr_read_b32 v91, a153
  v_fma_mix_f32 v90, v91, s41, -v29 op_sel:[0,0,0] op_sel_hi:[1,0,0]
  v_fma_mix_f32 v91, v91, s41, -v29 op_sel:[1,0,0] op_sel_hi:[1,0,0]
  v_exp_f32 v90, v90
  v_mfma_f32_32x32x16_bf16 a[48:63], v[52:55], v[76:79], a[48:63]
  v_exp_f32 v91, v91
  v_cvt_pk_bf16_f32 v68, v88, v89
  v_accvgpr_read_b32 v93, a154
  v_fma_mix_f32 v92, v93, s41, -v29 op_sel:[0,0,0] op_sel_hi:[1,0,0]
  v_fma_mix_f32 v93, v93, s41, -v29 op_sel:[1,0,0] op_sel_hi:[1,0,0]
  v_mfma_f32_16x16x32_bf16 a[228:231], a[232:235], v[76:79], a[228:231]
  v_exp_f32 v92, v92
  v_exp_f32 v93, v93
  v_mfma_f32_32x32x16_bf16 a[80:95], v[56:59], v[76:79], a[80:95]
  v_cvt_pk_bf16_f32 v69, v90, v91
  v_accvgpr_read_b32 v95, a155
  v_fma_mix_f32 v94, v95, s41, -v29 op_sel:[0,0,0] op_sel_hi:[1,0,0]
  v_fma_mix_f32 v95, v95, s41, -v29 op_sel:[1,0,0] op_sel_hi:[1,0,0]
  v_exp_f32 v94, v94
  v_exp_f32 v95, v95
  v_cvt_pk_bf16_f32 v70, v92, v93
  v_mfma_f32_32x32x16_bf16 a[112:127], v[60:63], v[76:79], a[112:127]
  s_lshr_b32 s46, s2, 3
  s_lshl_b32 s46, s46, 2
  s_add_u32 s46, s46, s32
  s_lshl_b32 s46, s46, 10
  s_getpc_b64 s[16:17]
K1_PC:
  s_add_u32 s16, s16, K23_SEG-K1_PC
  s_addc_u32 s17, s17, 0
  s_mov_b32 s18, CODE_END-K23_SEG
  s_mov_b32 s19, 0x20000
  buffer_load_dwordx4 a[236:239], v24, s[16:19], s46 offen
  s_waitcnt lgkmcnt(0)
  v_mfma_f32_32x32x16_bf16 a[0:15], v[32:35], v[64:67], a[0:15]
  v_cvt_pk_bf16_f32 v71, v94, v95
  ds_read_b128 v[48:51], v16 offset:28672
  ds_read_b128 v[52:55], v16 offset:29696
  ds_read_b128 v[56:59], v16 offset:30720
  ds_read_b128 v[60:63], v16 offset:31744
  v_accvgpr_read_b32 v81, a148
  v_fma_mix_f32 v80, v81, s41, -v28 op_sel:[0,0,0] op_sel_hi:[1,0,0]
  v_fma_mix_f32 v81, v81, s41, -v28 op_sel:[1,0,0] op_sel_hi:[1,0,0]
  v_exp_f32 v80, v80
  v_mfma_f32_32x32x16_bf16 a[32:47], v[36:39], v[64:67], a[32:47]
  v_exp_f32 v81, v81
  v_accvgpr_read_b32 v83, a149
  v_fma_mix_f32 v82, v83, s41, -v28 op_sel:[0,0,0] op_sel_hi:[1,0,0]
  v_fma_mix_f32 v83, v83, s41, -v28 op_sel:[1,0,0] op_sel_hi:[1,0,0]
  v_exp_f32 v82, v82
  v_mfma_f32_16x16x32_bf16 a[224:227], a[232:235], v[64:67], a[224:227]
  v_mfma_f32_32x32x16_bf16 a[64:79], v[40:43], v[64:67], a[64:79]
  v_exp_f32 v83, v83
  v_cvt_pk_bf16_f32 v72, v80, v81
  v_accvgpr_read_b32 v85, a150
  v_fma_mix_f32 v84, v85, s41, -v28 op_sel:[0,0,0] op_sel_hi:[1,0,0]
  v_fma_mix_f32 v85, v85, s41, -v28 op_sel:[1,0,0] op_sel_hi:[1,0,0]
  v_exp_f32 v84, v84
  v_exp_f32 v85, v85
  v_mfma_f32_32x32x16_bf16 a[96:111], v[44:47], v[64:67], a[96:111]
  v_cvt_pk_bf16_f32 v73, v82, v83
  v_accvgpr_read_b32 v87, a151
  v_fma_mix_f32 v86, v87, s41, -v28 op_sel:[0,0,0] op_sel_hi:[1,0,0]
  v_fma_mix_f32 v87, v87, s41, -v28 op_sel:[1,0,0] op_sel_hi:[1,0,0]
  v_exp_f32 v86, v86
  v_exp_f32 v87, v87
  v_mfma_f32_32x32x16_bf16 a[16:31], v[32:35], v[68:71], a[16:31]
  v_cvt_pk_bf16_f32 v74, v84, v85
  v_accvgpr_read_b32 v89, a156
  v_fma_mix_f32 v88, v89, s41, -v29 op_sel:[0,0,0] op_sel_hi:[1,0,0]
  v_cvt_pk_bf16_f32 v75, v86, v87
  v_fma_mix_f32 v89, v89, s41, -v29 op_sel:[1,0,0] op_sel_hi:[1,0,0]
  v_exp_f32 v88, v88
  v_mfma_f32_32x32x16_bf16 a[48:63], v[36:39], v[68:71], a[48:63]
  v_exp_f32 v89, v89
  v_accvgpr_read_b32 v91, a157
  v_fma_mix_f32 v90, v91, s41, -v29 op_sel:[0,0,0] op_sel_hi:[1,0,0]
  v_fma_mix_f32 v91, v91, s41, -v29 op_sel:[1,0,0] op_sel_hi:[1,0,0]
  v_exp_f32 v90, v90
  v_mfma_f32_16x16x32_bf16 a[228:231], a[232:235], v[68:71], a[228:231]
  v_exp_f32 v91, v91
  v_mfma_f32_32x32x16_bf16 a[80:95], v[40:43], v[68:71], a[80:95]
  v_cvt_pk_bf16_f32 v76, v88, v89
  v_accvgpr_read_b32 v93, a158
  v_fma_mix_f32 v92, v93, s41, -v29 op_sel:[0,0,0] op_sel_hi:[1,0,0]
  v_fma_mix_f32 v93, v93, s41, -v29 op_sel:[1,0,0] op_sel_hi:[1,0,0]
  v_exp_f32 v92, v92
  v_exp_f32 v93, v93
  v_cvt_pk_bf16_f32 v77, v90, v91
  v_mfma_f32_32x32x16_bf16 a[112:127], v[44:47], v[68:71], a[112:127]
  v_accvgpr_read_b32 v95, a159
  v_fma_mix_f32 v94, v95, s41, -v29 op_sel:[0,0,0] op_sel_hi:[1,0,0]
  v_fma_mix_f32 v95, v95, s41, -v29 op_sel:[1,0,0] op_sel_hi:[1,0,0]
  v_exp_f32 v94, v94
  v_exp_f32 v95, v95
  v_cvt_pk_bf16_f32 v78, v92, v93
  s_waitcnt lgkmcnt(0)
  v_mfma_f32_32x32x16_bf16 a[0:15], v[48:51], v[72:75], a[0:15]
  v_cvt_pk_bf16_f32 v79, v94, v95
  s_waitcnt vmcnt(18)
  s_barrier
  ds_read_b128 v[32:35], v16 offset:32768
  ds_read_b128 v[36:39], v16 offset:33792
  ds_read_b128 v[40:43], v16 offset:34816
  ds_read_b128 v[44:47], v16 offset:35840
  v_accvgpr_read_b32 v81, a160
  v_fma_mix_f32 v80, v81, s41, -v28 op_sel:[0,0,0] op_sel_hi:[1,0,0]
  v_fma_mix_f32 v81, v81, s41, -v28 op_sel:[1,0,0] op_sel_hi:[1,0,0]
  v_mfma_f32_32x32x16_bf16 a[32:47], v[52:55], v[72:75], a[32:47]
  v_exp_f32 v80, v80
  v_exp_f32 v81, v81
  v_accvgpr_read_b32 v83, a161
  v_fma_mix_f32 v82, v83, s41, -v28 op_sel:[0,0,0] op_sel_hi:[1,0,0]
  v_mfma_f32_16x16x32_bf16 a[224:227], a[232:235], v[72:75], a[224:227]
  v_fma_mix_f32 v83, v83, s41, -v28 op_sel:[1,0,0] op_sel_hi:[1,0,0]
  v_exp_f32 v82, v82
  v_mfma_f32_32x32x16_bf16 a[64:79], v[56:59], v[72:75], a[64:79]
  v_exp_f32 v83, v83
  v_cvt_pk_bf16_f32 v64, v80, v81
  v_accvgpr_read_b32 v85, a162
  v_fma_mix_f32 v84, v85, s41, -v28 op_sel:[0,0,0] op_sel_hi:[1,0,0]
  v_fma_mix_f32 v85, v85, s41, -v28 op_sel:[1,0,0] op_sel_hi:[1,0,0]
  v_exp_f32 v84, v84
  v_mfma_f32_32x32x16_bf16 a[96:111], v[60:63], v[72:75], a[96:111]
  v_exp_f32 v85, v85
  v_cvt_pk_bf16_f32 v65, v82, v83
  v_accvgpr_read_b32 v87, a163
  v_fma_mix_f32 v86, v87, s41, -v28 op_sel:[0,0,0] op_sel_hi:[1,0,0]
  v_fma_mix_f32 v87, v87, s41, -v28 op_sel:[1,0,0] op_sel_hi:[1,0,0]
  v_exp_f32 v86, v86
  v_mfma_f32_32x32x16_bf16 a[16:31], v[48:51], v[76:79], a[16:31]
  v_exp_f32 v87, v87
  v_cvt_pk_bf16_f32 v66, v84, v85
  v_accvgpr_read_b32 v89, a168
  v_fma_mix_f32 v88, v89, s41, -v29 op_sel:[0,0,0] op_sel_hi:[1,0,0]
  v_cvt_pk_bf16_f32 v67, v86, v87
  v_fma_mix_f32 v89, v89, s41, -v29 op_sel:[1,0,0] op_sel_hi:[1,0,0]
  v_exp_f32 v88, v88
  v_mfma_f32_32x32x16_bf16 a[48:63], v[52:55], v[76:79], a[48:63]
  v_exp_f32 v89, v89
  v_accvgpr_read_b32 v91, a169
  v_fma_mix_f32 v90, v91, s41, -v29 op_sel:[0,0,0] op_sel_hi:[1,0,0]
  v_fma_mix_f32 v91, v91, s41, -v29 op_sel:[1,0,0] op_sel_hi:[1,0,0]
  v_exp_f32 v90, v90
  v_mfma_f32_16x16x32_bf16 a[228:231], a[232:235], v[76:79], a[228:231]
  v_exp_f32 v91, v91
  v_mfma_f32_32x32x16_bf16 a[80:95], v[56:59], v[76:79], a[80:95]
  v_cvt_pk_bf16_f32 v68, v88, v89
  v_accvgpr_read_b32 v93, a170
  v_fma_mix_f32 v92, v93, s41, -v29 op_sel:[0,0,0] op_sel_hi:[1,0,0]
  v_fma_mix_f32 v93, v93, s41, -v29 op_sel:[1,0,0] op_sel_hi:[1,0,0]
  v_exp_f32 v92, v92
  v_exp_f32 v93, v93
  v_mfma_f32_32x32x16_bf16 a[112:127], v[60:63], v[76:79], a[112:127]
  v_cvt_pk_bf16_f32 v69, v90, v91
  v_accvgpr_read_b32 v95, a171
  v_fma_mix_f32 v94, v95, s41, -v29 op_sel:[0,0,0] op_sel_hi:[1,0,0]
  v_fma_mix_f32 v95, v95, s41, -v29 op_sel:[1,0,0] op_sel_hi:[1,0,0]
  v_exp_f32 v94, v94
  v_exp_f32 v95, v95
  v_cvt_pk_bf16_f32 v70, v92, v93
  s_waitcnt lgkmcnt(0)
  v_mfma_f32_32x32x16_bf16 a[0:15], v[32:35], v[64:67], a[0:15]
  v_cvt_pk_bf16_f32 v71, v94, v95
  ds_read_b128 v[48:51], v16 offset:36864
  ds_read_b128 v[52:55], v16 offset:37888
  ds_read_b128 v[56:59], v16 offset:38912
  ds_read_b128 v[60:63], v16 offset:39936
  v_accvgpr_read_b32 v81, a164
  v_fma_mix_f32 v80, v81, s41, -v28 op_sel:[0,0,0] op_sel_hi:[1,0,0]
  v_fma_mix_f32 v81, v81, s41, -v28 op_sel:[1,0,0] op_sel_hi:[1,0,0]
  v_exp_f32 v80, v80
  v_mfma_f32_32x32x16_bf16 a[32:47], v[36:39], v[64:67], a[32:47]
  v_exp_f32 v81, v81
  v_accvgpr_read_b32 v83, a165
  v_fma_mix_f32 v82, v83, s41, -v28 op_sel:[0,0,0] op_sel_hi:[1,0,0]
  v_fma_mix_f32 v83, v83, s41, -v28 op_sel:[1,0,0] op_sel_hi:[1,0,0]
  v_exp_f32 v82, v82
  v_mfma_f32_16x16x32_bf16 a[224:227], a[232:235], v[64:67], a[224:227]
  v_mfma_f32_32x32x16_bf16 a[64:79], v[40:43], v[64:67], a[64:79]
  v_exp_f32 v83, v83
  v_cvt_pk_bf16_f32 v72, v80, v81
  v_accvgpr_read_b32 v85, a166
  v_fma_mix_f32 v84, v85, s41, -v28 op_sel:[0,0,0] op_sel_hi:[1,0,0]
  v_fma_mix_f32 v85, v85, s41, -v28 op_sel:[1,0,0] op_sel_hi:[1,0,0]
  v_exp_f32 v84, v84
  v_exp_f32 v85, v85
  v_mfma_f32_32x32x16_bf16 a[96:111], v[44:47], v[64:67], a[96:111]
  v_cvt_pk_bf16_f32 v73, v82, v83
  v_accvgpr_read_b32 v87, a167
  v_fma_mix_f32 v86, v87, s41, -v28 op_sel:[0,0,0] op_sel_hi:[1,0,0]
  v_fma_mix_f32 v87, v87, s41, -v28 op_sel:[1,0,0] op_sel_hi:[1,0,0]
  v_exp_f32 v86, v86
  v_exp_f32 v87, v87
  v_mfma_f32_32x32x16_bf16 a[16:31], v[32:35], v[68:71], a[16:31]
  v_cvt_pk_bf16_f32 v74, v84, v85
  v_accvgpr_read_b32 v89, a172
  v_fma_mix_f32 v88, v89, s41, -v29 op_sel:[0,0,0] op_sel_hi:[1,0,0]
  v_cvt_pk_bf16_f32 v75, v86, v87
  v_fma_mix_f32 v89, v89, s41, -v29 op_sel:[1,0,0] op_sel_hi:[1,0,0]
  v_exp_f32 v88, v88
  v_mfma_f32_32x32x16_bf16 a[48:63], v[36:39], v[68:71], a[48:63]
  v_exp_f32 v89, v89
  v_accvgpr_read_b32 v91, a173
  v_fma_mix_f32 v90, v91, s41, -v29 op_sel:[0,0,0] op_sel_hi:[1,0,0]
  v_fma_mix_f32 v91, v91, s41, -v29 op_sel:[1,0,0] op_sel_hi:[1,0,0]
  v_exp_f32 v90, v90
  v_mfma_f32_16x16x32_bf16 a[228:231], a[232:235], v[68:71], a[228:231]
  v_exp_f32 v91, v91
  v_mfma_f32_32x32x16_bf16 a[80:95], v[40:43], v[68:71], a[80:95]
  v_cvt_pk_bf16_f32 v76, v88, v89
  v_accvgpr_read_b32 v93, a174
  v_fma_mix_f32 v92, v93, s41, -v29 op_sel:[0,0,0] op_sel_hi:[1,0,0]
  v_fma_mix_f32 v93, v93, s41, -v29 op_sel:[1,0,0] op_sel_hi:[1,0,0]
  v_exp_f32 v92, v92
  v_exp_f32 v93, v93
  v_cvt_pk_bf16_f32 v77, v90, v91
  v_mfma_f32_32x32x16_bf16 a[112:127], v[44:47], v[68:71], a[112:127]
  v_accvgpr_read_b32 v95, a175
  v_fma_mix_f32 v94, v95, s41, -v29 op_sel:[0,0,0] op_sel_hi:[1,0,0]
  v_fma_mix_f32 v95, v95, s41, -v29 op_sel:[1,0,0] op_sel_hi:[1,0,0]
  v_exp_f32 v94, v94
  v_exp_f32 v95, v95
  v_cvt_pk_bf16_f32 v78, v92, v93
  s_waitcnt lgkmcnt(0)
  v_mfma_f32_32x32x16_bf16 a[0:15], v[48:51], v[72:75], a[0:15]
  v_cvt_pk_bf16_f32 v79, v94, v95
  ds_read_b128 v[32:35], v16 offset:40960
  ds_read_b128 v[36:39], v16 offset:41984
  ds_read_b128 v[40:43], v16 offset:43008
  ds_read_b128 v[44:47], v16 offset:44032
  v_accvgpr_read_b32 v81, a176
  v_fma_mix_f32 v80, v81, s41, -v28 op_sel:[0,0,0] op_sel_hi:[1,0,0]
  v_fma_mix_f32 v81, v81, s41, -v28 op_sel:[1,0,0] op_sel_hi:[1,0,0]
  v_exp_f32 v80, v80
  v_mfma_f32_32x32x16_bf16 a[32:47], v[52:55], v[72:75], a[32:47]
  v_exp_f32 v81, v81
  v_accvgpr_read_b32 v83, a177
  v_fma_mix_f32 v82, v83, s41, -v28 op_sel:[0,0,0] op_sel_hi:[1,0,0]
  v_fma_mix_f32 v83, v83, s41, -v28 op_sel:[1,0,0] op_sel_hi:[1,0,0]
  v_exp_f32 v82, v82
  v_mfma_f32_16x16x32_bf16 a[224:227], a[232:235], v[72:75], a[224:227]
  v_exp_f32 v83, v83
  v_cvt_pk_bf16_f32 v64, v80, v81
  v_mfma_f32_32x32x16_bf16 a[64:79], v[56:59], v[72:75], a[64:79]
  v_accvgpr_read_b32 v85, a178
  v_fma_mix_f32 v84, v85, s41, -v28 op_sel:[0,0,0] op_sel_hi:[1,0,0]
  v_fma_mix_f32 v85, v85, s41, -v28 op_sel:[1,0,0] op_sel_hi:[1,0,0]
  v_exp_f32 v84, v84
  v_exp_f32 v85, v85
  v_cvt_pk_bf16_f32 v65, v82, v83
  v_accvgpr_read_b32 v87, a179
  v_mfma_f32_32x32x16_bf16 a[96:111], v[60:63], v[72:75], a[96:111]
  v_fma_mix_f32 v86, v87, s41, -v28 op_sel:[0,0,0] op_sel_hi:[1,0,0]
  v_fma_mix_f32 v87, v87, s41, -v28 op_sel:[1,0,0] op_sel_hi:[1,0,0]
  v_exp_f32 v86, v86
  v_exp_f32 v87, v87
  v_cvt_pk_bf16_f32 v66, v84, v85
  v_accvgpr_read_b32 v89, a184
  v_fma_mix_f32 v88, v89, s41, -v29 op_sel:[0,0,0] op_sel_hi:[1,0,0]
  v_mfma_f32_32x32x16_bf16 a[16:31], v[48:51], v[76:79], a[16:31]
  v_cvt_pk_bf16_f32 v67, v86, v87
  v_fma_mix_f32 v89, v89, s41, -v29 op_sel:[1,0,0] op_sel_hi:[1,0,0]
  v_exp_f32 v88, v88
  v_exp_f32 v89, v89
  v_accvgpr_read_b32 v91, a185
  v_fma_mix_f32 v90, v91, s41, -v29 op_sel:[0,0,0] op_sel_hi:[1,0,0]
  v_fma_mix_f32 v91, v91, s41, -v29 op_sel:[1,0,0] op_sel_hi:[1,0,0]
  v_mfma_f32_32x32x16_bf16 a[48:63], v[52:55], v[76:79], a[48:63]
  v_exp_f32 v90, v90
  v_exp_f32 v91, v91
  v_cvt_pk_bf16_f32 v68, v88, v89
  v_accvgpr_read_b32 v93, a186
  v_mfma_f32_16x16x32_bf16 a[228:231], a[232:235], v[76:79], a[228:231]
  v_fma_mix_f32 v92, v93, s41, -v29 op_sel:[0,0,0] op_sel_hi:[1,0,0]
  v_fma_mix_f32 v93, v93, s41, -v29 op_sel:[1,0,0] op_sel_hi:[1,0,0]
  v_exp_f32 v92, v92
  v_mfma_f32_32x32x16_bf16 a[80:95], v[56:59], v[76:79], a[80:95]
  v_exp_f32 v93, v93
  v_cvt_pk_bf16_f32 v69, v90, v91
  v_accvgpr_read_b32 v95, a187
  v_fma_mix_f32 v94, v95, s41, -v29 op_sel:[0,0,0] op_sel_hi:[1,0,0]
  v_fma_mix_f32 v95, v95, s41, -v29 op_sel:[1,0,0] op_sel_hi:[1,0,0]
  v_exp_f32 v94, v94
  v_mfma_f32_32x32x16_bf16 a[112:127], v[60:63], v[76:79], a[112:127]
  v_exp_f32 v95, v95
  v_cvt_pk_bf16_f32 v70, v92, v93
  s_add_u32 m0, s43, 0
  s_nop 0
  buffer_load_dwordx4 v2, s[4:7], s44 offen lds
  buffer_load_dwordx4 v3, s[4:7], s44 offen offset:1024 lds
  buffer_load_dwordx4 v4, s[4:7], s44 offen offset:2048 lds
  buffer_load_dwordx4 v5, s[4:7], s44 offen offset:3072 lds
  s_add_u32 s44, s44, s49
  s_waitcnt lgkmcnt(0)
  v_mfma_f32_32x32x16_bf16 a[0:15], v[32:35], v[64:67], a[0:15]
  v_cvt_pk_bf16_f32 v71, v94, v95
  ds_read_b128 v[48:51], v16 offset:45056
  ds_read_b128 v[52:55], v16 offset:46080
  ds_read_b128 v[56:59], v16 offset:47104
  ds_read_b128 v[60:63], v16 offset:48128
  v_accvgpr_read_b32 v81, a180
  v_fma_mix_f32 v80, v81, s41, -v28 op_sel:[0,0,0] op_sel_hi:[1,0,0]
  v_fma_mix_f32 v81, v81, s41, -v28 op_sel:[1,0,0] op_sel_hi:[1,0,0]
  v_exp_f32 v80, v80
  v_mfma_f32_32x32x16_bf16 a[32:47], v[36:39], v[64:67], a[32:47]
  v_exp_f32 v81, v81
  v_accvgpr_read_b32 v83, a181
  v_fma_mix_f32 v82, v83, s41, -v28 op_sel:[0,0,0] op_sel_hi:[1,0,0]
  v_fma_mix_f32 v83, v83, s41, -v28 op_sel:[1,0,0] op_sel_hi:[1,0,0]
  v_exp_f32 v82, v82
  v_mfma_f32_16x16x32_bf16 a[224:227], a[232:235], v[64:67], a[224:227]
  v_exp_f32 v83, v83
  v_cvt_pk_bf16_f32 v72, v80, v81
  v_mfma_f32_32x32x16_bf16 a[64:79], v[40:43], v[64:67], a[64:79]
  v_accvgpr_read_b32 v85, a182
  v_fma_mix_f32 v84, v85, s41, -v28 op_sel:[0,0,0] op_sel_hi:[1,0,0]
  v_fma_mix_f32 v85, v85, s41, -v28 op_sel:[1,0,0] op_sel_hi:[1,0,0]
  v_exp_f32 v84, v84
  v_exp_f32 v85, v85
  v_cvt_pk_bf16_f32 v73, v82, v83
  v_accvgpr_read_b32 v87, a183
  v_mfma_f32_32x32x16_bf16 a[96:111], v[44:47], v[64:67], a[96:111]
  v_fma_mix_f32 v86, v87, s41, -v28 op_sel:[0,0,0] op_sel_hi:[1,0,0]
  v_fma_mix_f32 v87, v87, s41, -v28 op_sel:[1,0,0] op_sel_hi:[1,0,0]
  v_exp_f32 v86, v86
  v_exp_f32 v87, v87
  v_cvt_pk_bf16_f32 v74, v84, v85
  v_accvgpr_read_b32 v89, a188
  v_fma_mix_f32 v88, v89, s41, -v29 op_sel:[0,0,0] op_sel_hi:[1,0,0]
  v_mfma_f32_32x32x16_bf16 a[16:31], v[32:35], v[68:71], a[16:31]
  v_cvt_pk_bf16_f32 v75, v86, v87
  v_fma_mix_f32 v89, v89, s41, -v29 op_sel:[1,0,0] op_sel_hi:[1,0,0]
  v_exp_f32 v88, v88
  v_exp_f32 v89, v89
  v_accvgpr_read_b32 v91, a189
  v_fma_mix_f32 v90, v91, s41, -v29 op_sel:[0,0,0] op_sel_hi:[1,0,0]
  v_fma_mix_f32 v91, v91, s41, -v29 op_sel:[1,0,0] op_sel_hi:[1,0,0]
  v_mfma_f32_32x32x16_bf16 a[48:63], v[36:39], v[68:71], a[48:63]
  v_exp_f32 v90, v90
  v_exp_f32 v91, v91
  v_cvt_pk_bf16_f32 v76, v88, v89
  v_accvgpr_read_b32 v93, a190
  v_mfma_f32_16x16x32_bf16 a[228:231], a[232:235], v[68:71], a[228:231]
  v_fma_mix_f32 v92, v93, s41, -v29 op_sel:[0,0,0] op_sel_hi:[1,0,0]
  v_fma_mix_f32 v93, v93, s41, -v29 op_sel:[1,0,0] op_sel_hi:[1,0,0]
  v_exp_f32 v92, v92
  v_mfma_f32_32x32x16_bf16 a[80:95], v[40:43], v[68:71], a[80:95]
  v_exp_f32 v93, v93
  v_cvt_pk_bf16_f32 v77, v90, v91
  v_accvgpr_read_b32 v95, a191
  v_fma_mix_f32 v94, v95, s41, -v29 op_sel:[0,0,0] op_sel_hi:[1,0,0]
  v_fma_mix_f32 v95, v95, s41, -v29 op_sel:[1,0,0] op_sel_hi:[1,0,0]
  v_exp_f32 v94, v94
  v_mfma_f32_32x32x16_bf16 a[112:127], v[44:47], v[68:71], a[112:127]
  v_exp_f32 v95, v95
  v_cvt_pk_bf16_f32 v78, v92, v93
  s_add_u32 m0, s43, 4096
  s_nop 0
  buffer_load_dwordx4 v2, s[4:7], s44 offen lds
  buffer_load_dwordx4 v3, s[4:7], s44 offen offset:1024 lds
  buffer_load_dwordx4 v4, s[4:7], s44 offen offset:2048 lds
  buffer_load_dwordx4 v5, s[4:7], s44 offen offset:3072 lds
  s_add_u32 s44, s44, s49
  s_waitcnt lgkmcnt(0)
  v_mfma_f32_32x32x16_bf16 a[0:15], v[48:51], v[72:75], a[0:15]
  v_cvt_pk_bf16_f32 v79, v94, v95
  ds_read_b128 v[32:35], v16 offset:49152
  ds_read_b128 v[36:39], v16 offset:50176
  ds_read_b128 v[40:43], v16 offset:51200
  ds_read_b128 v[44:47], v16 offset:52224
  v_accvgpr_read_b32 v81, a192
  v_fma_mix_f32 v80, v81, s41, -v28 op_sel:[0,0,0] op_sel_hi:[1,0,0]
  v_fma_mix_f32 v81, v81, s41, -v28 op_sel:[1,0,0] op_sel_hi:[1,0,0]
  v_exp_f32 v80, v80
  v_mfma_f32_32x32x16_bf16 a[32:47], v[52:55], v[72:75], a[32:47]
  v_exp_f32 v81, v81
  v_accvgpr_read_b32 v83, a193
  v_fma_mix_f32 v82, v83, s41, -v28 op_sel:[0,0,0] op_sel_hi:[1,0,0]
  v_fma_mix_f32 v83, v83, s41, -v28 op_sel:[1,0,0] op_sel_hi:[1,0,0]
  v_exp_f32 v82, v82
  v_mfma_f32_16x16x32_bf16 a[224:227], a[232:235], v[72:75], a[224:227]
  v_exp_f32 v83, v83
  v_cvt_pk_bf16_f32 v64, v80, v81
  v_mfma_f32_32x32x16_bf16 a[64:79], v[56:59], v[72:75], a[64:79]
  v_accvgpr_read_b32 v85, a194
  v_fma_mix_f32 v84, v85, s41, -v28 op_sel:[0,0,0] op_sel_hi:[1,0,0]
  v_fma_mix_f32 v85, v85, s41, -v28 op_sel:[1,0,0] op_sel_hi:[1,0,0]
  v_exp_f32 v84, v84
  v_exp_f32 v85, v85
  v_cvt_pk_bf16_f32 v65, v82, v83
  v_accvgpr_read_b32 v87, a195
  v_mfma_f32_32x32x16_bf16 a[96:111], v[60:63], v[72:75], a[96:111]
  v_fma_mix_f32 v86, v87, s41, -v28 op_sel:[0,0,0] op_sel_hi:[1,0,0]
  v_fma_mix_f32 v87, v87, s41, -v28 op_sel:[1,0,0] op_sel_hi:[1,0,0]
  v_exp_f32 v86, v86
  v_exp_f32 v87, v87
  v_cvt_pk_bf16_f32 v66, v84, v85
  v_accvgpr_read_b32 v89, a200
  v_fma_mix_f32 v88, v89, s41, -v29 op_sel:[0,0,0] op_sel_hi:[1,0,0]
  v_mfma_f32_32x32x16_bf16 a[16:31], v[48:51], v[76:79], a[16:31]
  v_cvt_pk_bf16_f32 v67, v86, v87
  v_fma_mix_f32 v89, v89, s41, -v29 op_sel:[1,0,0] op_sel_hi:[1,0,0]
  v_exp_f32 v88, v88
  v_exp_f32 v89, v89
  v_accvgpr_read_b32 v91, a201
  v_fma_mix_f32 v90, v91, s41, -v29 op_sel:[0,0,0] op_sel_hi:[1,0,0]
  v_fma_mix_f32 v91, v91, s41, -v29 op_sel:[1,0,0] op_sel_hi:[1,0,0]
  v_mfma_f32_32x32x16_bf16 a[48:63], v[52:55], v[76:79], a[48:63]
  v_exp_f32 v90, v90
  v_exp_f32 v91, v91
  v_cvt_pk_bf16_f32 v68, v88, v89
  v_accvgpr_read_b32 v93, a202
  v_mfma_f32_16x16x32_bf16 a[228:231], a[232:235], v[76:79], a[228:231]
  v_fma_mix_f32 v92, v93, s41, -v29 op_sel:[0,0,0] op_sel_hi:[1,0,0]
  v_fma_mix_f32 v93, v93, s41, -v29 op_sel:[1,0,0] op_sel_hi:[1,0,0]
  v_exp_f32 v92, v92
  v_mfma_f32_32x32x16_bf16 a[80:95], v[56:59], v[76:79], a[80:95]
  v_exp_f32 v93, v93
  v_cvt_pk_bf16_f32 v69, v90, v91
  v_accvgpr_read_b32 v95, a203
  v_fma_mix_f32 v94, v95, s41, -v29 op_sel:[0,0,0] op_sel_hi:[1,0,0]
  v_fma_mix_f32 v95, v95, s41, -v29 op_sel:[1,0,0] op_sel_hi:[1,0,0]
  v_exp_f32 v94, v94
  v_mfma_f32_32x32x16_bf16 a[112:127], v[60:63], v[76:79], a[112:127]
  v_exp_f32 v95, v95
  v_cvt_pk_bf16_f32 v70, v92, v93
  s_add_u32 m0, s43, 8192
  s_nop 0
  buffer_load_dwordx4 v2, s[4:7], s44 offen lds
  buffer_load_dwordx4 v3, s[4:7], s44 offen offset:1024 lds
  buffer_load_dwordx4 v4, s[4:7], s44 offen offset:2048 lds
  buffer_load_dwordx4 v5, s[4:7], s44 offen offset:3072 lds
  s_add_u32 s44, s44, s49
  s_waitcnt lgkmcnt(0)
  v_mfma_f32_32x32x16_bf16 a[0:15], v[32:35], v[64:67], a[0:15]
  v_cvt_pk_bf16_f32 v71, v94, v95
  ds_read_b128 v[48:51], v16 offset:53248
  ds_read_b128 v[52:55], v16 offset:54272
  ds_read_b128 v[56:59], v16 offset:55296
  ds_read_b128 v[60:63], v16 offset:56320
  v_accvgpr_read_b32 v81, a196
  v_fma_mix_f32 v80, v81, s41, -v28 op_sel:[0,0,0] op_sel_hi:[1,0,0]
  v_fma_mix_f32 v81, v81, s41, -v28 op_sel:[1,0,0] op_sel_hi:[1,0,0]
  v_exp_f32 v80, v80
  v_mfma_f32_32x32x16_bf16 a[32:47], v[36:39], v[64:67], a[32:47]
  v_exp_f32 v81, v81
  v_accvgpr_read_b32 v83, a197
  v_fma_mix_f32 v82, v83, s41, -v28 op_sel:[0,0,0] op_sel_hi:[1,0,0]
  v_fma_mix_f32 v83, v83, s41, -v28 op_sel:[1,0,0] op_sel_hi:[1,0,0]
  v_exp_f32 v82, v82
  v_mfma_f32_16x16x32_bf16 a[224:227], a[232:235], v[64:67], a[224:227]
  v_exp_f32 v83, v83
  v_cvt_pk_bf16_f32 v72, v80, v81
  v_mfma_f32_32x32x16_bf16 a[64:79], v[40:43], v[64:67], a[64:79]
  v_accvgpr_read_b32 v85, a198
  v_fma_mix_f32 v84, v85, s41, -v28 op_sel:[0,0,0] op_sel_hi:[1,0,0]
  v_fma_mix_f32 v85, v85, s41, -v28 op_sel:[1,0,0] op_sel_hi:[1,0,0]
  v_exp_f32 v84, v84
  v_exp_f32 v85, v85
  v_cvt_pk_bf16_f32 v73, v82, v83
  v_accvgpr_read_b32 v87, a199
  v_mfma_f32_32x32x16_bf16 a[96:111], v[44:47], v[64:67], a[96:111]
  v_fma_mix_f32 v86, v87, s41, -v28 op_sel:[0,0,0] op_sel_hi:[1,0,0]
  v_fma_mix_f32 v87, v87, s41, -v28 op_sel:[1,0,0] op_sel_hi:[1,0,0]
  v_exp_f32 v86, v86
  v_exp_f32 v87, v87
  v_cvt_pk_bf16_f32 v74, v84, v85
  v_accvgpr_read_b32 v89, a204
  v_fma_mix_f32 v88, v89, s41, -v29 op_sel:[0,0,0] op_sel_hi:[1,0,0]
  v_mfma_f32_32x32x16_bf16 a[16:31], v[32:35], v[68:71], a[16:31]
  v_cvt_pk_bf16_f32 v75, v86, v87
  v_fma_mix_f32 v89, v89, s41, -v29 op_sel:[1,0,0] op_sel_hi:[1,0,0]
  v_exp_f32 v88, v88
  v_exp_f32 v89, v89
  v_accvgpr_read_b32 v91, a205
  v_fma_mix_f32 v90, v91, s41, -v29 op_sel:[0,0,0] op_sel_hi:[1,0,0]
  v_fma_mix_f32 v91, v91, s41, -v29 op_sel:[1,0,0] op_sel_hi:[1,0,0]
  v_mfma_f32_32x32x16_bf16 a[48:63], v[36:39], v[68:71], a[48:63]
  v_exp_f32 v90, v90
  v_exp_f32 v91, v91
  v_cvt_pk_bf16_f32 v76, v88, v89
  v_accvgpr_read_b32 v93, a206
  v_mfma_f32_16x16x32_bf16 a[228:231], a[232:235], v[68:71], a[228:231]
  v_fma_mix_f32 v92, v93, s41, -v29 op_sel:[0,0,0] op_sel_hi:[1,0,0]
  v_fma_mix_f32 v93, v93, s41, -v29 op_sel:[1,0,0] op_sel_hi:[1,0,0]
  v_exp_f32 v92, v92
  v_mfma_f32_32x32x16_bf16 a[80:95], v[40:43], v[68:71], a[80:95]
  v_exp_f32 v93, v93
  v_cvt_pk_bf16_f32 v77, v90, v91
  v_accvgpr_read_b32 v95, a207
  v_fma_mix_f32 v94, v95, s41, -v29 op_sel:[0,0,0] op_sel_hi:[1,0,0]
  v_fma_mix_f32 v95, v95, s41, -v29 op_sel:[1,0,0] op_sel_hi:[1,0,0]
  v_exp_f32 v94, v94
  v_mfma_f32_32x32x16_bf16 a[112:127], v[44:47], v[68:71], a[112:127]
  v_exp_f32 v95, v95
  v_cvt_pk_bf16_f32 v78, v92, v93
  s_add_u32 m0, s43, 12288
  s_nop 0
  buffer_load_dwordx4 v2, s[4:7], s44 offen lds
  buffer_load_dwordx4 v3, s[4:7], s44 offen offset:1024 lds
  buffer_load_dwordx4 v4, s[4:7], s44 offen offset:2048 lds
  buffer_load_dwordx4 v5, s[4:7], s44 offen offset:3072 lds
  s_add_u32 s44, s44, s49
  s_waitcnt lgkmcnt(0)
  v_mfma_f32_32x32x16_bf16 a[0:15], v[48:51], v[72:75], a[0:15]
  v_cvt_pk_bf16_f32 v79, v94, v95
  ds_read_b128 v[32:35], v16 offset:57344
  ds_read_b128 v[36:39], v16 offset:58368
  ds_read_b128 v[40:43], v16 offset:59392
  ds_read_b128 v[44:47], v16 offset:60416
  v_accvgpr_read_b32 v81, a208
  v_fma_mix_f32 v80, v81, s41, -v28 op_sel:[0,0,0] op_sel_hi:[1,0,0]
  v_fma_mix_f32 v81, v81, s41, -v28 op_sel:[1,0,0] op_sel_hi:[1,0,0]
  v_exp_f32 v80, v80
  v_mfma_f32_32x32x16_bf16 a[32:47], v[52:55], v[72:75], a[32:47]
  v_exp_f32 v81, v81
  v_accvgpr_read_b32 v83, a209
  v_fma_mix_f32 v82, v83, s41, -v28 op_sel:[0,0,0] op_sel_hi:[1,0,0]
  v_fma_mix_f32 v83, v83, s41, -v28 op_sel:[1,0,0] op_sel_hi:[1,0,0]
  v_exp_f32 v82, v82
  v_mfma_f32_16x16x32_bf16 a[224:227], a[232:235], v[72:75], a[224:227]
  v_mfma_f32_32x32x16_bf16 a[64:79], v[56:59], v[72:75], a[64:79]
  v_exp_f32 v83, v83
  v_cvt_pk_bf16_f32 v64, v80, v81
  v_accvgpr_read_b32 v85, a210
  v_fma_mix_f32 v84, v85, s41, -v28 op_sel:[0,0,0] op_sel_hi:[1,0,0]
  v_fma_mix_f32 v85, v85, s41, -v28 op_sel:[1,0,0] op_sel_hi:[1,0,0]
  v_exp_f32 v84, v84
  v_exp_f32 v85, v85
  v_mfma_f32_32x32x16_bf16 a[96:111], v[60:63], v[72:75], a[96:111]
  v_cvt_pk_bf16_f32 v65, v82, v83
  v_accvgpr_read_b32 v87, a211
  v_fma_mix_f32 v86, v87, s41, -v28 op_sel:[0,0,0] op_sel_hi:[1,0,0]
  v_fma_mix_f32 v87, v87, s41, -v28 op_sel:[1,0,0] op_sel_hi:[1,0,0]
  v_exp_f32 v86, v86
  v_exp_f32 v87, v87
  v_mfma_f32_32x32x16_bf16 a[16:31], v[48:51], v[76:79], a[16:31]
  v_cvt_pk_bf16_f32 v66, v84, v85
  v_accvgpr_read_b32 v89, a216
  v_fma_mix_f32 v88, v89, s41, -v29 op_sel:[0,0,0] op_sel_hi:[1,0,0]
  v_cvt_pk_bf16_f32 v67, v86, v87
  v_fma_mix_f32 v89, v89, s41, -v29 op_sel:[1,0,0] op_sel_hi:[1,0,0]
  v_exp_f32 v88, v88
  v_mfma_f32_32x32x16_bf16 a[48:63], v[52:55], v[76:79], a[48:63]
  v_exp_f32 v89, v89
  v_accvgpr_read_b32 v91, a217
  v_fma_mix_f32 v90, v91, s41, -v29 op_sel:[0,0,0] op_sel_hi:[1,0,0]
  v_fma_mix_f32 v91, v91, s41, -v29 op_sel:[1,0,0] op_sel_hi:[1,0,0]
  v_exp_f32 v90, v90
  v_mfma_f32_16x16x32_bf16 a[228:231], a[232:235], v[76:79], a[228:231]
  v_exp_f32 v91, v91
  v_mfma_f32_32x32x16_bf16 a[80:95], v[56:59], v[76:79], a[80:95]
  v_cvt_pk_bf16_f32 v68, v88, v89
  v_accvgpr_read_b32 v93, a218
  v_fma_mix_f32 v92, v93, s41, -v29 op_sel:[0,0,0] op_sel_hi:[1,0,0]
  v_fma_mix_f32 v93, v93, s41, -v29 op_sel:[1,0,0] op_sel_hi:[1,0,0]
  v_exp_f32 v92, v92
  v_exp_f32 v93, v93
  v_cvt_pk_bf16_f32 v69, v90, v91
  v_mfma_f32_32x32x16_bf16 a[112:127], v[60:63], v[76:79], a[112:127]
  v_accvgpr_read_b32 v95, a219
  v_fma_mix_f32 v94, v95, s41, -v29 op_sel:[0,0,0] op_sel_hi:[1,0,0]
  v_fma_mix_f32 v95, v95, s41, -v29 op_sel:[1,0,0] op_sel_hi:[1,0,0]
  v_exp_f32 v94, v94
  v_exp_f32 v95, v95
  v_cvt_pk_bf16_f32 v70, v92, v93
  s_waitcnt lgkmcnt(0)
  v_mfma_f32_32x32x16_bf16 a[0:15], v[32:35], v[64:67], a[0:15]
  v_cvt_pk_bf16_f32 v71, v94, v95
  ds_read_b128 v[48:51], v16 offset:61440
  ds_read_b128 v[52:55], v16 offset:62464
  ds_read_b128 v[56:59], v16 offset:63488
  ds_read_b128 v[60:63], v16 offset:64512
  v_accvgpr_read_b32 v81, a212
  v_fma_mix_f32 v80, v81, s41, -v28 op_sel:[0,0,0] op_sel_hi:[1,0,0]
  v_fma_mix_f32 v81, v81, s41, -v28 op_sel:[1,0,0] op_sel_hi:[1,0,0]
  v_exp_f32 v80, v80
  v_mfma_f32_32x32x16_bf16 a[32:47], v[36:39], v[64:67], a[32:47]
  v_exp_f32 v81, v81
  v_accvgpr_read_b32 v83, a213
  v_fma_mix_f32 v82, v83, s41, -v28 op_sel:[0,0,0] op_sel_hi:[1,0,0]
  v_fma_mix_f32 v83, v83, s41, -v28 op_sel:[1,0,0] op_sel_hi:[1,0,0]
  v_exp_f32 v82, v82
  v_mfma_f32_16x16x32_bf16 a[224:227], a[232:235], v[64:67], a[224:227]
  v_mfma_f32_32x32x16_bf16 a[64:79], v[40:43], v[64:67], a[64:79]
  v_exp_f32 v83, v83
  v_cvt_pk_bf16_f32 v72, v80, v81
  v_accvgpr_read_b32 v85, a214
  v_fma_mix_f32 v84, v85, s41, -v28 op_sel:[0,0,0] op_sel_hi:[1,0,0]
  v_fma_mix_f32 v85, v85, s41, -v28 op_sel:[1,0,0] op_sel_hi:[1,0,0]
  v_exp_f32 v84, v84
  v_exp_f32 v85, v85
  v_mfma_f32_32x32x16_bf16 a[96:111], v[44:47], v[64:67], a[96:111]
  v_cvt_pk_bf16_f32 v73, v82, v83
  v_accvgpr_read_b32 v87, a215
  v_fma_mix_f32 v86, v87, s41, -v28 op_sel:[0,0,0] op_sel_hi:[1,0,0]
  v_fma_mix_f32 v87, v87, s41, -v28 op_sel:[1,0,0] op_sel_hi:[1,0,0]
  v_exp_f32 v86, v86
  v_exp_f32 v87, v87
  v_mfma_f32_32x32x16_bf16 a[16:31], v[32:35], v[68:71], a[16:31]
  v_cvt_pk_bf16_f32 v74, v84, v85
  v_accvgpr_read_b32 v89, a220
  v_fma_mix_f32 v88, v89, s41, -v29 op_sel:[0,0,0] op_sel_hi:[1,0,0]
  v_cvt_pk_bf16_f32 v75, v86, v87
  v_fma_mix_f32 v89, v89, s41, -v29 op_sel:[1,0,0] op_sel_hi:[1,0,0]
  v_exp_f32 v88, v88
  v_mfma_f32_32x32x16_bf16 a[48:63], v[36:39], v[68:71], a[48:63]
  v_exp_f32 v89, v89
  v_accvgpr_read_b32 v91, a221
  v_fma_mix_f32 v90, v91, s41, -v29 op_sel:[0,0,0] op_sel_hi:[1,0,0]
  v_fma_mix_f32 v91, v91, s41, -v29 op_sel:[1,0,0] op_sel_hi:[1,0,0]
  v_exp_f32 v90, v90
  v_mfma_f32_16x16x32_bf16 a[228:231], a[232:235], v[68:71], a[228:231]
  v_exp_f32 v91, v91
  v_mfma_f32_32x32x16_bf16 a[80:95], v[40:43], v[68:71], a[80:95]
  v_cvt_pk_bf16_f32 v76, v88, v89
  v_accvgpr_read_b32 v93, a222
  v_fma_mix_f32 v92, v93, s41, -v29 op_sel:[0,0,0] op_sel_hi:[1,0,0]
  v_fma_mix_f32 v93, v93, s41, -v29 op_sel:[1,0,0] op_sel_hi:[1,0,0]
  v_exp_f32 v92, v92
  v_exp_f32 v93, v93
  v_cvt_pk_bf16_f32 v77, v90, v91
  v_mfma_f32_32x32x16_bf16 a[112:127], v[44:47], v[68:71], a[112:127]
  v_accvgpr_read_b32 v95, a223
  v_fma_mix_f32 v94, v95, s41, -v29 op_sel:[0,0,0] op_sel_hi:[1,0,0]
  v_fma_mix_f32 v95, v95, s41, -v29 op_sel:[1,0,0] op_sel_hi:[1,0,0]
  v_exp_f32 v94, v94
  v_exp_f32 v95, v95
  v_cvt_pk_bf16_f32 v78, v92, v93
  s_waitcnt lgkmcnt(0)
  v_mfma_f32_32x32x16_bf16 a[0:15], v[48:51], v[72:75], a[0:15]
  v_cvt_pk_bf16_f32 v79, v94, v95
  v_mfma_f32_32x32x16_bf16 a[32:47], v[52:55], v[72:75], a[32:47]
  v_mfma_f32_16x16x32_bf16 a[224:227], a[232:235], v[72:75], a[224:227]
  v_mfma_f32_32x32x16_bf16 a[64:79], v[56:59], v[72:75], a[64:79]
  v_mfma_f32_32x32x16_bf16 a[96:111], v[60:63], v[72:75], a[96:111]
  v_mfma_f32_32x32x16_bf16 a[16:31], v[48:51], v[76:79], a[16:31]
  v_mfma_f32_32x32x16_bf16 a[48:63], v[52:55], v[76:79], a[48:63]
  v_mfma_f32_16x16x32_bf16 a[228:231], a[232:235], v[76:79], a[228:231]
  v_mfma_f32_32x32x16_bf16 a[80:95], v[56:59], v[76:79], a[80:95]
  v_mfma_f32_32x32x16_bf16 a[112:127], v[60:63], v[76:79], a[112:127]
  s_nop 7
  v_accvgpr_read_b32 v26, a224
  v_accvgpr_read_b32 v27, a228
  v_rcp_f32 v26, v26
  v_rcp_f32 v27, v27
  v_accvgpr_read_b32 v96, a0
  v_accvgpr_read_b32 v97, a1
  v_accvgpr_read_b32 v98, a2
  v_accvgpr_read_b32 v99, a3
  v_accvgpr_read_b32 v100, a4
  v_accvgpr_read_b32 v101, a5
  v_accvgpr_read_b32 v102, a6
  v_accvgpr_read_b32 v103, a7
  v_pk_mul_f32 v[96:97], v[96:97], v[26:27] op_sel:[0,0] op_sel_hi:[1,0]
  v_pk_mul_f32 v[98:99], v[98:99], v[26:27] op_sel:[0,0] op_sel_hi:[1,0]
  v_pk_mul_f32 v[100:101], v[100:101], v[26:27] op_sel:[0,0] op_sel_hi:[1,0]
  v_pk_mul_f32 v[102:103], v[102:103], v[26:27] op_sel:[0,0] op_sel_hi:[1,0]
  v_cvt_pk_bf16_f32 v112, v96, v97
  v_cvt_pk_bf16_f32 v113, v98, v99
  v_cvt_pk_bf16_f32 v114, v100, v101
  v_cvt_pk_bf16_f32 v115, v102, v103
  ds_write_b128 v30, v[112:115] offset:0
  v_accvgpr_read_b32 v104, a8
  v_accvgpr_read_b32 v105, a9
  v_accvgpr_read_b32 v106, a10
  v_accvgpr_read_b32 v107, a11
  v_accvgpr_read_b32 v108, a12
  v_accvgpr_read_b32 v109, a13
  v_accvgpr_read_b32 v110, a14
  v_accvgpr_read_b32 v111, a15
  v_pk_mul_f32 v[104:105], v[104:105], v[26:27] op_sel:[0,0] op_sel_hi:[1,0]
  v_pk_mul_f32 v[106:107], v[106:107], v[26:27] op_sel:[0,0] op_sel_hi:[1,0]
  v_pk_mul_f32 v[108:109], v[108:109], v[26:27] op_sel:[0,0] op_sel_hi:[1,0]
  v_pk_mul_f32 v[110:111], v[110:111], v[26:27] op_sel:[0,0] op_sel_hi:[1,0]
  v_cvt_pk_bf16_f32 v116, v104, v105
  v_cvt_pk_bf16_f32 v117, v106, v107
  v_cvt_pk_bf16_f32 v118, v108, v109
  v_cvt_pk_bf16_f32 v119, v110, v111
  ds_write_b128 v31, v[116:119] offset:2048
  v_accvgpr_read_b32 v96, a32
  v_accvgpr_read_b32 v97, a33
  v_accvgpr_read_b32 v98, a34
  v_accvgpr_read_b32 v99, a35
  v_accvgpr_read_b32 v100, a36
  v_accvgpr_read_b32 v101, a37
  v_accvgpr_read_b32 v102, a38
  v_accvgpr_read_b32 v103, a39
  v_pk_mul_f32 v[96:97], v[96:97], v[26:27] op_sel:[0,0] op_sel_hi:[1,0]
  v_pk_mul_f32 v[98:99], v[98:99], v[26:27] op_sel:[0,0] op_sel_hi:[1,0]
  v_pk_mul_f32 v[100:101], v[100:101], v[26:27] op_sel:[0,0] op_sel_hi:[1,0]
  v_pk_mul_f32 v[102:103], v[102:103], v[26:27] op_sel:[0,0] op_sel_hi:[1,0]
  v_cvt_pk_bf16_f32 v120, v96, v97
  v_cvt_pk_bf16_f32 v121, v98, v99
  v_cvt_pk_bf16_f32 v122, v100, v101
  v_cvt_pk_bf16_f32 v123, v102, v103
  ds_write_b128 v30, v[120:123] offset:4096
  v_accvgpr_read_b32 v104, a40
  v_accvgpr_read_b32 v105, a41
  v_accvgpr_read_b32 v106, a42
  v_accvgpr_read_b32 v107, a43
  v_accvgpr_read_b32 v108, a44
  v_accvgpr_read_b32 v109, a45
  v_accvgpr_read_b32 v110, a46
  v_accvgpr_read_b32 v111, a47
  v_pk_mul_f32 v[104:105], v[104:105], v[26:27] op_sel:[0,0] op_sel_hi:[1,0]
  v_pk_mul_f32 v[106:107], v[106:107], v[26:27] op_sel:[0,0] op_sel_hi:[1,0]
  v_pk_mul_f32 v[108:109], v[108:109], v[26:27] op_sel:[0,0] op_sel_hi:[1,0]
  v_pk_mul_f32 v[110:111], v[110:111], v[26:27] op_sel:[0,0] op_sel_hi:[1,0]
  v_cvt_pk_bf16_f32 v124, v104, v105
  v_cvt_pk_bf16_f32 v125, v106, v107
  v_cvt_pk_bf16_f32 v126, v108, v109
  v_cvt_pk_bf16_f32 v127, v110, v111
  ds_write_b128 v31, v[124:127] offset:6144
  v_accvgpr_read_b32 v96, a64
  v_accvgpr_read_b32 v97, a65
  v_accvgpr_read_b32 v98, a66
  v_accvgpr_read_b32 v99, a67
  v_accvgpr_read_b32 v100, a68
  v_accvgpr_read_b32 v101, a69
  v_accvgpr_read_b32 v102, a70
  v_accvgpr_read_b32 v103, a71
  v_pk_mul_f32 v[96:97], v[96:97], v[26:27] op_sel:[0,0] op_sel_hi:[1,0]
  v_pk_mul_f32 v[98:99], v[98:99], v[26:27] op_sel:[0,0] op_sel_hi:[1,0]
  v_pk_mul_f32 v[100:101], v[100:101], v[26:27] op_sel:[0,0] op_sel_hi:[1,0]
  v_pk_mul_f32 v[102:103], v[102:103], v[26:27] op_sel:[0,0] op_sel_hi:[1,0]
  v_cvt_pk_bf16_f32 v112, v96, v97
  v_cvt_pk_bf16_f32 v113, v98, v99
  v_cvt_pk_bf16_f32 v114, v100, v101
  v_cvt_pk_bf16_f32 v115, v102, v103
  ds_write_b128 v30, v[112:115] offset:8192
  v_accvgpr_read_b32 v104, a72
  v_accvgpr_read_b32 v105, a73
  v_accvgpr_read_b32 v106, a74
  v_accvgpr_read_b32 v107, a75
  v_accvgpr_read_b32 v108, a76
  v_accvgpr_read_b32 v109, a77
  v_accvgpr_read_b32 v110, a78
  v_accvgpr_read_b32 v111, a79
  v_pk_mul_f32 v[104:105], v[104:105], v[26:27] op_sel:[0,0] op_sel_hi:[1,0]
  v_pk_mul_f32 v[106:107], v[106:107], v[26:27] op_sel:[0,0] op_sel_hi:[1,0]
  v_pk_mul_f32 v[108:109], v[108:109], v[26:27] op_sel:[0,0] op_sel_hi:[1,0]
  v_pk_mul_f32 v[110:111], v[110:111], v[26:27] op_sel:[0,0] op_sel_hi:[1,0]
  v_cvt_pk_bf16_f32 v116, v104, v105
  v_cvt_pk_bf16_f32 v117, v106, v107
  v_cvt_pk_bf16_f32 v118, v108, v109
  v_cvt_pk_bf16_f32 v119, v110, v111
  ds_write_b128 v31, v[116:119] offset:10240
  v_accvgpr_read_b32 v96, a96
  v_accvgpr_read_b32 v97, a97
  v_accvgpr_read_b32 v98, a98
  v_accvgpr_read_b32 v99, a99
  v_accvgpr_read_b32 v100, a100
  v_accvgpr_read_b32 v101, a101
  v_accvgpr_read_b32 v102, a102
  v_accvgpr_read_b32 v103, a103
  v_pk_mul_f32 v[96:97], v[96:97], v[26:27] op_sel:[0,0] op_sel_hi:[1,0]
  v_pk_mul_f32 v[98:99], v[98:99], v[26:27] op_sel:[0,0] op_sel_hi:[1,0]
  v_pk_mul_f32 v[100:101], v[100:101], v[26:27] op_sel:[0,0] op_sel_hi:[1,0]
  v_pk_mul_f32 v[102:103], v[102:103], v[26:27] op_sel:[0,0] op_sel_hi:[1,0]
  v_cvt_pk_bf16_f32 v120, v96, v97
  v_cvt_pk_bf16_f32 v121, v98, v99
  v_cvt_pk_bf16_f32 v122, v100, v101
  v_cvt_pk_bf16_f32 v123, v102, v103
  ds_write_b128 v30, v[120:123] offset:12288
  v_accvgpr_read_b32 v104, a104
  v_accvgpr_read_b32 v105, a105
  v_accvgpr_read_b32 v106, a106
  v_accvgpr_read_b32 v107, a107
  v_accvgpr_read_b32 v108, a108
  v_accvgpr_read_b32 v109, a109
  v_accvgpr_read_b32 v110, a110
  v_accvgpr_read_b32 v111, a111
  v_pk_mul_f32 v[104:105], v[104:105], v[26:27] op_sel:[0,0] op_sel_hi:[1,0]
  v_pk_mul_f32 v[106:107], v[106:107], v[26:27] op_sel:[0,0] op_sel_hi:[1,0]
  v_pk_mul_f32 v[108:109], v[108:109], v[26:27] op_sel:[0,0] op_sel_hi:[1,0]
  v_pk_mul_f32 v[110:111], v[110:111], v[26:27] op_sel:[0,0] op_sel_hi:[1,0]
  v_cvt_pk_bf16_f32 v124, v104, v105
  v_cvt_pk_bf16_f32 v125, v106, v107
  v_cvt_pk_bf16_f32 v126, v108, v109
  v_cvt_pk_bf16_f32 v127, v110, v111
  ds_write_b128 v31, v[124:127] offset:14336
  v_accvgpr_read_b32 v96, a16
  v_accvgpr_read_b32 v97, a17
  v_accvgpr_read_b32 v98, a18
  v_accvgpr_read_b32 v99, a19
  v_accvgpr_read_b32 v100, a20
  v_accvgpr_read_b32 v101, a21
  v_accvgpr_read_b32 v102, a22
  v_accvgpr_read_b32 v103, a23
  v_pk_mul_f32 v[96:97], v[96:97], v[26:27] op_sel:[0,1] op_sel_hi:[1,1]
  v_pk_mul_f32 v[98:99], v[98:99], v[26:27] op_sel:[0,1] op_sel_hi:[1,1]
  v_pk_mul_f32 v[100:101], v[100:101], v[26:27] op_sel:[0,1] op_sel_hi:[1,1]
  v_pk_mul_f32 v[102:103], v[102:103], v[26:27] op_sel:[0,1] op_sel_hi:[1,1]
  v_cvt_pk_bf16_f32 v112, v96, v97
  v_cvt_pk_bf16_f32 v113, v98, v99
  v_cvt_pk_bf16_f32 v114, v100, v101
  v_cvt_pk_bf16_f32 v115, v102, v103
  ds_write_b128 v30, v[112:115] offset:1024
  v_accvgpr_read_b32 v104, a24
  v_accvgpr_read_b32 v105, a25
  v_accvgpr_read_b32 v106, a26
  v_accvgpr_read_b32 v107, a27
  v_accvgpr_read_b32 v108, a28
  v_accvgpr_read_b32 v109, a29
  v_accvgpr_read_b32 v110, a30
  v_accvgpr_read_b32 v111, a31
  v_pk_mul_f32 v[104:105], v[104:105], v[26:27] op_sel:[0,1] op_sel_hi:[1,1]
  v_pk_mul_f32 v[106:107], v[106:107], v[26:27] op_sel:[0,1] op_sel_hi:[1,1]
  v_pk_mul_f32 v[108:109], v[108:109], v[26:27] op_sel:[0,1] op_sel_hi:[1,1]
  v_pk_mul_f32 v[110:111], v[110:111], v[26:27] op_sel:[0,1] op_sel_hi:[1,1]
  v_cvt_pk_bf16_f32 v116, v104, v105
  v_cvt_pk_bf16_f32 v117, v106, v107
  v_cvt_pk_bf16_f32 v118, v108, v109
  v_cvt_pk_bf16_f32 v119, v110, v111
  ds_write_b128 v31, v[116:119] offset:3072
  v_accvgpr_read_b32 v96, a48
  v_accvgpr_read_b32 v97, a49
  v_accvgpr_read_b32 v98, a50
  v_accvgpr_read_b32 v99, a51
  v_accvgpr_read_b32 v100, a52
  v_accvgpr_read_b32 v101, a53
  v_accvgpr_read_b32 v102, a54
  v_accvgpr_read_b32 v103, a55
  v_pk_mul_f32 v[96:97], v[96:97], v[26:27] op_sel:[0,1] op_sel_hi:[1,1]
  v_pk_mul_f32 v[98:99], v[98:99], v[26:27] op_sel:[0,1] op_sel_hi:[1,1]
  v_pk_mul_f32 v[100:101], v[100:101], v[26:27] op_sel:[0,1] op_sel_hi:[1,1]
  v_pk_mul_f32 v[102:103], v[102:103], v[26:27] op_sel:[0,1] op_sel_hi:[1,1]
  v_cvt_pk_bf16_f32 v120, v96, v97
  v_cvt_pk_bf16_f32 v121, v98, v99
  v_cvt_pk_bf16_f32 v122, v100, v101
  v_cvt_pk_bf16_f32 v123, v102, v103
  ds_write_b128 v30, v[120:123] offset:5120
  v_accvgpr_read_b32 v104, a56
  v_accvgpr_read_b32 v105, a57
  v_accvgpr_read_b32 v106, a58
  v_accvgpr_read_b32 v107, a59
  v_accvgpr_read_b32 v108, a60
  v_accvgpr_read_b32 v109, a61
  v_accvgpr_read_b32 v110, a62
  v_accvgpr_read_b32 v111, a63
  v_pk_mul_f32 v[104:105], v[104:105], v[26:27] op_sel:[0,1] op_sel_hi:[1,1]
  v_pk_mul_f32 v[106:107], v[106:107], v[26:27] op_sel:[0,1] op_sel_hi:[1,1]
  v_pk_mul_f32 v[108:109], v[108:109], v[26:27] op_sel:[0,1] op_sel_hi:[1,1]
  v_pk_mul_f32 v[110:111], v[110:111], v[26:27] op_sel:[0,1] op_sel_hi:[1,1]
  v_cvt_pk_bf16_f32 v124, v104, v105
  v_cvt_pk_bf16_f32 v125, v106, v107
  v_cvt_pk_bf16_f32 v126, v108, v109
  v_cvt_pk_bf16_f32 v127, v110, v111
  ds_write_b128 v31, v[124:127] offset:7168
  v_accvgpr_read_b32 v96, a80
  v_accvgpr_read_b32 v97, a81
  v_accvgpr_read_b32 v98, a82
  v_accvgpr_read_b32 v99, a83
  v_accvgpr_read_b32 v100, a84
  v_accvgpr_read_b32 v101, a85
  v_accvgpr_read_b32 v102, a86
  v_accvgpr_read_b32 v103, a87
  v_pk_mul_f32 v[96:97], v[96:97], v[26:27] op_sel:[0,1] op_sel_hi:[1,1]
  v_pk_mul_f32 v[98:99], v[98:99], v[26:27] op_sel:[0,1] op_sel_hi:[1,1]
  v_pk_mul_f32 v[100:101], v[100:101], v[26:27] op_sel:[0,1] op_sel_hi:[1,1]
  v_pk_mul_f32 v[102:103], v[102:103], v[26:27] op_sel:[0,1] op_sel_hi:[1,1]
  v_cvt_pk_bf16_f32 v112, v96, v97
  v_cvt_pk_bf16_f32 v113, v98, v99
  v_cvt_pk_bf16_f32 v114, v100, v101
  v_cvt_pk_bf16_f32 v115, v102, v103
  ds_write_b128 v30, v[112:115] offset:9216
  v_accvgpr_read_b32 v104, a88
  v_accvgpr_read_b32 v105, a89
  v_accvgpr_read_b32 v106, a90
  v_accvgpr_read_b32 v107, a91
  v_accvgpr_read_b32 v108, a92
  v_accvgpr_read_b32 v109, a93
  v_accvgpr_read_b32 v110, a94
  v_accvgpr_read_b32 v111, a95
  v_pk_mul_f32 v[104:105], v[104:105], v[26:27] op_sel:[0,1] op_sel_hi:[1,1]
  v_pk_mul_f32 v[106:107], v[106:107], v[26:27] op_sel:[0,1] op_sel_hi:[1,1]
  v_pk_mul_f32 v[108:109], v[108:109], v[26:27] op_sel:[0,1] op_sel_hi:[1,1]
  v_pk_mul_f32 v[110:111], v[110:111], v[26:27] op_sel:[0,1] op_sel_hi:[1,1]
  v_cvt_pk_bf16_f32 v116, v104, v105
  v_cvt_pk_bf16_f32 v117, v106, v107
  v_cvt_pk_bf16_f32 v118, v108, v109
  v_cvt_pk_bf16_f32 v119, v110, v111
  ds_write_b128 v31, v[116:119] offset:11264
  v_accvgpr_read_b32 v96, a112
  v_accvgpr_read_b32 v97, a113
  v_accvgpr_read_b32 v98, a114
  v_accvgpr_read_b32 v99, a115
  v_accvgpr_read_b32 v100, a116
  v_accvgpr_read_b32 v101, a117
  v_accvgpr_read_b32 v102, a118
  v_accvgpr_read_b32 v103, a119
  v_pk_mul_f32 v[96:97], v[96:97], v[26:27] op_sel:[0,1] op_sel_hi:[1,1]
  v_pk_mul_f32 v[98:99], v[98:99], v[26:27] op_sel:[0,1] op_sel_hi:[1,1]
  v_pk_mul_f32 v[100:101], v[100:101], v[26:27] op_sel:[0,1] op_sel_hi:[1,1]
  v_pk_mul_f32 v[102:103], v[102:103], v[26:27] op_sel:[0,1] op_sel_hi:[1,1]
  v_cvt_pk_bf16_f32 v120, v96, v97
  v_cvt_pk_bf16_f32 v121, v98, v99
  v_cvt_pk_bf16_f32 v122, v100, v101
  v_cvt_pk_bf16_f32 v123, v102, v103
  ds_write_b128 v30, v[120:123] offset:13312
  v_accvgpr_read_b32 v104, a120
  v_accvgpr_read_b32 v105, a121
  v_accvgpr_read_b32 v106, a122
  v_accvgpr_read_b32 v107, a123
  v_accvgpr_read_b32 v108, a124
  v_accvgpr_read_b32 v109, a125
  v_accvgpr_read_b32 v110, a126
  v_accvgpr_read_b32 v111, a127
  v_pk_mul_f32 v[104:105], v[104:105], v[26:27] op_sel:[0,1] op_sel_hi:[1,1]
  v_pk_mul_f32 v[106:107], v[106:107], v[26:27] op_sel:[0,1] op_sel_hi:[1,1]
  v_pk_mul_f32 v[108:109], v[108:109], v[26:27] op_sel:[0,1] op_sel_hi:[1,1]
  v_pk_mul_f32 v[110:111], v[110:111], v[26:27] op_sel:[0,1] op_sel_hi:[1,1]
  v_cvt_pk_bf16_f32 v124, v104, v105
  v_cvt_pk_bf16_f32 v125, v106, v107
  v_cvt_pk_bf16_f32 v126, v108, v109
  v_cvt_pk_bf16_f32 v127, v110, v111
  ds_write_b128 v31, v[124:127] offset:15360
  v_lshrrev_b32 v84, 5, v1
  v_and_b32 v85, 31, v1
  v_lshlrev_b32 v86, 1, v84
  v_xor_b32 v85, v85, v86
  v_lshlrev_b32 v84, 9, v84
  v_lshl_add_u32 v10, v85, 4, v84
  v_xor_b32 v85, 4, v85
  v_lshl_add_u32 v11, v85, 4, v84
  s_waitcnt lgkmcnt(0)
  s_barrier
  s_waitcnt vmcnt(12)
  ds_read_b128 v[192:195], v10 offset:0
  ds_read_b128 v[196:199], v10 offset:1024
  ds_read_b64_tr_b16 v[160:161], v6 offset:0
  ds_read_b64_tr_b16 v[162:163], v6 offset:1024
  ds_read_b64_tr_b16 v[164:165], v7 offset:0
  ds_read_b64_tr_b16 v[166:167], v7 offset:1024
  ds_read_b64_tr_b16 v[168:169], v8 offset:0
  ds_read_b64_tr_b16 v[170:171], v8 offset:1024
  ds_read_b64_tr_b16 v[172:173], v9 offset:0
  ds_read_b64_tr_b16 v[174:175], v9 offset:1024
  s_waitcnt lgkmcnt(0)
  v_mfma_f32_32x32x16_bf16 v[32:47], v[160:163], v[192:195], 0
  s_waitcnt vmcnt(8)
  ds_read_b128 v[200:203], v11 offset:2048
  v_mfma_f32_32x32x16_bf16 v[48:63], v[160:163], v[196:199], 0
  ds_read_b128 v[204:207], v11 offset:3072
  ds_read_b64_tr_b16 v[176:177], v6 offset:4096
  ds_read_b64_tr_b16 v[178:179], v6 offset:5120
  v_mfma_f32_32x32x16_bf16 v[64:79], v[164:167], v[192:195], 0
  ds_read_b64_tr_b16 v[180:181], v7 offset:4096
  ds_read_b64_tr_b16 v[182:183], v7 offset:5120
  v_mfma_f32_32x32x16_bf16 v[80:95], v[164:167], v[196:199], 0
  ds_read_b64_tr_b16 v[184:185], v8 offset:4096
  ds_read_b64_tr_b16 v[186:187], v8 offset:5120
  v_mfma_f32_32x32x16_bf16 v[96:111], v[168:171], v[192:195], 0
  ds_read_b64_tr_b16 v[188:189], v9 offset:4096
  ds_read_b64_tr_b16 v[190:191], v9 offset:5120
  v_mfma_f32_32x32x16_bf16 v[112:127], v[168:171], v[196:199], 0
  s_add_u32 m0, s43, 0
  s_nop 0
  buffer_load_dwordx4 v2, s[4:7], s44 offen lds
  v_mfma_f32_32x32x16_bf16 v[128:143], v[172:175], v[192:195], 0
  buffer_load_dwordx4 v3, s[4:7], s44 offen offset:1024 lds
  buffer_load_dwordx4 v4, s[4:7], s44 offen offset:2048 lds
  v_mfma_f32_32x32x16_bf16 v[144:159], v[172:175], v[196:199], 0
  buffer_load_dwordx4 v5, s[4:7], s44 offen offset:3072 lds
  s_add_u32 s44, s44, s49
  s_waitcnt lgkmcnt(0)
  v_mfma_f32_32x32x16_bf16 v[32:47], v[176:179], v[200:203], v[32:47]
  s_waitcnt vmcnt(8)
  ds_read_b128 v[192:195], v10 offset:4096
  v_mfma_f32_32x32x16_bf16 v[48:63], v[176:179], v[204:207], v[48:63]
  ds_read_b128 v[196:199], v10 offset:5120
  ds_read_b64_tr_b16 v[160:161], v6 offset:8192
  ds_read_b64_tr_b16 v[162:163], v6 offset:9216
  v_mfma_f32_32x32x16_bf16 v[64:79], v[180:183], v[200:203], v[64:79]
  ds_read_b64_tr_b16 v[164:165], v7 offset:8192
  ds_read_b64_tr_b16 v[166:167], v7 offset:9216
  v_mfma_f32_32x32x16_bf16 v[80:95], v[180:183], v[204:207], v[80:95]
  ds_read_b64_tr_b16 v[168:169], v8 offset:8192
  ds_read_b64_tr_b16 v[170:171], v8 offset:9216
  v_mfma_f32_32x32x16_bf16 v[96:111], v[184:187], v[200:203], v[96:111]
  ds_read_b64_tr_b16 v[172:173], v9 offset:8192
  ds_read_b64_tr_b16 v[174:175], v9 offset:9216
  v_mfma_f32_32x32x16_bf16 v[112:127], v[184:187], v[204:207], v[112:127]
  s_add_u32 m0, s43, 4096
  s_nop 0
  buffer_load_dwordx4 v2, s[4:7], s44 offen lds
  v_mfma_f32_32x32x16_bf16 v[128:143], v[188:191], v[200:203], v[128:143]
  buffer_load_dwordx4 v3, s[4:7], s44 offen offset:1024 lds
  buffer_load_dwordx4 v4, s[4:7], s44 offen offset:2048 lds
  v_mfma_f32_32x32x16_bf16 v[144:159], v[188:191], v[204:207], v[144:159]
  buffer_load_dwordx4 v5, s[4:7], s44 offen offset:3072 lds
  s_add_u32 s44, s44, s49
  s_waitcnt lgkmcnt(0)
  v_mfma_f32_32x32x16_bf16 v[32:47], v[160:163], v[192:195], v[32:47]
  s_waitcnt vmcnt(8)
  ds_read_b128 v[200:203], v11 offset:6144
  v_mfma_f32_32x32x16_bf16 v[48:63], v[160:163], v[196:199], v[48:63]
  ds_read_b128 v[204:207], v11 offset:7168
  ds_read_b64_tr_b16 v[176:177], v6 offset:12288
  ds_read_b64_tr_b16 v[178:179], v6 offset:13312
  v_mfma_f32_32x32x16_bf16 v[64:79], v[164:167], v[192:195], v[64:79]
  ds_read_b64_tr_b16 v[180:181], v7 offset:12288
  ds_read_b64_tr_b16 v[182:183], v7 offset:13312
  v_mfma_f32_32x32x16_bf16 v[80:95], v[164:167], v[196:199], v[80:95]
  ds_read_b64_tr_b16 v[184:185], v8 offset:12288
  ds_read_b64_tr_b16 v[186:187], v8 offset:13312
  v_mfma_f32_32x32x16_bf16 v[96:111], v[168:171], v[192:195], v[96:111]
  ds_read_b64_tr_b16 v[188:189], v9 offset:12288
  ds_read_b64_tr_b16 v[190:191], v9 offset:13312
  v_mfma_f32_32x32x16_bf16 v[112:127], v[168:171], v[196:199], v[112:127]
  s_add_u32 m0, s43, 8192
  s_nop 0
  buffer_load_dwordx4 v2, s[4:7], s44 offen lds
  v_mfma_f32_32x32x16_bf16 v[128:143], v[172:175], v[192:195], v[128:143]
  buffer_load_dwordx4 v3, s[4:7], s44 offen offset:1024 lds
  buffer_load_dwordx4 v4, s[4:7], s44 offen offset:2048 lds
  v_mfma_f32_32x32x16_bf16 v[144:159], v[172:175], v[196:199], v[144:159]
  buffer_load_dwordx4 v5, s[4:7], s44 offen offset:3072 lds
  s_add_u32 s44, s44, s49
  s_waitcnt lgkmcnt(0)
  v_mfma_f32_32x32x16_bf16 v[32:47], v[176:179], v[200:203], v[32:47]
  s_waitcnt vmcnt(8)
  ds_read_b128 v[192:195], v10 offset:8192
  v_mfma_f32_32x32x16_bf16 v[48:63], v[176:179], v[204:207], v[48:63]
  ds_read_b128 v[196:199], v10 offset:9216
  ds_read_b64_tr_b16 v[160:161], v6 offset:0
  ds_read_b64_tr_b16 v[162:163], v6 offset:1024
  v_mfma_f32_32x32x16_bf16 v[64:79], v[180:183], v[200:203], v[64:79]
  ds_read_b64_tr_b16 v[164:165], v7 offset:0
  ds_read_b64_tr_b16 v[166:167], v7 offset:1024
  v_mfma_f32_32x32x16_bf16 v[80:95], v[180:183], v[204:207], v[80:95]
  ds_read_b64_tr_b16 v[168:169], v8 offset:0
  ds_read_b64_tr_b16 v[170:171], v8 offset:1024
  v_mfma_f32_32x32x16_bf16 v[96:111], v[184:187], v[200:203], v[96:111]
  ds_read_b64_tr_b16 v[172:173], v9 offset:0
  ds_read_b64_tr_b16 v[174:175], v9 offset:1024
  v_mfma_f32_32x32x16_bf16 v[112:127], v[184:187], v[204:207], v[112:127]
  s_add_u32 m0, s43, 12288
  s_nop 0
  buffer_load_dwordx4 v2, s[4:7], s44 offen lds
  v_mfma_f32_32x32x16_bf16 v[128:143], v[188:191], v[200:203], v[128:143]
  buffer_load_dwordx4 v3, s[4:7], s44 offen offset:1024 lds
  buffer_load_dwordx4 v4, s[4:7], s44 offen offset:2048 lds
  v_mfma_f32_32x32x16_bf16 v[144:159], v[188:191], v[204:207], v[144:159]
  buffer_load_dwordx4 v5, s[4:7], s44 offen offset:3072 lds
  s_add_u32 s44, s44, s49
  v_add_u32 v10, 8192, v10
  v_add_u32 v11, 8192, v11
  s_mov_b32 s45, 6
K1_OP_LOOP:
  s_waitcnt lgkmcnt(0)
  v_mfma_f32_32x32x16_bf16 v[32:47], v[160:163], v[192:195], v[32:47]
  s_waitcnt vmcnt(8)
  ds_read_b128 v[200:203], v11 offset:2048
  v_mfma_f32_32x32x16_bf16 v[48:63], v[160:163], v[196:199], v[48:63]
  ds_read_b128 v[204:207], v11 offset:3072
  ds_read_b64_tr_b16 v[176:177], v6 offset:4096
  ds_read_b64_tr_b16 v[178:179], v6 offset:5120
  v_mfma_f32_32x32x16_bf16 v[64:79], v[164:167], v[192:195], v[64:79]
  ds_read_b64_tr_b16 v[180:181], v7 offset:4096
  ds_read_b64_tr_b16 v[182:183], v7 offset:5120
  v_mfma_f32_32x32x16_bf16 v[80:95], v[164:167], v[196:199], v[80:95]
  ds_read_b64_tr_b16 v[184:185], v8 offset:4096
  ds_read_b64_tr_b16 v[186:187], v8 offset:5120
  v_mfma_f32_32x32x16_bf16 v[96:111], v[168:171], v[192:195], v[96:111]
  ds_read_b64_tr_b16 v[188:189], v9 offset:4096
  ds_read_b64_tr_b16 v[190:191], v9 offset:5120
  v_mfma_f32_32x32x16_bf16 v[112:127], v[168:171], v[196:199], v[112:127]
  s_add_u32 m0, s43, 0
  s_nop 0
  buffer_load_dwordx4 v2, s[4:7], s44 offen lds
  v_mfma_f32_32x32x16_bf16 v[128:143], v[172:175], v[192:195], v[128:143]
  buffer_load_dwordx4 v3, s[4:7], s44 offen offset:1024 lds
  buffer_load_dwordx4 v4, s[4:7], s44 offen offset:2048 lds
  v_mfma_f32_32x32x16_bf16 v[144:159], v[172:175], v[196:199], v[144:159]
  buffer_load_dwordx4 v5, s[4:7], s44 offen offset:3072 lds
  s_add_u32 s44, s44, s49
  s_waitcnt lgkmcnt(0)
  v_mfma_f32_32x32x16_bf16 v[32:47], v[176:179], v[200:203], v[32:47]
  s_waitcnt vmcnt(8)
  ds_read_b128 v[192:195], v10 offset:4096
  v_mfma_f32_32x32x16_bf16 v[48:63], v[176:179], v[204:207], v[48:63]
  ds_read_b128 v[196:199], v10 offset:5120
  ds_read_b64_tr_b16 v[160:161], v6 offset:8192
  ds_read_b64_tr_b16 v[162:163], v6 offset:9216
  v_mfma_f32_32x32x16_bf16 v[64:79], v[180:183], v[200:203], v[64:79]
  ds_read_b64_tr_b16 v[164:165], v7 offset:8192
  ds_read_b64_tr_b16 v[166:167], v7 offset:9216
  v_mfma_f32_32x32x16_bf16 v[80:95], v[180:183], v[204:207], v[80:95]
  ds_read_b64_tr_b16 v[168:169], v8 offset:8192
  ds_read_b64_tr_b16 v[170:171], v8 offset:9216
  v_mfma_f32_32x32x16_bf16 v[96:111], v[184:187], v[200:203], v[96:111]
  ds_read_b64_tr_b16 v[172:173], v9 offset:8192
  ds_read_b64_tr_b16 v[174:175], v9 offset:9216
  v_mfma_f32_32x32x16_bf16 v[112:127], v[184:187], v[204:207], v[112:127]
  s_add_u32 m0, s43, 4096
  s_nop 0
  buffer_load_dwordx4 v2, s[4:7], s44 offen lds
  v_mfma_f32_32x32x16_bf16 v[128:143], v[188:191], v[200:203], v[128:143]
  buffer_load_dwordx4 v3, s[4:7], s44 offen offset:1024 lds
  buffer_load_dwordx4 v4, s[4:7], s44 offen offset:2048 lds
  v_mfma_f32_32x32x16_bf16 v[144:159], v[188:191], v[204:207], v[144:159]
  buffer_load_dwordx4 v5, s[4:7], s44 offen offset:3072 lds
  s_add_u32 s44, s44, s49
  s_waitcnt lgkmcnt(0)
  v_mfma_f32_32x32x16_bf16 v[32:47], v[160:163], v[192:195], v[32:47]
  s_waitcnt vmcnt(8)
  ds_read_b128 v[200:203], v11 offset:6144
  v_mfma_f32_32x32x16_bf16 v[48:63], v[160:163], v[196:199], v[48:63]
  ds_read_b128 v[204:207], v11 offset:7168
  ds_read_b64_tr_b16 v[176:177], v6 offset:12288
  ds_read_b64_tr_b16 v[178:179], v6 offset:13312
  v_mfma_f32_32x32x16_bf16 v[64:79], v[164:167], v[192:195], v[64:79]
  ds_read_b64_tr_b16 v[180:181], v7 offset:12288
  ds_read_b64_tr_b16 v[182:183], v7 offset:13312
  v_mfma_f32_32x32x16_bf16 v[80:95], v[164:167], v[196:199], v[80:95]
  ds_read_b64_tr_b16 v[184:185], v8 offset:12288
  ds_read_b64_tr_b16 v[186:187], v8 offset:13312
  v_mfma_f32_32x32x16_bf16 v[96:111], v[168:171], v[192:195], v[96:111]
  ds_read_b64_tr_b16 v[188:189], v9 offset:12288
  ds_read_b64_tr_b16 v[190:191], v9 offset:13312
  v_mfma_f32_32x32x16_bf16 v[112:127], v[168:171], v[196:199], v[112:127]
  s_add_u32 m0, s43, 8192
  s_nop 0
  buffer_load_dwordx4 v2, s[4:7], s44 offen lds
  v_mfma_f32_32x32x16_bf16 v[128:143], v[172:175], v[192:195], v[128:143]
  buffer_load_dwordx4 v3, s[4:7], s44 offen offset:1024 lds
  buffer_load_dwordx4 v4, s[4:7], s44 offen offset:2048 lds
  v_mfma_f32_32x32x16_bf16 v[144:159], v[172:175], v[196:199], v[144:159]
  buffer_load_dwordx4 v5, s[4:7], s44 offen offset:3072 lds
  s_add_u32 s44, s44, s49
  s_waitcnt lgkmcnt(0)
  v_mfma_f32_32x32x16_bf16 v[32:47], v[176:179], v[200:203], v[32:47]
  s_waitcnt vmcnt(8)
  ds_read_b128 v[192:195], v10 offset:8192
  v_mfma_f32_32x32x16_bf16 v[48:63], v[176:179], v[204:207], v[48:63]
  ds_read_b128 v[196:199], v10 offset:9216
  ds_read_b64_tr_b16 v[160:161], v6 offset:0
  ds_read_b64_tr_b16 v[162:163], v6 offset:1024
  v_mfma_f32_32x32x16_bf16 v[64:79], v[180:183], v[200:203], v[64:79]
  ds_read_b64_tr_b16 v[164:165], v7 offset:0
  ds_read_b64_tr_b16 v[166:167], v7 offset:1024
  v_mfma_f32_32x32x16_bf16 v[80:95], v[180:183], v[204:207], v[80:95]
  ds_read_b64_tr_b16 v[168:169], v8 offset:0
  ds_read_b64_tr_b16 v[170:171], v8 offset:1024
  v_mfma_f32_32x32x16_bf16 v[96:111], v[184:187], v[200:203], v[96:111]
  ds_read_b64_tr_b16 v[172:173], v9 offset:0
  ds_read_b64_tr_b16 v[174:175], v9 offset:1024
  v_mfma_f32_32x32x16_bf16 v[112:127], v[184:187], v[204:207], v[112:127]
  s_add_u32 m0, s43, 12288
  s_nop 0
  buffer_load_dwordx4 v2, s[4:7], s44 offen lds
  v_mfma_f32_32x32x16_bf16 v[128:143], v[188:191], v[200:203], v[128:143]
  buffer_load_dwordx4 v3, s[4:7], s44 offen offset:1024 lds
  buffer_load_dwordx4 v4, s[4:7], s44 offen offset:2048 lds
  v_mfma_f32_32x32x16_bf16 v[144:159], v[188:191], v[204:207], v[144:159]
  buffer_load_dwordx4 v5, s[4:7], s44 offen offset:3072 lds
  s_add_u32 s44, s44, s49
  v_add_u32 v10, 8192, v10
  v_add_u32 v11, 8192, v11
  s_sub_u32 s45, s45, 1
  s_cmp_lg_u32 s45, 0
  s_cbranch_scc1 K1_OP_LOOP
  s_waitcnt lgkmcnt(0)
  v_mfma_f32_32x32x16_bf16 v[32:47], v[160:163], v[192:195], v[32:47]
  s_waitcnt vmcnt(8)
  v_mfma_f32_32x32x16_bf16 v[48:63], v[160:163], v[196:199], v[48:63]
  ds_read_b128 v[200:203], v11 offset:2048
  ds_read_b128 v[204:207], v11 offset:3072
  v_mfma_f32_32x32x16_bf16 v[64:79], v[164:167], v[192:195], v[64:79]
  ds_read_b64_tr_b16 v[176:177], v6 offset:4096
  v_mfma_f32_32x32x16_bf16 v[80:95], v[164:167], v[196:199], v[80:95]
  ds_read_b64_tr_b16 v[178:179], v6 offset:5120
  ds_read_b64_tr_b16 v[180:181], v7 offset:4096
  v_mfma_f32_32x32x16_bf16 v[96:111], v[168:171], v[192:195], v[96:111]
  ds_read_b64_tr_b16 v[182:183], v7 offset:5120
  v_mfma_f32_32x32x16_bf16 v[112:127], v[168:171], v[196:199], v[112:127]
  ds_read_b64_tr_b16 v[184:185], v8 offset:4096
  v_mfma_f32_32x32x16_bf16 v[128:143], v[172:175], v[192:195], v[128:143]
  ds_read_b64_tr_b16 v[186:187], v8 offset:5120
  ds_read_b64_tr_b16 v[188:189], v9 offset:4096
  v_mfma_f32_32x32x16_bf16 v[144:159], v[172:175], v[196:199], v[144:159]
  ds_read_b64_tr_b16 v[190:191], v9 offset:5120
  s_waitcnt lgkmcnt(0)
  v_mfma_f32_32x32x16_bf16 v[32:47], v[176:179], v[200:203], v[32:47]
  s_waitcnt vmcnt(4)
  v_mfma_f32_32x32x16_bf16 v[48:63], v[176:179], v[204:207], v[48:63]
  ds_read_b128 v[192:195], v10 offset:4096
  ds_read_b128 v[196:199], v10 offset:5120
  v_mfma_f32_32x32x16_bf16 v[64:79], v[180:183], v[200:203], v[64:79]
  ds_read_b64_tr_b16 v[160:161], v6 offset:8192
  v_mfma_f32_32x32x16_bf16 v[80:95], v[180:183], v[204:207], v[80:95]
  ds_read_b64_tr_b16 v[162:163], v6 offset:9216
  ds_read_b64_tr_b16 v[164:165], v7 offset:8192
  v_mfma_f32_32x32x16_bf16 v[96:111], v[184:187], v[200:203], v[96:111]
  ds_read_b64_tr_b16 v[166:167], v7 offset:9216
  v_mfma_f32_32x32x16_bf16 v[112:127], v[184:187], v[204:207], v[112:127]
  ds_read_b64_tr_b16 v[168:169], v8 offset:8192
  v_mfma_f32_32x32x16_bf16 v[128:143], v[188:191], v[200:203], v[128:143]
  ds_read_b64_tr_b16 v[170:171], v8 offset:9216
  ds_read_b64_tr_b16 v[172:173], v9 offset:8192
  v_mfma_f32_32x32x16_bf16 v[144:159], v[188:191], v[204:207], v[144:159]
  ds_read_b64_tr_b16 v[174:175], v9 offset:9216
  s_waitcnt lgkmcnt(0)
  v_mfma_f32_32x32x16_bf16 v[32:47], v[160:163], v[192:195], v[32:47]
  s_waitcnt vmcnt(0)
  v_mfma_f32_32x32x16_bf16 v[48:63], v[160:163], v[196:199], v[48:63]
  ds_read_b128 v[200:203], v11 offset:6144
  ds_read_b128 v[204:207], v11 offset:7168
  v_mfma_f32_32x32x16_bf16 v[64:79], v[164:167], v[192:195], v[64:79]
  ds_read_b64_tr_b16 v[176:177], v6 offset:12288
  v_mfma_f32_32x32x16_bf16 v[80:95], v[164:167], v[196:199], v[80:95]
  ds_read_b64_tr_b16 v[178:179], v6 offset:13312
  ds_read_b64_tr_b16 v[180:181], v7 offset:12288
  v_mfma_f32_32x32x16_bf16 v[96:111], v[168:171], v[192:195], v[96:111]
  ds_read_b64_tr_b16 v[182:183], v7 offset:13312
  v_mfma_f32_32x32x16_bf16 v[112:127], v[168:171], v[196:199], v[112:127]
  ds_read_b64_tr_b16 v[184:185], v8 offset:12288
  v_mfma_f32_32x32x16_bf16 v[128:143], v[172:175], v[192:195], v[128:143]
  ds_read_b64_tr_b16 v[186:187], v8 offset:13312
  ds_read_b64_tr_b16 v[188:189], v9 offset:12288
  v_mfma_f32_32x32x16_bf16 v[144:159], v[172:175], v[196:199], v[144:159]
  ds_read_b64_tr_b16 v[190:191], v9 offset:13312
  s_waitcnt lgkmcnt(0)
  v_mfma_f32_32x32x16_bf16 v[32:47], v[176:179], v[200:203], v[32:47]
  v_mfma_f32_32x32x16_bf16 v[48:63], v[176:179], v[204:207], v[48:63]
  v_mfma_f32_32x32x16_bf16 v[64:79], v[180:183], v[200:203], v[64:79]
  v_mfma_f32_32x32x16_bf16 v[80:95], v[180:183], v[204:207], v[80:95]
  v_mfma_f32_32x32x16_bf16 v[96:111], v[184:187], v[200:203], v[96:111]
  v_mfma_f32_32x32x16_bf16 v[112:127], v[184:187], v[204:207], v[112:127]
  v_mfma_f32_32x32x16_bf16 v[128:143], v[188:191], v[200:203], v[128:143]
  v_mfma_f32_32x32x16_bf16 v[144:159], v[188:191], v[204:207], v[144:159]
  s_nop 7
  s_mov_b32 s46, 0
  v_cvt_pk_bf16_f32 v160, v32, v33
  v_cvt_pk_bf16_f32 v161, v34, v35
  v_cvt_pk_bf16_f32 v162, v36, v37
  v_cvt_pk_bf16_f32 v163, v38, v39
  buffer_store_dwordx4 v[160:163], v24, s[24:27], s46 offen offset:0 sc1
  v_cvt_pk_bf16_f32 v164, v40, v41
  v_cvt_pk_bf16_f32 v165, v42, v43
  v_cvt_pk_bf16_f32 v166, v44, v45
  v_cvt_pk_bf16_f32 v167, v46, v47
  buffer_store_dwordx4 v[164:167], v24, s[24:27], s46 offen offset:1024 sc1
  v_cvt_pk_bf16_f32 v168, v48, v49
  v_cvt_pk_bf16_f32 v169, v50, v51
  v_cvt_pk_bf16_f32 v170, v52, v53
  v_cvt_pk_bf16_f32 v171, v54, v55
  buffer_store_dwordx4 v[168:171], v24, s[24:27], s46 offen offset:2048 sc1
  v_cvt_pk_bf16_f32 v172, v56, v57
  v_cvt_pk_bf16_f32 v173, v58, v59
  v_cvt_pk_bf16_f32 v174, v60, v61
  v_cvt_pk_bf16_f32 v175, v62, v63
  buffer_store_dwordx4 v[172:175], v24, s[24:27], s46 offen offset:3072 sc1
  s_mov_b32 s47, 4096
  v_cvt_pk_bf16_f32 v160, v64, v65
  v_cvt_pk_bf16_f32 v161, v66, v67
  v_cvt_pk_bf16_f32 v162, v68, v69
  v_cvt_pk_bf16_f32 v163, v70, v71
  buffer_store_dwordx4 v[160:163], v24, s[24:27], s47 offen offset:0 sc1
  v_cvt_pk_bf16_f32 v164, v72, v73
  v_cvt_pk_bf16_f32 v165, v74, v75
  v_cvt_pk_bf16_f32 v166, v76, v77
  v_cvt_pk_bf16_f32 v167, v78, v79
  buffer_store_dwordx4 v[164:167], v24, s[24:27], s47 offen offset:1024 sc1
  v_cvt_pk_bf16_f32 v168, v80, v81
  v_cvt_pk_bf16_f32 v169, v82, v83
  v_cvt_pk_bf16_f32 v170, v84, v85
  v_cvt_pk_bf16_f32 v171, v86, v87
  buffer_store_dwordx4 v[168:171], v24, s[24:27], s47 offen offset:2048 sc1
  v_cvt_pk_bf16_f32 v172, v88, v89
  v_cvt_pk_bf16_f32 v173, v90, v91
  v_cvt_pk_bf16_f32 v174, v92, v93
  v_cvt_pk_bf16_f32 v175, v94, v95
  buffer_store_dwordx4 v[172:175], v24, s[24:27], s47 offen offset:3072 sc1
  s_mov_b32 s46, 8192
  v_cvt_pk_bf16_f32 v160, v96, v97
  v_cvt_pk_bf16_f32 v161, v98, v99
  v_cvt_pk_bf16_f32 v162, v100, v101
  v_cvt_pk_bf16_f32 v163, v102, v103
  buffer_store_dwordx4 v[160:163], v24, s[24:27], s46 offen offset:0 sc1
  v_cvt_pk_bf16_f32 v164, v104, v105
  v_cvt_pk_bf16_f32 v165, v106, v107
  v_cvt_pk_bf16_f32 v166, v108, v109
  v_cvt_pk_bf16_f32 v167, v110, v111
  buffer_store_dwordx4 v[164:167], v24, s[24:27], s46 offen offset:1024 sc1
  v_cvt_pk_bf16_f32 v168, v112, v113
  v_cvt_pk_bf16_f32 v169, v114, v115
  v_cvt_pk_bf16_f32 v170, v116, v117
  v_cvt_pk_bf16_f32 v171, v118, v119
  buffer_store_dwordx4 v[168:171], v24, s[24:27], s46 offen offset:2048 sc1
  v_cvt_pk_bf16_f32 v172, v120, v121
  v_cvt_pk_bf16_f32 v173, v122, v123
  v_cvt_pk_bf16_f32 v174, v124, v125
  v_cvt_pk_bf16_f32 v175, v126, v127
  buffer_store_dwordx4 v[172:175], v24, s[24:27], s46 offen offset:3072 sc1
  s_mov_b32 s47, 12288
  v_cvt_pk_bf16_f32 v160, v128, v129
  v_cvt_pk_bf16_f32 v161, v130, v131
  v_cvt_pk_bf16_f32 v162, v132, v133
  v_cvt_pk_bf16_f32 v163, v134, v135
  buffer_store_dwordx4 v[160:163], v24, s[24:27], s47 offen offset:0 sc1
  v_cvt_pk_bf16_f32 v164, v136, v137
  v_cvt_pk_bf16_f32 v165, v138, v139
  v_cvt_pk_bf16_f32 v166, v140, v141
  v_cvt_pk_bf16_f32 v167, v142, v143
  buffer_store_dwordx4 v[164:167], v24, s[24:27], s47 offen offset:1024 sc1
  v_cvt_pk_bf16_f32 v168, v144, v145
  v_cvt_pk_bf16_f32 v169, v146, v147
  v_cvt_pk_bf16_f32 v170, v148, v149
  v_cvt_pk_bf16_f32 v171, v150, v151
  buffer_store_dwordx4 v[168:171], v24, s[24:27], s47 offen offset:2048 sc1
  v_cvt_pk_bf16_f32 v172, v152, v153
  v_cvt_pk_bf16_f32 v173, v154, v155
  v_cvt_pk_bf16_f32 v174, v156, v157
  v_cvt_pk_bf16_f32 v175, v158, v159
  buffer_store_dwordx4 v[172:175], v24, s[24:27], s47 offen offset:3072 sc1
K23_SEG:
  s_lshl_b32 s23, s34, 8
  s_lshl_b32 s22, s33, 2
  s_add_u32 s23, s23, s22
  s_load_dwordx4 s[60:63], s[0:1], 104
  s_load_dwordx2 s[54:55], s[0:1], 0
  s_load_dwordx4 s[56:59], s[0:1], 48
  s_bfe_u32 s3, s2, 0x20001
  s_lshl_b32 s3, s3, 6
  s_and_b32 s20, s2, 1
  s_lshl_b32 s20, s20, 5
  s_add_u32 s3, s3, s20
  s_lshr_b32 s20, s2, 3
  s_add_u32 s3, s3, s20
  s_mov_b32 s40, 0xffff0000
  s_mov_b32 s41, 0x3b000000
  s_mov_b32 s42, 0x3727c5ac
  v_and_b32 v1, 63, v0
  v_lshrrev_b32 v2, 6, v0
  v_and_b32 v3, 7, v0
  v_bfe_u32 v4, v0, 3, 3
  v_readfirstlane_b32 s8, v2
  v_lshlrev_b32 v5, 14, v2
  v_lshrrev_b32 v6, 2, v4
  v_lshl_add_u32 v5, v6, 12, v5
  v_and_b32 v6, 3, v4
  v_lshl_add_u32 v5, v6, 9, v5
  v_lshl_add_u32 v5, v3, 4, v5
  s_bfe_u32 s20, s3, 0x10002
  s_lshl_b32 s20, s20, 11
  s_and_b32 s21, s3, 3
  s_lshl_b32 s21, s21, 7
  s_add_u32 s20, s20, s21
  v_add_u32 v5, s20, v5
  v_add_u32 v6, 8192, v5
  v_lshl_add_u32 v7, v2, 4, v4
  v_lshlrev_b32 v8, 10, v3
  v_lshl_add_u32 v8, v7, 4, v8
  v_lshlrev_b32 v9, 5, v7
  v_lshlrev_b32 v10, 9, v7
  v_lshl_add_u32 v10, v3, 4, v10
  v_add_u32 v10, s21, v10
  v_add_u32 v11, 4096, v10
  v_lshlrev_b32 v12, 3, v3
  v_add_u32 v12, 131072, v12
  v_lshl_add_u32 v13, v2, 6, v12
  s_mov_b32 s44, 0
  s_mov_b32 s45, 2097152
  s_mov_b32 s46, 4194304
  s_mov_b32 s47, 6291456
  s_mov_b32 s48, 8388608
  s_mov_b32 s49, 10485760
  s_mov_b32 s50, 12582912
  s_mov_b32 s51, 14680064
  s_mov_b32 s52, 4096
  s_mov_b32 s53, 8192
  s_waitcnt lgkmcnt(0)
  s_lshl_b32 s22, s3, 13
  s_add_u32 s24, s54, s22
  s_addc_u32 s25, s55, 0
  s_mov_b32 s26, 0x2000
  s_mov_b32 s27, 0x20000
  s_mov_b32 s28, s62
  s_mov_b32 s29, s63
  s_mov_b32 s30, 0x3000
  s_mov_b32 s31, 0x20000
  s_lshr_b32 s22, s3, 3
  s_lshl_b32 s22, s22, 16
  s_add_u32 s16, s62, 0x2000000
  s_addc_u32 s17, s63, 0
  s_add_u32 s16, s16, s22
  s_addc_u32 s17, s17, 0
  s_mov_b32 s18, 0x1000000
  s_mov_b32 s19, 0x20000
  s_sub_u32 s18, s18, s22
  buffer_load_dwordx4 v[80:83], v8, s[24:27], 0 offen offset:0
  buffer_load_dwordx4 v[84:87], v8, s[24:27], 0 offen offset:128
  buffer_load_dwordx4 v[88:91], v9, s[28:31], s52 offen offset:0 sc1
  buffer_load_dwordx4 v[92:95], v9, s[28:31], s52 offen offset:16 sc1
  buffer_load_dwordx4 v[96:99], v9, s[28:31], s52 offen offset:256 sc1
  buffer_load_dwordx4 v[100:103], v9, s[28:31], s52 offen offset:272 sc1
  buffer_load_dwordx4 v[104:107], v9, s[28:31], s52 offen offset:2048 sc1
  buffer_load_dwordx4 v[120:123], v9, s[28:31], s53 offen offset:0 sc1
  buffer_load_dwordx4 v[108:111], v9, s[28:31], s52 offen offset:2064 sc1
  buffer_load_dwordx4 v[124:127], v9, s[28:31], s53 offen offset:16 sc1
  buffer_load_dwordx4 v[112:115], v9, s[28:31], s52 offen offset:2304 sc1
  buffer_load_dwordx4 v[128:131], v9, s[28:31], s53 offen offset:256 sc1
  buffer_load_dwordx4 v[116:119], v9, s[28:31], s52 offen offset:2320 sc1
  buffer_load_dwordx4 v[132:135], v9, s[28:31], s53 offen offset:272 sc1
  s_lshr_b32 s22, s3, 2
  s_lshl_b32 s22, s22, 15
  s_add_u32 s32, s62, 0x400000
  s_addc_u32 s33, s63, 0
  s_add_u32 s32, s32, s22
  s_addc_u32 s33, s33, 0
  s_mov_b32 s34, 0x8000
  s_mov_b32 s35, 0x20000
  s_add_u32 s36, s62, 0x600000
  s_addc_u32 s37, s63, 0
  s_add_u32 s36, s36, s22
  s_addc_u32 s37, s37, 0
  s_mov_b32 s38, 0x8000
  s_mov_b32 s39, 0x20000
  s_bfe_u32 s12, s2, 0x20001
  s_lshl_b32 s12, s12, 2
  s_bfe_u32 s20, s2, 0x20003
  s_add_u32 s12, s12, s20
  s_and_b32 s11, s2, 1
  s_mul_i32 s11, s11, 7
  s_lshr_b32 s20, s2, 5
  s_add_u32 s11, s11, s20
  s_min_u32 s11, s11, 13
  v_lshrrev_b32 v196, 4, v1
  v_and_b32 v197, 15, v1
  v_lshlrev_b32 v198, 2, v196
  v_xor_b32 v197, v197, v198
  v_mul_u32_u24 v196, 3584, v196
  v_lshl_add_u32 v192, v197, 4, v196
  v_add_u32 v193, 13312, v192
  v_add_u32 v194, 26624, v192
  v_add_u32 v195, 39936, v192
  s_lshl_b32 s9, s8, 12
  s_lshl_b32 s21, s11, 8
  s_mul_i32 s20, s8, 57344
  s_add_u32 s21, s21, s20
  s_add_u32 s4, s56, s21
  s_addc_u32 s5, s57, 0
  s_mov_b32 s6, 0x195300
  s_mov_b32 s7, 0x20000
  s_add_u32 s23, s23, 0x2f000
  v_mov_b32 v196, s23
  v_mov_b32 v197, 1
  s_waitcnt vmcnt(14)
  s_barrier
  s_cmp_lg_u32 s8, 0
  s_cbranch_scc1 K3_NOPUBP
  s_mov_b64 exec, 1
  global_store_dword v196, v197, s[62:63] sc1
  s_mov_b64 exec, -1
K3_NOPUBP:
  s_lshr_b32 s23, s3, 3
  s_lshl_b32 s23, s23, 8
  s_add_u32 s23, s23, 0x2f000
  v_lshlrev_b32 v196, 2, v3
  v_add_u32 v196, s23, v196
  s_mov_b32 s23, 0xff
  s_mov_b32 s14, 0
K3_POLLP:
  global_load_dword v197, v196, s[62:63] sc1
  s_waitcnt vmcnt(0)
  v_cmp_ne_u32 vcc, 0, v197
  s_nop 1
  s_and_b32 s22, vcc_lo, s23
  s_andn2_b32 s23, s23, s22
  s_bitcmp1_b32 s22, 0
  s_cbranch_scc0 K3_SKIP0
  buffer_load_dwordx4 v[16:19], v5, s[16:19], s44 offen sc1
  buffer_load_dwordx4 v[20:23], v6, s[16:19], s44 offen sc1
K3_SKIP0:
  s_bitcmp1_b32 s22, 1
  s_cbranch_scc0 K3_SKIP1
  buffer_load_dwordx4 v[24:27], v5, s[16:19], s45 offen sc1
  buffer_load_dwordx4 v[28:31], v6, s[16:19], s45 offen sc1
K3_SKIP1:
  s_bitcmp1_b32 s22, 2
  s_cbranch_scc0 K3_SKIP2
  buffer_load_dwordx4 v[32:35], v5, s[16:19], s46 offen sc1
  buffer_load_dwordx4 v[36:39], v6, s[16:19], s46 offen sc1
K3_SKIP2:
  s_bitcmp1_b32 s22, 3
  s_cbranch_scc0 K3_SKIP3
  buffer_load_dwordx4 v[40:43], v5, s[16:19], s47 offen sc1
  buffer_load_dwordx4 v[44:47], v6, s[16:19], s47 offen sc1
K3_SKIP3:
  s_bitcmp1_b32 s22, 4
  s_cbranch_scc0 K3_SKIP4
  buffer_load_dwordx4 v[48:51], v5, s[16:19], s48 offen sc1
  buffer_load_dwordx4 v[52:55], v6, s[16:19], s48 offen sc1
K3_SKIP4:
  s_bitcmp1_b32 s22, 5
  s_cbranch_scc0 K3_SKIP5
  buffer_load_dwordx4 v[56:59], v5, s[16:19], s49 offen sc1
  buffer_load_dwordx4 v[60:63], v6, s[16:19], s49 offen sc1
K3_SKIP5:
  s_bitcmp1_b32 s22, 6
  s_cbranch_scc0 K3_SKIP6
  buffer_load_dwordx4 v[64:67], v5, s[16:19], s50 offen sc1
  buffer_load_dwordx4 v[68:71], v6, s[16:19], s50 offen sc1
K3_SKIP6:
  s_bitcmp1_b32 s22, 7
  s_cbranch_scc0 K3_SKIP7
  buffer_load_dwordx4 v[72:75], v5, s[16:19], s51 offen sc1
  buffer_load_dwordx4 v[76:79], v6, s[16:19], s51 offen sc1
K3_SKIP7:
  s_cmp_lg_u32 s14, 0
  s_cbranch_scc1 K3_NOTFIRST
  s_add_u32 m0, s9, 0
  s_mov_b32 s10, 0
  buffer_load_dwordx4 v192, s[4:7], s10 offen offset:0 lds
  buffer_load_dwordx4 v193, s[4:7], s10 offen offset:1024 lds
  buffer_load_dwordx4 v194, s[4:7], s10 offen offset:2048 lds
  buffer_load_dwordx4 v195, s[4:7], s10 offen offset:3072 lds
  s_add_u32 m0, s9, 16384
  s_mov_b32 s10, 229376
  buffer_load_dwordx4 v192, s[4:7], s10 offen offset:0 lds
  buffer_load_dwordx4 v193, s[4:7], s10 offen offset:1024 lds
  buffer_load_dwordx4 v194, s[4:7], s10 offen offset:2048 lds
  buffer_load_dwordx4 v195, s[4:7], s10 offen offset:3072 lds
  s_add_u32 m0, s9, 32768
  s_mov_b32 s10, 458752
  buffer_load_dwordx4 v192, s[4:7], s10 offen offset:0 lds
  buffer_load_dwordx4 v193, s[4:7], s10 offen offset:1024 lds
  buffer_load_dwordx4 v194, s[4:7], s10 offen offset:2048 lds
  buffer_load_dwordx4 v195, s[4:7], s10 offen offset:3072 lds
  s_add_u32 m0, s9, 49152
  s_mov_b32 s10, 688128
  buffer_load_dwordx4 v192, s[4:7], s10 offen offset:0 lds
  buffer_load_dwordx4 v193, s[4:7], s10 offen offset:1024 lds
  buffer_load_dwordx4 v194, s[4:7], s10 offen offset:2048 lds
  buffer_load_dwordx4 v195, s[4:7], s10 offen offset:3072 lds
  s_add_u32 m0, s9, 65536
  s_mov_b32 s10, 917504
  buffer_load_dwordx4 v192, s[4:7], s10 offen offset:0 lds
  buffer_load_dwordx4 v193, s[4:7], s10 offen offset:1024 lds
  buffer_load_dwordx4 v194, s[4:7], s10 offen offset:2048 lds
  buffer_load_dwordx4 v195, s[4:7], s10 offen offset:3072 lds
  s_add_u32 m0, s9, 81920
  s_mov_b32 s10, 1146880
  buffer_load_dwordx4 v192, s[4:7], s10 offen offset:0 lds
  buffer_load_dwordx4 v193, s[4:7], s10 offen offset:1024 lds
  buffer_load_dwordx4 v194, s[4:7], s10 offen offset:2048 lds
  buffer_load_dwordx4 v195, s[4:7], s10 offen offset:3072 lds
  s_add_u32 m0, s9, 98304
  s_mov_b32 s10, 1376256
  buffer_load_dwordx4 v192, s[4:7], s10 offen offset:0 lds
  buffer_load_dwordx4 v193, s[4:7], s10 offen offset:1024 lds
  buffer_load_dwordx4 v194, s[4:7], s10 offen offset:2048 lds
  buffer_load_dwordx4 v195, s[4:7], s10 offen offset:3072 lds
  s_add_u32 m0, s9, 114688
  s_mov_b32 s10, 1605632
  buffer_load_dwordx4 v192, s[4:7], s10 offen offset:0 lds
  buffer_load_dwordx4 v193, s[4:7], s10 offen offset:1024 lds
  buffer_load_dwordx4 v194, s[4:7], s10 offen offset:2048 lds
  buffer_load_dwordx4 v195, s[4:7], s10 offen offset:3072 lds
  v_lshlrev_b32 v176, 16, v80
  v_and_b32 v177, s40, v80
  v_lshlrev_b32 v178, 16, v81
  v_and_b32 v179, s40, v81
  v_lshlrev_b32 v180, 16, v82
  v_and_b32 v181, s40, v82
  v_lshlrev_b32 v182, 16, v83
  v_and_b32 v183, s40, v83
  v_lshlrev_b32 v184, 16, v84
  v_and_b32 v185, s40, v84
  v_lshlrev_b32 v186, 16, v85
  v_and_b32 v187, s40, v85
  v_lshlrev_b32 v188, 16, v86
  v_and_b32 v189, s40, v86
  v_lshlrev_b32 v190, 16, v87
  v_and_b32 v191, s40, v87
  s_cmp_eq_u32 s23, 0
  s_cbranch_scc1 K3_ACC
K3_NOTFIRST:
  s_add_u32 s14, s14, 1
  s_cmp_eq_u32 s23, 0
  s_cbranch_scc1 K3_ALL
  s_cmp_lt_u32 s14, 0x100000
  s_cbranch_scc1 K3_POLLP
K3_ALL:
  s_waitcnt vmcnt(0)
K3_ACC:
  s_waitcnt vmcnt(46)
  v_lshlrev_b32 v136, 16, v16
  v_and_b32 v137, s40, v16
  v_lshlrev_b32 v138, 16, v17
  v_and_b32 v139, s40, v17
  v_lshlrev_b32 v140, 16, v18
  v_and_b32 v141, s40, v18
  v_lshlrev_b32 v142, 16, v19
  v_and_b32 v143, s40, v19
  v_lshlrev_b32 v144, 16, v20
  v_and_b32 v145, s40, v20
  v_lshlrev_b32 v146, 16, v21
  v_and_b32 v147, s40, v21
  v_lshlrev_b32 v148, 16, v22
  v_and_b32 v149, s40, v22
  v_lshlrev_b32 v150, 16, v23
  v_and_b32 v151, s40, v23
  s_waitcnt vmcnt(44)
  v_lshlrev_b32 v152, 16, v24
  v_and_b32 v153, s40, v24
  v_lshlrev_b32 v154, 16, v25
  v_and_b32 v155, s40, v25
  v_lshlrev_b32 v156, 16, v26
  v_and_b32 v157, s40, v26
  v_lshlrev_b32 v158, 16, v27
  v_and_b32 v159, s40, v27
  v_pk_add_f32 v[136:137], v[136:137], v[152:153]
  v_pk_add_f32 v[138:139], v[138:139], v[154:155]
  v_pk_add_f32 v[140:141], v[140:141], v[156:157]
  v_pk_add_f32 v[142:143], v[142:143], v[158:159]
  v_lshlrev_b32 v160, 16, v28
  v_and_b32 v161, s40, v28
  v_lshlrev_b32 v162, 16, v29
  v_and_b32 v163, s40, v29
  v_lshlrev_b32 v164, 16, v30
  v_and_b32 v165, s40, v30
  v_lshlrev_b32 v166, 16, v31
  v_and_b32 v167, s40, v31
  v_pk_add_f32 v[144:145], v[144:145], v[160:161]
  v_pk_add_f32 v[146:147], v[146:147], v[162:163]
  v_pk_add_f32 v[148:149], v[148:149], v[164:165]
  v_pk_add_f32 v[150:151], v[150:151], v[166:167]
  s_waitcnt vmcnt(42)
  v_lshlrev_b32 v152, 16, v32
  v_and_b32 v153, s40, v32
  v_lshlrev_b32 v154, 16, v33
  v_and_b32 v155, s40, v33
  v_lshlrev_b32 v156, 16, v34
  v_and_b32 v157, s40, v34
  v_lshlrev_b32 v158, 16, v35
  v_and_b32 v159, s40, v35
  v_pk_add_f32 v[136:137], v[136:137], v[152:153]
  v_pk_add_f32 v[138:139], v[138:139], v[154:155]
  v_pk_add_f32 v[140:141], v[140:141], v[156:157]
  v_pk_add_f32 v[142:143], v[142:143], v[158:159]
  v_lshlrev_b32 v160, 16, v36
  v_and_b32 v161, s40, v36
  v_lshlrev_b32 v162, 16, v37
  v_and_b32 v163, s40, v37
  v_lshlrev_b32 v164, 16, v38
  v_and_b32 v165, s40, v38
  v_lshlrev_b32 v166, 16, v39
  v_and_b32 v167, s40, v39
  v_pk_add_f32 v[144:145], v[144:145], v[160:161]
  v_pk_add_f32 v[146:147], v[146:147], v[162:163]
  v_pk_add_f32 v[148:149], v[148:149], v[164:165]
  v_pk_add_f32 v[150:151], v[150:151], v[166:167]
  s_waitcnt vmcnt(40)
  v_lshlrev_b32 v152, 16, v40
  v_and_b32 v153, s40, v40
  v_lshlrev_b32 v154, 16, v41
  v_and_b32 v155, s40, v41
  v_lshlrev_b32 v156, 16, v42
  v_and_b32 v157, s40, v42
  v_lshlrev_b32 v158, 16, v43
  v_and_b32 v159, s40, v43
  v_pk_add_f32 v[136:137], v[136:137], v[152:153]
  v_pk_add_f32 v[138:139], v[138:139], v[154:155]
  v_pk_add_f32 v[140:141], v[140:141], v[156:157]
  v_pk_add_f32 v[142:143], v[142:143], v[158:159]
  v_lshlrev_b32 v160, 16, v44
  v_and_b32 v161, s40, v44
  v_lshlrev_b32 v162, 16, v45
  v_and_b32 v163, s40, v45
  v_lshlrev_b32 v164, 16, v46
  v_and_b32 v165, s40, v46
  v_lshlrev_b32 v166, 16, v47
  v_and_b32 v167, s40, v47
  v_pk_add_f32 v[144:145], v[144:145], v[160:161]
  v_pk_add_f32 v[146:147], v[146:147], v[162:163]
  v_pk_add_f32 v[148:149], v[148:149], v[164:165]
  v_pk_add_f32 v[150:151], v[150:151], v[166:167]
  s_waitcnt vmcnt(38)
  v_lshlrev_b32 v152, 16, v48
  v_and_b32 v153, s40, v48
  v_lshlrev_b32 v154, 16, v49
  v_and_b32 v155, s40, v49
  v_lshlrev_b32 v156, 16, v50
  v_and_b32 v157, s40, v50
  v_lshlrev_b32 v158, 16, v51
  v_and_b32 v159, s40, v51
  v_pk_add_f32 v[136:137], v[136:137], v[152:153]
  v_pk_add_f32 v[138:139], v[138:139], v[154:155]
  v_pk_add_f32 v[140:141], v[140:141], v[156:157]
  v_pk_add_f32 v[142:143], v[142:143], v[158:159]
  v_lshlrev_b32 v160, 16, v52
  v_and_b32 v161, s40, v52
  v_lshlrev_b32 v162, 16, v53
  v_and_b32 v163, s40, v53
  v_lshlrev_b32 v164, 16, v54
  v_and_b32 v165, s40, v54
  v_lshlrev_b32 v166, 16, v55
  v_and_b32 v167, s40, v55
  v_pk_add_f32 v[144:145], v[144:145], v[160:161]
  v_pk_add_f32 v[146:147], v[146:147], v[162:163]
  v_pk_add_f32 v[148:149], v[148:149], v[164:165]
  v_pk_add_f32 v[150:151], v[150:151], v[166:167]
  s_waitcnt vmcnt(36)
  v_lshlrev_b32 v152, 16, v56
  v_and_b32 v153, s40, v56
  v_lshlrev_b32 v154, 16, v57
  v_and_b32 v155, s40, v57
  v_lshlrev_b32 v156, 16, v58
  v_and_b32 v157, s40, v58
  v_lshlrev_b32 v158, 16, v59
  v_and_b32 v159, s40, v59
  v_pk_add_f32 v[136:137], v[136:137], v[152:153]
  v_pk_add_f32 v[138:139], v[138:139], v[154:155]
  v_pk_add_f32 v[140:141], v[140:141], v[156:157]
  v_pk_add_f32 v[142:143], v[142:143], v[158:159]
  v_lshlrev_b32 v160, 16, v60
  v_and_b32 v161, s40, v60
  v_lshlrev_b32 v162, 16, v61
  v_and_b32 v163, s40, v61
  v_lshlrev_b32 v164, 16, v62
  v_and_b32 v165, s40, v62
  v_lshlrev_b32 v166, 16, v63
  v_and_b32 v167, s40, v63
  v_pk_add_f32 v[144:145], v[144:145], v[160:161]
  v_pk_add_f32 v[146:147], v[146:147], v[162:163]
  v_pk_add_f32 v[148:149], v[148:149], v[164:165]
  v_pk_add_f32 v[150:151], v[150:151], v[166:167]
  s_waitcnt vmcnt(34)
  v_lshlrev_b32 v152, 16, v64
  v_and_b32 v153, s40, v64
  v_lshlrev_b32 v154, 16, v65
  v_and_b32 v155, s40, v65
  v_lshlrev_b32 v156, 16, v66
  v_and_b32 v157, s40, v66
  v_lshlrev_b32 v158, 16, v67
  v_and_b32 v159, s40, v67
  v_pk_add_f32 v[136:137], v[136:137], v[152:153]
  v_pk_add_f32 v[138:139], v[138:139], v[154:155]
  v_pk_add_f32 v[140:141], v[140:141], v[156:157]
  v_pk_add_f32 v[142:143], v[142:143], v[158:159]
  v_lshlrev_b32 v160, 16, v68
  v_and_b32 v161, s40, v68
  v_lshlrev_b32 v162, 16, v69
  v_and_b32 v163, s40, v69
  v_lshlrev_b32 v164, 16, v70
  v_and_b32 v165, s40, v70
  v_lshlrev_b32 v166, 16, v71
  v_and_b32 v167, s40, v71
  v_pk_add_f32 v[144:145], v[144:145], v[160:161]
  v_pk_add_f32 v[146:147], v[146:147], v[162:163]
  v_pk_add_f32 v[148:149], v[148:149], v[164:165]
  v_pk_add_f32 v[150:151], v[150:151], v[166:167]
  s_waitcnt vmcnt(32)
  v_lshlrev_b32 v152, 16, v72
  v_and_b32 v153, s40, v72
  v_lshlrev_b32 v154, 16, v73
  v_and_b32 v155, s40, v73
  v_lshlrev_b32 v156, 16, v74
  v_and_b32 v157, s40, v74
  v_lshlrev_b32 v158, 16, v75
  v_and_b32 v159, s40, v75
  v_pk_add_f32 v[136:137], v[136:137], v[152:153]
  v_pk_add_f32 v[138:139], v[138:139], v[154:155]
  v_pk_add_f32 v[140:141], v[140:141], v[156:157]
  v_pk_add_f32 v[142:143], v[142:143], v[158:159]
  v_lshlrev_b32 v160, 16, v76
  v_and_b32 v161, s40, v76
  v_lshlrev_b32 v162, 16, v77
  v_and_b32 v163, s40, v77
  v_lshlrev_b32 v164, 16, v78
  v_and_b32 v165, s40, v78
  v_lshlrev_b32 v166, 16, v79
  v_and_b32 v167, s40, v79
  v_pk_add_f32 v[144:145], v[144:145], v[160:161]
  v_pk_add_f32 v[146:147], v[146:147], v[162:163]
  v_pk_add_f32 v[148:149], v[148:149], v[164:165]
  v_pk_add_f32 v[150:151], v[150:151], v[166:167]
  v_pk_fma_f32 v[136:137], v[136:137], v[88:89], v[176:177]
  v_pk_fma_f32 v[138:139], v[138:139], v[90:91], v[178:179]
  v_pk_fma_f32 v[140:141], v[140:141], v[92:93], v[180:181]
  v_pk_fma_f32 v[142:143], v[142:143], v[94:95], v[182:183]
  v_pk_fma_f32 v[144:145], v[144:145], v[96:97], v[184:185]
  v_pk_fma_f32 v[146:147], v[146:147], v[98:99], v[186:187]
  v_pk_fma_f32 v[148:149], v[148:149], v[100:101], v[188:189]
  v_pk_fma_f32 v[150:151], v[150:151], v[102:103], v[190:191]
  v_cvt_pk_bf16_f32 v16, v136, v137
  v_cvt_pk_bf16_f32 v17, v138, v139
  v_cvt_pk_bf16_f32 v18, v140, v141
  v_cvt_pk_bf16_f32 v19, v142, v143
  v_cvt_pk_bf16_f32 v20, v144, v145
  v_cvt_pk_bf16_f32 v21, v146, v147
  v_cvt_pk_bf16_f32 v22, v148, v149
  v_cvt_pk_bf16_f32 v23, v150, v151
  v_pk_add_f32 v[152:153], v[136:137], 0 op_sel_hi:[1,0]
  v_pk_mul_f32 v[154:155], v[136:137], v[136:137]
  v_pk_add_f32 v[152:153], v[152:153], v[138:139]
  v_pk_fma_f32 v[154:155], v[138:139], v[138:139], v[154:155]
  v_pk_add_f32 v[152:153], v[152:153], v[140:141]
  v_pk_fma_f32 v[154:155], v[140:141], v[140:141], v[154:155]
  v_pk_add_f32 v[152:153], v[152:153], v[142:143]
  v_pk_fma_f32 v[154:155], v[142:143], v[142:143], v[154:155]
  v_pk_add_f32 v[152:153], v[152:153], v[144:145]
  v_pk_fma_f32 v[154:155], v[144:145], v[144:145], v[154:155]
  v_pk_add_f32 v[152:153], v[152:153], v[146:147]
  v_pk_fma_f32 v[154:155], v[146:147], v[146:147], v[154:155]
  v_pk_add_f32 v[152:153], v[152:153], v[148:149]
  v_pk_fma_f32 v[154:155], v[148:149], v[148:149], v[154:155]
  v_pk_add_f32 v[152:153], v[152:153], v[150:151]
  v_pk_fma_f32 v[154:155], v[150:151], v[150:151], v[154:155]
  v_add_f32 v14, v152, v153
  v_add_f32 v15, v154, v155
  s_nop 0
  v_add_f32_dpp v14, v14, v14 row_ror:8 row_mask:0xf bank_mask:0xf
  v_add_f32_dpp v15, v15, v15 row_ror:8 row_mask:0xf bank_mask:0xf
  v_mov_b32 v152, v14
  v_mov_b32 v153, v15
  s_nop 0
  v_permlane16_swap_b32 v14, v152
  v_permlane16_swap_b32 v15, v153
  v_add_f32 v14, v14, v152
  v_add_f32 v15, v15, v153
  v_mov_b32 v152, v14
  v_mov_b32 v153, v15
  s_nop 0
  v_permlane32_swap_b32 v14, v152
  v_permlane32_swap_b32 v15, v153
  v_add_f32 v14, v14, v152
  v_add_f32 v15, v15, v153
  ds_write_b64 v13, v[14:15]
  s_waitcnt lgkmcnt(0)
  s_barrier
  ds_read_b64 v[152:153], v12 offset:0
  ds_read_b64 v[154:155], v12 offset:64
  ds_read_b64 v[156:157], v12 offset:128
  ds_read_b64 v[158:159], v12 offset:192
  s_waitcnt lgkmcnt(0)
  v_pk_add_f32 v[152:153], v[152:153], v[154:155]
  v_pk_add_f32 v[156:157], v[156:157], v[158:159]
  v_pk_add_f32 v[152:153], v[152:153], v[156:157]
  v_mul_f32 v152, s41, v152
  v_mul_f32 v153, s41, v153
  v_fma_f32 v153, -v152, v152, v153
  v_max_f32 v153, 0, v153
  v_add_f32 v153, s42, v153
  v_rsq_f32 v153, v153
  s_nop 0
  v_mul_f32_e64 v152, -v152, v153
  v_pk_fma_f32 v[136:137], v[136:137], v[152:153], v[152:153] op_sel:[0,1,0] op_sel_hi:[1,1,0]
  v_pk_fma_f32 v[138:139], v[138:139], v[152:153], v[152:153] op_sel:[0,1,0] op_sel_hi:[1,1,0]
  v_pk_fma_f32 v[140:141], v[140:141], v[152:153], v[152:153] op_sel:[0,1,0] op_sel_hi:[1,1,0]
  v_pk_fma_f32 v[142:143], v[142:143], v[152:153], v[152:153] op_sel:[0,1,0] op_sel_hi:[1,1,0]
  v_pk_fma_f32 v[144:145], v[144:145], v[152:153], v[152:153] op_sel:[0,1,0] op_sel_hi:[1,1,0]
  v_pk_fma_f32 v[146:147], v[146:147], v[152:153], v[152:153] op_sel:[0,1,0] op_sel_hi:[1,1,0]
  v_pk_fma_f32 v[148:149], v[148:149], v[152:153], v[152:153] op_sel:[0,1,0] op_sel_hi:[1,1,0]
  v_pk_fma_f32 v[150:151], v[150:151], v[152:153], v[152:153] op_sel:[0,1,0] op_sel_hi:[1,1,0]
  v_pk_fma_f32 v[136:137], v[136:137], v[120:121], v[104:105]
  v_pk_fma_f32 v[138:139], v[138:139], v[122:123], v[106:107]
  v_pk_fma_f32 v[140:141], v[140:141], v[124:125], v[108:109]
  v_pk_fma_f32 v[142:143], v[142:143], v[126:127], v[110:111]
  v_pk_fma_f32 v[144:145], v[144:145], v[128:129], v[112:113]
  v_pk_fma_f32 v[146:147], v[146:147], v[130:131], v[114:115]
  v_pk_fma_f32 v[148:149], v[148:149], v[132:133], v[116:117]
  v_pk_fma_f32 v[150:151], v[150:151], v[134:135], v[118:119]
  v_cvt_pk_bf16_f32 v24, v136, v137
  v_cvt_pk_bf16_f32 v25, v138, v139
  v_cvt_pk_bf16_f32 v26, v140, v141
  v_cvt_pk_bf16_f32 v27, v142, v143
  v_cvt_pk_bf16_f32 v28, v144, v145
  v_cvt_pk_bf16_f32 v29, v146, v147
  v_cvt_pk_bf16_f32 v30, v148, v149
  v_cvt_pk_bf16_f32 v31, v150, v151
  buffer_store_dwordx4 v[24:27], v10, s[36:39], 0 offen sc1
  buffer_store_dwordx4 v[28:31], v11, s[36:39], 0 offen sc1
  buffer_store_dwordx4 v[16:19], v10, s[32:35], 0 offen sc1
  buffer_store_dwordx4 v[20:23], v11, s[32:35], 0 offen sc1
  s_lshl_b32 s13, s8, 13
  s_add_u32 s13, s13, 131072
  s_lshr_b32 s15, s8, 1
  s_lshl_b32 s15, s15, 15
  s_and_b32 s20, s8, 1
  s_lshl_b32 s20, s20, 12
  s_add_u32 s15, s15, s20
  s_lshl_b32 s20, s12, 17
  s_add_u32 s20, s20, s15
  s_add_u32 s16, s62, 0x600000
  s_addc_u32 s17, s63, 0
  s_add_u32 s16, s16, s20
  s_addc_u32 s17, s17, 0
  s_mov_b32 s18, 0x17000
  s_mov_b32 s19, 0x20000
  v_lshlrev_b32 v7, 4, v1
  s_mov_b32 s22, 0xbdd2d3e8
  v_lshrrev_b32 v8, 5, v1
  v_lshlrev_b32 v8, 11, v8
  v_bfe_u32 v9, v1, 2, 2
  v_lshl_add_u32 v8, v9, 8, v8
  v_xor_b32 v9, s8, v9
  v_lshl_add_u32 v8, v9, 6, v8
  v_bfe_u32 v9, v1, 4, 1
  v_lshl_add_u32 v8, v9, 5, v8
  v_and_b32 v9, 1, v1
  v_lshl_add_u32 v8, v9, 4, v8
  v_bfe_u32 v9, v1, 1, 1
  v_lshl_add_u32 v2, v9, 3, v8
  v_add_u32 v3, 0x10000, v2
  v_mov_b32 v4, v7
  v_add_u32 v5, 0x10000, v7
  v_lshrrev_b32 v8, 3, v1
  v_lshlrev_b32 v8, 12, v8
  v_and_b32 v9, 7, v1
  v_lshrrev_b32 v10, 4, v1
  v_xor_b32 v9, v9, v10
  v_lshl_add_u32 v160, v9, 4, v8
  v_xor_b32 v9, 4, v9
  v_lshl_add_u32 v161, v9, 4, v8
  v_add_u32 v161, 31744, v161
  v_add_u32 v162, 63488, v160
  v_add_u32 v163, 63488, v161
  v_add_u32 v164, 131072, v160
  v_add_u32 v165, 131072, v161
  v_add_u32 v166, 194560, v160
  v_add_u32 v167, 194560, v161
  v_and_b32 v8, 15, v1
  v_lshrrev_b32 v9, 1, v8
  v_xor_b32 v9, v9, v10
  v_lshlrev_b32 v8, 7, v8
  v_add_u32 v8, s13, v8
  v_lshl_add_u32 v168, v9, 4, v8
  v_xor_b32 v9, 4, v9
  v_lshl_add_u32 v169, v9, 4, v8
  s_bfe_u32 s20, s2, 0x20001
  s_lshl_b32 s20, s20, 3
  s_bfe_u32 s21, s2, 0x30003
  s_add_u32 s20, s20, s21
  s_lshl_b32 s20, s20, 18
  s_lshl_b32 s21, s8, 10
  s_add_u32 s20, s20, s21
  s_lshl_b32 s49, s8, 14
  s_add_u32 s44, s58, s20
  s_addc_u32 s45, s59, 0
  s_mov_b32 s46, 0x3f400
  s_mov_b32 s47, 0x20000
  s_lshr_b32 s3, s3, 4
  s_lshl_b32 s3, s3, 8
  s_add_u32 s3, s3, 0x2c000
  v_mov_b32 v8, s3
  v_mov_b32 v9, 1
  s_waitcnt vmcnt(0)
  s_barrier
  s_cmp_lg_u32 s8, 0
  s_cbranch_scc1 K3_NOPUB
  s_mov_b64 exec, 1
  global_atomic_add v8, v9, s[62:63]
  s_mov_b64 exec, -1
K3_NOPUB:
  s_cmp_ge_u32 s2, 224
  s_cbranch_scc1 K3_WOF
  v_mov_b32 v151, 0xc0135761
  ds_read_b64_tr_b16 a[0:1], v2 offset:0
  ds_read_b64_tr_b16 a[2:3], v2 offset:1024
  ds_read_b64_tr_b16 a[4:5], v2 offset:4096
  ds_read_b64_tr_b16 a[6:7], v2 offset:5120
  ds_read_b64_tr_b16 a[8:9], v2 offset:8192
  ds_read_b64_tr_b16 a[10:11], v2 offset:9216
  ds_read_b64_tr_b16 a[12:13], v2 offset:12288
  ds_read_b64_tr_b16 a[14:15], v2 offset:13312
  ds_read_b64_tr_b16 a[16:17], v2 offset:16384
  ds_read_b64_tr_b16 a[18:19], v2 offset:17408
  ds_read_b64_tr_b16 a[20:21], v2 offset:20480
  ds_read_b64_tr_b16 a[22:23], v2 offset:21504
  ds_read_b64_tr_b16 a[24:25], v2 offset:24576
  ds_read_b64_tr_b16 a[26:27], v2 offset:25600
  ds_read_b64_tr_b16 a[28:29], v2 offset:28672
  ds_read_b64_tr_b16 a[30:31], v2 offset:29696
  ds_read_b64_tr_b16 a[32:33], v2 offset:32768
  ds_read_b64_tr_b16 a[34:35], v2 offset:33792
  ds_read_b64_tr_b16 a[36:37], v2 offset:36864
  ds_read_b64_tr_b16 a[38:39], v2 offset:37888
  ds_read_b64_tr_b16 a[40:41], v2 offset:40960
  ds_read_b64_tr_b16 a[42:43], v2 offset:41984
  ds_read_b64_tr_b16 a[44:45], v2 offset:45056
  ds_read_b64_tr_b16 a[46:47], v2 offset:46080
  ds_read_b64_tr_b16 a[48:49], v2 offset:49152
  ds_read_b64_tr_b16 a[50:51], v2 offset:50176
  ds_read_b64_tr_b16 a[52:53], v2 offset:53248
  ds_read_b64_tr_b16 a[54:55], v2 offset:54272
  ds_read_b64_tr_b16 a[56:57], v2 offset:57344
  ds_read_b64_tr_b16 a[58:59], v2 offset:58368
  ds_read_b64_tr_b16 a[60:61], v2 offset:61440
  ds_read_b64_tr_b16 a[62:63], v2 offset:62464
  ds_read_b64_tr_b16 a[64:65], v3 offset:0
  ds_read_b64_tr_b16 a[66:67], v3 offset:1024
  ds_read_b64_tr_b16 a[68:69], v3 offset:4096
  ds_read_b64_tr_b16 a[70:71], v3 offset:5120
  ds_read_b64_tr_b16 a[72:73], v3 offset:8192
  ds_read_b64_tr_b16 a[74:75], v3 offset:9216
  ds_read_b64_tr_b16 a[76:77], v3 offset:12288
  ds_read_b64_tr_b16 a[78:79], v3 offset:13312
  ds_read_b64_tr_b16 a[80:81], v3 offset:16384
  ds_read_b64_tr_b16 a[82:83], v3 offset:17408
  ds_read_b64_tr_b16 a[84:85], v3 offset:20480
  ds_read_b64_tr_b16 a[86:87], v3 offset:21504
  ds_read_b64_tr_b16 a[88:89], v3 offset:24576
  ds_read_b64_tr_b16 a[90:91], v3 offset:25600
  ds_read_b64_tr_b16 a[92:93], v3 offset:28672
  ds_read_b64_tr_b16 a[94:95], v3 offset:29696
  ds_read_b64_tr_b16 a[96:97], v3 offset:32768
  ds_read_b64_tr_b16 a[98:99], v3 offset:33792
  ds_read_b64_tr_b16 a[100:101], v3 offset:36864
  ds_read_b64_tr_b16 a[102:103], v3 offset:37888
  ds_read_b64_tr_b16 a[104:105], v3 offset:40960
  ds_read_b64_tr_b16 a[106:107], v3 offset:41984
  ds_read_b64_tr_b16 a[108:109], v3 offset:45056
  ds_read_b64_tr_b16 a[110:111], v3 offset:46080
  ds_read_b64_tr_b16 a[112:113], v3 offset:49152
  ds_read_b64_tr_b16 a[114:115], v3 offset:50176
  ds_read_b64_tr_b16 a[116:117], v3 offset:53248
  ds_read_b64_tr_b16 a[118:119], v3 offset:54272
  ds_read_b64_tr_b16 a[120:121], v3 offset:57344
  ds_read_b64_tr_b16 a[122:123], v3 offset:58368
  ds_read_b64_tr_b16 a[124:125], v3 offset:61440
  ds_read_b64_tr_b16 a[126:127], v3 offset:62464
  s_cmp_lg_u32 s8, 0
  s_cbranch_scc1 K3_NOPOLL
  s_lshl_b32 s20, s12, 8
  s_add_u32 s20, s20, 0x2c000
  v_mov_b32 v8, s20
  s_mov_b32 s14, 0
K3_POLLH:
  global_load_dword v9, v8, s[62:63] sc1
  s_waitcnt vmcnt(0)
  v_readfirstlane_b32 s20, v9
  s_add_u32 s14, s14, 1
  s_cmp_ge_u32 s20, 16
  s_cbranch_scc1 K3_NOPOLL
  s_cmp_lt_u32 s14, 0x100000
  s_cbranch_scc1 K3_POLLH
K3_NOPOLL:
  s_waitcnt lgkmcnt(0)
  s_barrier
  s_add_u32 m0, s15, 0
  s_mov_b32 s20, 0
  buffer_load_dwordx4 v7, s[16:19], s20 offen offset:0 sc1 lds
  buffer_load_dwordx4 v7, s[16:19], s20 offen offset:1024 sc1 lds
  buffer_load_dwordx4 v7, s[16:19], s20 offen offset:2048 sc1 lds
  buffer_load_dwordx4 v7, s[16:19], s20 offen offset:3072 sc1 lds
  s_add_u32 m0, s15, 8192
  s_mov_b32 s20, 8192
  buffer_load_dwordx4 v7, s[16:19], s20 offen offset:0 sc1 lds
  buffer_load_dwordx4 v7, s[16:19], s20 offen offset:1024 sc1 lds
  buffer_load_dwordx4 v7, s[16:19], s20 offen offset:2048 sc1 lds
  buffer_load_dwordx4 v7, s[16:19], s20 offen offset:3072 sc1 lds
  s_add_u32 m0, s15, 16384
  s_mov_b32 s20, 16384
  buffer_load_dwordx4 v7, s[16:19], s20 offen offset:0 sc1 lds
  buffer_load_dwordx4 v7, s[16:19], s20 offen offset:1024 sc1 lds
  buffer_load_dwordx4 v7, s[16:19], s20 offen offset:2048 sc1 lds
  buffer_load_dwordx4 v7, s[16:19], s20 offen offset:3072 sc1 lds
  s_waitcnt vmcnt(8)
  s_barrier
  ds_read_b128 v[88:91], v4 offset:0
  ds_read_b128 v[92:95], v4 offset:32768
  ds_read_b128 v[96:99], v4 offset:1024
  ds_read_b128 v[100:103], v4 offset:33792
  s_waitcnt lgkmcnt(2)
  v_mfma_f32_32x32x16_bf16 v[16:31], a[0:3], v[88:91], 0
  ds_read_b128 v[104:107], v4 offset:2048
  ds_read_b128 v[108:111], v4 offset:34816
  v_mfma_f32_32x32x16_bf16 v[32:47], a[0:3], v[92:95], 0
  s_add_u32 m0, s15, 24576
  s_mov_b32 s20, 24576
  buffer_load_dwordx4 v7, s[16:19], s20 offen offset:0 sc1 lds
  buffer_load_dwordx4 v7, s[16:19], s20 offen offset:1024 sc1 lds
  buffer_load_dwordx4 v7, s[16:19], s20 offen offset:2048 sc1 lds
  buffer_load_dwordx4 v7, s[16:19], s20 offen offset:3072 sc1 lds
  s_waitcnt lgkmcnt(2)
  v_mfma_f32_32x32x16_bf16 v[16:31], a[4:7], v[96:99], v[16:31]
  ds_read_b128 v[112:115], v4 offset:3072
  v_mfma_f32_32x32x16_bf16 v[32:47], a[4:7], v[100:103], v[32:47]
  ds_read_b128 v[116:119], v4 offset:35840
  s_waitcnt lgkmcnt(2)
  v_mfma_f32_32x32x16_bf16 v[16:31], a[8:11], v[104:107], v[16:31]
  ds_read_b128 v[88:91], v4 offset:4096
  v_mfma_f32_32x32x16_bf16 v[32:47], a[8:11], v[108:111], v[32:47]
  ds_read_b128 v[92:95], v4 offset:36864
  s_waitcnt lgkmcnt(2)
  v_mfma_f32_32x32x16_bf16 v[16:31], a[12:15], v[112:115], v[16:31]
  ds_read_b128 v[96:99], v4 offset:5120
  v_mfma_f32_32x32x16_bf16 v[32:47], a[12:15], v[116:119], v[32:47]
  ds_read_b128 v[100:103], v4 offset:37888
  s_waitcnt lgkmcnt(2)
  v_mfma_f32_32x32x16_bf16 v[16:31], a[16:19], v[88:91], v[16:31]
  ds_read_b128 v[104:107], v4 offset:6144
  ds_read_b128 v[108:111], v4 offset:38912
  v_mfma_f32_32x32x16_bf16 v[32:47], a[16:19], v[92:95], v[32:47]
  s_add_u32 m0, s15, 65536
  s_mov_b32 s20, 65536
  buffer_load_dwordx4 v7, s[16:19], s20 offen offset:0 sc1 lds
  buffer_load_dwordx4 v7, s[16:19], s20 offen offset:1024 sc1 lds
  buffer_load_dwordx4 v7, s[16:19], s20 offen offset:2048 sc1 lds
  buffer_load_dwordx4 v7, s[16:19], s20 offen offset:3072 sc1 lds
  s_waitcnt lgkmcnt(2)
  v_mfma_f32_32x32x16_bf16 v[16:31], a[20:23], v[96:99], v[16:31]
  ds_read_b128 v[112:115], v4 offset:7168
  v_mfma_f32_32x32x16_bf16 v[32:47], a[20:23], v[100:103], v[32:47]
  ds_read_b128 v[116:119], v4 offset:39936
  s_waitcnt lgkmcnt(2)
  v_mfma_f32_32x32x16_bf16 v[16:31], a[24:27], v[104:107], v[16:31]
  s_waitcnt vmcnt(12)
  s_barrier
  v_mfma_f32_32x32x16_bf16 v[32:47], a[24:27], v[108:111], v[32:47]
  ds_read_b128 v[88:91], v4 offset:8192
  ds_read_b128 v[92:95], v4 offset:40960
  s_waitcnt lgkmcnt(2)
  v_mfma_f32_32x32x16_bf16 v[16:31], a[28:31], v[112:115], v[16:31]
  ds_read_b128 v[96:99], v4 offset:9216
  v_mfma_f32_32x32x16_bf16 v[32:47], a[28:31], v[116:119], v[32:47]
  ds_read_b128 v[100:103], v4 offset:41984
  s_waitcnt lgkmcnt(2)
  v_mfma_f32_32x32x16_bf16 v[16:31], a[32:35], v[88:91], v[16:31]
  ds_read_b128 v[104:107], v4 offset:10240
  ds_read_b128 v[108:111], v4 offset:43008
  v_mfma_f32_32x32x16_bf16 v[32:47], a[32:35], v[92:95], v[32:47]
  s_add_u32 m0, s15, 73728
  s_mov_b32 s20, 73728
  buffer_load_dwordx4 v7, s[16:19], s20 offen offset:0 sc1 lds
  buffer_load_dwordx4 v7, s[16:19], s20 offen offset:1024 sc1 lds
  buffer_load_dwordx4 v7, s[16:19], s20 offen offset:2048 sc1 lds
  buffer_load_dwordx4 v7, s[16:19], s20 offen offset:3072 sc1 lds
  s_waitcnt lgkmcnt(2)
  v_mfma_f32_32x32x16_bf16 v[16:31], a[36:39], v[96:99], v[16:31]
  ds_read_b128 v[112:115], v4 offset:11264
  v_mfma_f32_32x32x16_bf16 v[32:47], a[36:39], v[100:103], v[32:47]
  ds_read_b128 v[116:119], v4 offset:44032
  s_waitcnt lgkmcnt(2)
  v_mfma_f32_32x32x16_bf16 v[16:31], a[40:43], v[104:107], v[16:31]
  ds_read_b128 v[88:91], v4 offset:12288
  v_mfma_f32_32x32x16_bf16 v[32:47], a[40:43], v[108:111], v[32:47]
  ds_read_b128 v[92:95], v4 offset:45056
  s_waitcnt lgkmcnt(2)
  v_mfma_f32_32x32x16_bf16 v[16:31], a[44:47], v[112:115], v[16:31]
  ds_read_b128 v[96:99], v4 offset:13312
  v_mfma_f32_32x32x16_bf16 v[32:47], a[44:47], v[116:119], v[32:47]
  ds_read_b128 v[100:103], v4 offset:46080
  s_waitcnt lgkmcnt(2)
  v_mfma_f32_32x32x16_bf16 v[16:31], a[48:51], v[88:91], v[16:31]
  ds_read_b128 v[104:107], v4 offset:14336
  ds_read_b128 v[108:111], v4 offset:47104
  v_mfma_f32_32x32x16_bf16 v[32:47], a[48:51], v[92:95], v[32:47]
  s_add_u32 m0, s15, 81920
  s_mov_b32 s20, 81920
  buffer_load_dwordx4 v7, s[16:19], s20 offen offset:0 sc1 lds
  buffer_load_dwordx4 v7, s[16:19], s20 offen offset:1024 sc1 lds
  buffer_load_dwordx4 v7, s[16:19], s20 offen offset:2048 sc1 lds
  buffer_load_dwordx4 v7, s[16:19], s20 offen offset:3072 sc1 lds
  s_waitcnt lgkmcnt(2)
  v_mfma_f32_32x32x16_bf16 v[16:31], a[52:55], v[96:99], v[16:31]
  ds_read_b128 v[112:115], v4 offset:15360
  v_mfma_f32_32x32x16_bf16 v[32:47], a[52:55], v[100:103], v[32:47]
  ds_read_b128 v[116:119], v4 offset:48128
  s_waitcnt lgkmcnt(2)
  v_mfma_f32_32x32x16_bf16 v[16:31], a[56:59], v[104:107], v[16:31]
  s_waitcnt vmcnt(16)
  s_barrier
  v_mfma_f32_32x32x16_bf16 v[32:47], a[56:59], v[108:111], v[32:47]
  ds_read_b128 v[88:91], v4 offset:16384
  ds_read_b128 v[92:95], v4 offset:49152
  s_waitcnt lgkmcnt(2)
  v_mfma_f32_32x32x16_bf16 v[16:31], a[60:63], v[112:115], v[16:31]
  ds_read_b128 v[96:99], v4 offset:17408
  v_mfma_f32_32x32x16_bf16 v[32:47], a[60:63], v[116:119], v[32:47]
  ds_read_b128 v[100:103], v4 offset:50176
  s_waitcnt lgkmcnt(2)
  v_mfma_f32_32x32x16_bf16 v[16:31], a[64:67], v[88:91], v[16:31]
  ds_read_b128 v[104:107], v4 offset:18432
  ds_read_b128 v[108:111], v4 offset:51200
  v_mfma_f32_32x32x16_bf16 v[32:47], a[64:67], v[92:95], v[32:47]
  s_add_u32 m0, s15, 90112
  s_mov_b32 s20, 90112
  buffer_load_dwordx4 v7, s[16:19], s20 offen offset:0 sc1 lds
  buffer_load_dwordx4 v7, s[16:19], s20 offen offset:1024 sc1 lds
  buffer_load_dwordx4 v7, s[16:19], s20 offen offset:2048 sc1 lds
  buffer_load_dwordx4 v7, s[16:19], s20 offen offset:3072 sc1 lds
  s_waitcnt lgkmcnt(2)
  v_mfma_f32_32x32x16_bf16 v[16:31], a[68:71], v[96:99], v[16:31]
  ds_read_b128 v[112:115], v4 offset:19456
  v_mfma_f32_32x32x16_bf16 v[32:47], a[68:71], v[100:103], v[32:47]
  ds_read_b128 v[116:119], v4 offset:52224
  s_waitcnt lgkmcnt(2)
  v_mfma_f32_32x32x16_bf16 v[16:31], a[72:75], v[104:107], v[16:31]
  ds_read_b128 v[88:91], v4 offset:20480
  ds_read_b128 v[92:95], v4 offset:53248
  v_mfma_f32_32x32x16_bf16 v[32:47], a[72:75], v[108:111], v[32:47]
  s_add_u32 m0, s13, 0
  s_mov_b32 s48, 0
  buffer_load_dwordx4 v160, s[44:47], s48 offen offset:0 lds
  s_waitcnt lgkmcnt(2)
  v_mfma_f32_32x32x16_bf16 v[16:31], a[76:79], v[112:115], v[16:31]
  ds_read_b128 v[96:99], v4 offset:21504
  ds_read_b128 v[100:103], v4 offset:54272
  v_mfma_f32_32x32x16_bf16 v[32:47], a[76:79], v[116:119], v[32:47]
  s_add_u32 m0, s13, 0
  s_mov_b32 s48, 0
  buffer_load_dwordx4 v161, s[44:47], s48 offen offset:1024 lds
  s_waitcnt lgkmcnt(2)
  v_mfma_f32_32x32x16_bf16 v[16:31], a[80:83], v[88:91], v[16:31]
  ds_read_b128 v[104:107], v4 offset:22528
  ds_read_b128 v[108:111], v4 offset:55296
  v_mfma_f32_32x32x16_bf16 v[32:47], a[80:83], v[92:95], v[32:47]
  s_add_u32 m0, s13, 0
  s_mov_b32 s48, 0
  buffer_load_dwordx4 v162, s[44:47], s48 offen offset:2048 lds
  s_waitcnt lgkmcnt(2)
  v_mfma_f32_32x32x16_bf16 v[16:31], a[84:87], v[96:99], v[16:31]
  ds_read_b128 v[112:115], v4 offset:23552
  ds_read_b128 v[116:119], v4 offset:56320
  v_mfma_f32_32x32x16_bf16 v[32:47], a[84:87], v[100:103], v[32:47]
  s_add_u32 m0, s13, 0
  s_mov_b32 s48, 0
  buffer_load_dwordx4 v163, s[44:47], s48 offen offset:3072 lds
  s_waitcnt lgkmcnt(2)
  v_mfma_f32_32x32x16_bf16 v[16:31], a[88:91], v[104:107], v[16:31]
  s_waitcnt vmcnt(20)
  s_barrier
  ds_read_b128 v[88:91], v4 offset:24576
  ds_read_b128 v[92:95], v4 offset:57344
  v_mfma_f32_32x32x16_bf16 v[32:47], a[88:91], v[108:111], v[32:47]
  s_add_u32 m0, s13, 4096
  s_mov_b32 s48, 0
  buffer_load_dwordx4 v164, s[44:47], s48 offen offset:0 lds
  s_waitcnt lgkmcnt(2)
  v_mfma_f32_32x32x16_bf16 v[16:31], a[92:95], v[112:115], v[16:31]
  ds_read_b128 v[96:99], v4 offset:25600
  ds_read_b128 v[100:103], v4 offset:58368
  v_mfma_f32_32x32x16_bf16 v[32:47], a[92:95], v[116:119], v[32:47]
  s_add_u32 m0, s13, 4096
  s_mov_b32 s48, 0
  buffer_load_dwordx4 v165, s[44:47], s48 offen offset:1024 lds
  s_waitcnt lgkmcnt(2)
  v_mfma_f32_32x32x16_bf16 v[16:31], a[96:99], v[88:91], v[16:31]
  ds_read_b128 v[104:107], v4 offset:26624
  ds_read_b128 v[108:111], v4 offset:59392
  v_mfma_f32_32x32x16_bf16 v[32:47], a[96:99], v[92:95], v[32:47]
  s_add_u32 m0, s13, 4096
  s_mov_b32 s48, 0
  buffer_load_dwordx4 v166, s[44:47], s48 offen offset:2048 lds
  s_waitcnt lgkmcnt(2)
  v_mfma_f32_32x32x16_bf16 v[16:31], a[100:103], v[96:99], v[16:31]
  ds_read_b128 v[112:115], v4 offset:27648
  ds_read_b128 v[116:119], v4 offset:60416
  v_mfma_f32_32x32x16_bf16 v[32:47], a[100:103], v[100:103], v[32:47]
  s_add_u32 m0, s13, 4096
  s_mov_b32 s48, 0
  buffer_load_dwordx4 v167, s[44:47], s48 offen offset:3072 lds
  s_waitcnt lgkmcnt(2)
  v_mfma_f32_32x32x16_bf16 v[16:31], a[104:107], v[104:107], v[16:31]
  ds_read_b128 v[88:91], v4 offset:28672
  v_mfma_f32_32x32x16_bf16 v[32:47], a[104:107], v[108:111], v[32:47]
  ds_read_b128 v[92:95], v4 offset:61440
  s_waitcnt lgkmcnt(2)
  v_mfma_f32_32x32x16_bf16 v[16:31], a[108:111], v[112:115], v[16:31]
  ds_read_b128 v[96:99], v4 offset:29696
  v_mfma_f32_32x32x16_bf16 v[32:47], a[108:111], v[116:119], v[32:47]
  ds_read_b128 v[100:103], v4 offset:62464
  s_waitcnt lgkmcnt(2)
  v_mfma_f32_32x32x16_bf16 v[16:31], a[112:115], v[88:91], v[16:31]
  ds_read_b128 v[104:107], v4 offset:30720
  v_mfma_f32_32x32x16_bf16 v[32:47], a[112:115], v[92:95], v[32:47]
  ds_read_b128 v[108:111], v4 offset:63488
  s_waitcnt lgkmcnt(2)
  v_mfma_f32_32x32x16_bf16 v[16:31], a[116:119], v[96:99], v[16:31]
  ds_read_b128 v[112:115], v4 offset:31744
  v_mfma_f32_32x32x16_bf16 v[32:47], a[116:119], v[100:103], v[32:47]
  ds_read_b128 v[116:119], v4 offset:64512
  s_waitcnt lgkmcnt(2)
  v_mfma_f32_32x32x16_bf16 v[16:31], a[120:123], v[104:107], v[16:31]
  s_waitcnt vmcnt(20)
  s_barrier
  v_mfma_f32_32x32x16_bf16 v[32:47], a[120:123], v[108:111], v[32:47]
  ds_read_b128 v[88:91], v5 offset:0
  ds_read_b128 v[92:95], v5 offset:32768
  s_waitcnt lgkmcnt(2)
  v_mfma_f32_32x32x16_bf16 v[16:31], a[124:127], v[112:115], v[16:31]
  ds_read_b128 v[96:99], v5 offset:1024
  v_mfma_f32_32x32x16_bf16 v[32:47], a[124:127], v[116:119], v[32:47]
  ds_read_b128 v[100:103], v5 offset:33792
  s_waitcnt lgkmcnt(2)
  v_mfma_f32_32x32x16_bf16 v[48:63], a[0:3], v[88:91], 0
  ds_read_b128 v[104:107], v5 offset:2048
  v_mfma_f32_32x32x16_bf16 v[64:79], a[0:3], v[92:95], 0
  ds_read_b128 v[108:111], v5 offset:34816
  s_waitcnt lgkmcnt(2)
  v_mfma_f32_32x32x16_bf16 v[48:63], a[4:7], v[96:99], v[48:63]
  s_waitcnt vmcnt(0)
  ds_read_b128 a[128:131], v168 offset:0
  ds_read_b128 a[132:135], v168 offset:2048
  ds_read_b128 a[136:139], v168 offset:4096
  v_mfma_f32_32x32x16_bf16 v[64:79], a[4:7], v[100:103], v[64:79]
  ds_read_b128 a[140:143], v168 offset:6144
  ds_read_b128 v[112:115], v5 offset:3072
  ds_read_b128 v[116:119], v5 offset:35840
  s_waitcnt lgkmcnt(2)
  v_mfma_f32_32x32x16_bf16 v[48:63], a[8:11], v[104:107], v[48:63]
  ds_read_b128 a[144:147], v169 offset:0
  ds_read_b128 a[148:151], v169 offset:2048
  ds_read_b128 a[152:155], v169 offset:4096
  ds_read_b128 a[156:159], v169 offset:6144
  ds_read_b128 v[88:91], v5 offset:4096
  ds_read_b128 v[92:95], v5 offset:36864
  v_mul_f32 v120, v16, v16
  v_mfma_f32_32x32x16_bf16 v[64:79], a[8:11], v[108:111], v[64:79]
  v_mul_f32 v121, v17, v17
  v_mul_f32 v122, v18, v18
  v_mul_f32 v123, v19, v19
  v_mul_f32 v124, v20, v20
  v_mul_f32 v125, v21, v21
  v_mul_f32 v126, v22, v22
  s_waitcnt lgkmcnt(2)
  v_mfma_f32_32x32x16_bf16 v[48:63], a[12:15], v[112:115], v[48:63]
  ds_read_b128 v[96:99], v5 offset:5120
  ds_read_b128 v[100:103], v5 offset:37888
  v_mul_f32 v127, v23, v23
  v_fma_f32 v120, v120, s22, v151
  v_fma_f32 v121, v121, s22, v151
  v_mfma_f32_32x32x16_bf16 v[64:79], a[12:15], v[116:119], v[64:79]
  v_fma_f32 v122, v122, s22, v151
  v_fma_f32 v123, v123, s22, v151
  v_fma_f32 v124, v124, s22, v151
  v_fma_f32 v125, v125, s22, v151
  s_waitcnt lgkmcnt(2)
  v_mfma_f32_32x32x16_bf16 v[48:63], a[16:19], v[88:91], v[48:63]
  ds_read_b128 v[104:107], v5 offset:6144
  ds_read_b128 v[108:111], v5 offset:38912
  s_add_u32 m0, s13, 0
  s_mov_b32 s48, 128
  buffer_load_dwordx4 v160, s[44:47], s48 offen offset:0 lds
  v_fma_f32 v126, v126, s22, v151
  v_fma_f32 v127, v127, s22, v151
  v_mfma_f32_32x32x16_bf16 v[64:79], a[16:19], v[92:95], v[64:79]
  v_mul_f32 v120, v120, v16
  v_mul_f32 v121, v121, v17
  v_mul_f32 v122, v122, v18
  v_mul_f32 v123, v123, v19
  v_mul_f32 v124, v124, v20
  v_mul_f32 v125, v125, v21
  s_waitcnt lgkmcnt(2)
  v_mfma_f32_32x32x16_bf16 v[48:63], a[20:23], v[96:99], v[48:63]
  ds_read_b128 v[112:115], v5 offset:7168
  ds_read_b128 v[116:119], v5 offset:39936
  s_add_u32 m0, s13, 0
  s_mov_b32 s48, 128
  buffer_load_dwordx4 v161, s[44:47], s48 offen offset:1024 lds
  v_mul_f32 v126, v126, v22
  v_mul_f32 v127, v127, v23
  v_exp_f32 v120, v120
  v_mfma_f32_32x32x16_bf16 v[64:79], a[20:23], v[100:103], v[64:79]
  v_exp_f32 v121, v121
  v_exp_f32 v122, v122
  v_exp_f32 v123, v123
  v_exp_f32 v124, v124
  s_waitcnt lgkmcnt(2)
  v_mfma_f32_32x32x16_bf16 v[48:63], a[24:27], v[104:107], v[48:63]
  s_waitcnt vmcnt(18)
  s_barrier
  ds_read_b128 v[88:91], v5 offset:8192
  ds_read_b128 v[92:95], v5 offset:40960
  s_add_u32 m0, s13, 0
  s_mov_b32 s48, 128
  buffer_load_dwordx4 v162, s[44:47], s48 offen offset:2048 lds
  v_exp_f32 v125, v125
  v_mfma_f32_32x32x16_bf16 v[64:79], a[24:27], v[108:111], v[64:79]
  v_exp_f32 v126, v126
  v_exp_f32 v127, v127
  v_add_f32 v120, 1.0, v120
  v_add_f32 v121, 1.0, v121
  v_add_f32 v122, 1.0, v122
  v_add_f32 v123, 1.0, v123
  v_add_f32 v124, 1.0, v124
  s_waitcnt lgkmcnt(2)
  v_mfma_f32_32x32x16_bf16 v[48:63], a[28:31], v[112:115], v[48:63]
  ds_read_b128 v[96:99], v5 offset:9216
  ds_read_b128 v[100:103], v5 offset:41984
  s_add_u32 m0, s13, 0
  s_mov_b32 s48, 128
  buffer_load_dwordx4 v163, s[44:47], s48 offen offset:3072 lds
  v_add_f32 v125, 1.0, v125
  v_add_f32 v126, 1.0, v126
  v_add_f32 v127, 1.0, v127
  v_mfma_f32_32x32x16_bf16 v[64:79], a[28:31], v[116:119], v[64:79]
  v_rcp_f32 v120, v120
  v_rcp_f32 v121, v121
  v_rcp_f32 v122, v122
  v_rcp_f32 v123, v123
  s_waitcnt lgkmcnt(2)
  v_mfma_f32_32x32x16_bf16 v[48:63], a[32:35], v[88:91], v[48:63]
  ds_read_b128 v[104:107], v5 offset:10240
  ds_read_b128 v[108:111], v5 offset:43008
  s_add_u32 m0, s13, 4096
  s_mov_b32 s48, 128
  buffer_load_dwordx4 v164, s[44:47], s48 offen offset:0 lds
  v_rcp_f32 v124, v124
  v_rcp_f32 v125, v125
  v_mfma_f32_32x32x16_bf16 v[64:79], a[32:35], v[92:95], v[64:79]
  v_rcp_f32 v126, v126
  v_rcp_f32 v127, v127
  v_mul_f32 v16, v16, v120
  v_mul_f32 v17, v17, v121
  v_mul_f32 v18, v18, v122
  v_mul_f32 v19, v19, v123
  s_waitcnt lgkmcnt(2)
  v_mfma_f32_32x32x16_bf16 v[48:63], a[36:39], v[96:99], v[48:63]
  ds_read_b128 v[112:115], v5 offset:11264
  ds_read_b128 v[116:119], v5 offset:44032
  s_add_u32 m0, s13, 4096
  s_mov_b32 s48, 128
  buffer_load_dwordx4 v165, s[44:47], s48 offen offset:1024 lds
  v_mul_f32 v20, v20, v124
  v_mfma_f32_32x32x16_bf16 v[64:79], a[36:39], v[100:103], v[64:79]
  v_mul_f32 v21, v21, v125
  v_mul_f32 v22, v22, v126
  v_mul_f32 v23, v23, v127
  v_mul_f32 v120, v24, v24
  v_mul_f32 v121, v25, v25
  v_mul_f32 v122, v26, v26
  s_waitcnt lgkmcnt(2)
  v_mfma_f32_32x32x16_bf16 v[48:63], a[40:43], v[104:107], v[48:63]
  ds_read_b128 v[88:91], v5 offset:12288
  ds_read_b128 v[92:95], v5 offset:45056
  s_add_u32 m0, s13, 4096
  s_mov_b32 s48, 128
  buffer_load_dwordx4 v166, s[44:47], s48 offen offset:2048 lds
  v_mul_f32 v123, v27, v27
  v_mul_f32 v124, v28, v28
  v_mfma_f32_32x32x16_bf16 v[64:79], a[40:43], v[108:111], v[64:79]
  v_mul_f32 v125, v29, v29
  v_mul_f32 v126, v30, v30
  v_mul_f32 v127, v31, v31
  v_fma_f32 v120, v120, s22, v151
  v_fma_f32 v121, v121, s22, v151
  v_fma_f32 v122, v122, s22, v151
  s_waitcnt lgkmcnt(2)
  v_mfma_f32_32x32x16_bf16 v[48:63], a[44:47], v[112:115], v[48:63]
  ds_read_b128 v[96:99], v5 offset:13312
  ds_read_b128 v[100:103], v5 offset:46080
  s_add_u32 m0, s13, 4096
  s_mov_b32 s48, 128
  buffer_load_dwordx4 v167, s[44:47], s48 offen offset:3072 lds
  v_fma_f32 v123, v123, s22, v151
  v_mfma_f32_32x32x16_bf16 v[64:79], a[44:47], v[116:119], v[64:79]
  v_fma_f32 v124, v124, s22, v151
  v_fma_f32 v125, v125, s22, v151
  v_fma_f32 v126, v126, s22, v151
  v_fma_f32 v127, v127, s22, v151
  v_mul_f32 v120, v120, v24
  v_mul_f32 v121, v121, v25
  s_waitcnt lgkmcnt(2)
  v_mfma_f32_32x32x16_bf16 v[48:63], a[48:51], v[88:91], v[48:63]
  ds_read_b128 v[104:107], v5 offset:14336
  ds_read_b128 v[108:111], v5 offset:47104
  s_add_u32 m0, s49, 0
  s_mov_b32 s48, 384
  buffer_load_dwordx4 v160, s[44:47], s48 offen offset:0 lds
  v_mul_f32 v122, v122, v26
  v_mul_f32 v123, v123, v27
  v_mul_f32 v124, v124, v28
  v_mfma_f32_32x32x16_bf16 v[64:79], a[48:51], v[92:95], v[64:79]
  v_mul_f32 v125, v125, v29
  v_mul_f32 v126, v126, v30
  v_mul_f32 v127, v127, v31
  v_exp_f32 v120, v120
  v_exp_f32 v121, v121
  s_waitcnt lgkmcnt(2)
  v_mfma_f32_32x32x16_bf16 v[48:63], a[52:55], v[96:99], v[48:63]
  ds_read_b128 v[112:115], v5 offset:15360
  ds_read_b128 v[116:119], v5 offset:48128
  s_add_u32 m0, s49, 0
  s_mov_b32 s48, 384
  buffer_load_dwordx4 v161, s[44:47], s48 offen offset:1024 lds
  v_exp_f32 v122, v122
  v_exp_f32 v123, v123
  v_mfma_f32_32x32x16_bf16 v[64:79], a[52:55], v[100:103], v[64:79]
  v_exp_f32 v124, v124
  v_exp_f32 v125, v125
  v_exp_f32 v126, v126
  v_exp_f32 v127, v127
  v_add_f32 v120, 1.0, v120
  s_waitcnt lgkmcnt(2)
  v_mfma_f32_32x32x16_bf16 v[48:63], a[56:59], v[104:107], v[48:63]
  s_waitcnt vmcnt(22)
  s_barrier
  ds_read_b128 v[88:91], v5 offset:16384
  ds_read_b128 v[92:95], v5 offset:49152
  s_add_u32 m0, s49, 0
  s_mov_b32 s48, 384
  buffer_load_dwordx4 v162, s[44:47], s48 offen offset:2048 lds
  v_add_f32 v121, 1.0, v121
  v_mfma_f32_32x32x16_bf16 v[64:79], a[56:59], v[108:111], v[64:79]
  v_add_f32 v122, 1.0, v122
  v_add_f32 v123, 1.0, v123
  v_add_f32 v124, 1.0, v124
  v_add_f32 v125, 1.0, v125
  v_add_f32 v126, 1.0, v126
  v_add_f32 v127, 1.0, v127
  v_rcp_f32 v120, v120
  s_waitcnt lgkmcnt(2)
  v_mfma_f32_32x32x16_bf16 v[48:63], a[60:63], v[112:115], v[48:63]
  ds_read_b128 v[96:99], v5 offset:17408
  ds_read_b128 v[100:103], v5 offset:50176
  s_add_u32 m0, s49, 0
  s_mov_b32 s48, 384
  buffer_load_dwordx4 v163, s[44:47], s48 offen offset:3072 lds
  v_rcp_f32 v121, v121
  v_rcp_f32 v122, v122
  v_mfma_f32_32x32x16_bf16 v[64:79], a[60:63], v[116:119], v[64:79]
  v_rcp_f32 v123, v123
  v_rcp_f32 v124, v124
  v_rcp_f32 v125, v125
  v_rcp_f32 v126, v126
  v_rcp_f32 v127, v127
  s_waitcnt lgkmcnt(2)
  v_mfma_f32_32x32x16_bf16 v[48:63], a[64:67], v[88:91], v[48:63]
  ds_read_b128 v[104:107], v5 offset:18432
  ds_read_b128 v[108:111], v5 offset:51200
  s_add_u32 m0, s49, 4096
  s_mov_b32 s48, 384
  buffer_load_dwordx4 v164, s[44:47], s48 offen offset:0 lds
  v_mul_f32 v24, v24, v120
  v_mul_f32 v25, v25, v121
  v_mfma_f32_32x32x16_bf16 v[64:79], a[64:67], v[92:95], v[64:79]
  v_mul_f32 v26, v26, v122
  v_mul_f32 v27, v27, v123
  v_mul_f32 v28, v28, v124
  v_mul_f32 v29, v29, v125
  v_mul_f32 v30, v30, v126
  v_mul_f32 v31, v31, v127
  s_waitcnt lgkmcnt(2)
  v_mfma_f32_32x32x16_bf16 v[48:63], a[68:71], v[96:99], v[48:63]
  ds_read_b128 v[112:115], v5 offset:19456
  ds_read_b128 v[116:119], v5 offset:52224
  s_add_u32 m0, s49, 4096
  s_mov_b32 s48, 384
  buffer_load_dwordx4 v165, s[44:47], s48 offen offset:1024 lds
  v_mul_f32 v120, v32, v32
  v_mfma_f32_32x32x16_bf16 v[64:79], a[68:71], v[100:103], v[64:79]
  v_mul_f32 v121, v33, v33
  v_mul_f32 v122, v34, v34
  v_mul_f32 v123, v35, v35
  v_mul_f32 v124, v36, v36
  v_mul_f32 v125, v37, v37
  v_mul_f32 v126, v38, v38
  s_waitcnt lgkmcnt(2)
  v_mfma_f32_32x32x16_bf16 v[48:63], a[72:75], v[104:107], v[48:63]
  ds_read_b128 v[88:91], v5 offset:20480
  ds_read_b128 v[92:95], v5 offset:53248
  s_add_u32 m0, s49, 4096
  s_mov_b32 s48, 384
  buffer_load_dwordx4 v166, s[44:47], s48 offen offset:2048 lds
  v_mul_f32 v127, v39, v39
  v_mfma_f32_32x32x16_bf16 v[64:79], a[72:75], v[108:111], v[64:79]
  v_fma_f32 v120, v120, s22, v151
  v_fma_f32 v121, v121, s22, v151
  v_fma_f32 v122, v122, s22, v151
  v_fma_f32 v123, v123, s22, v151
  v_fma_f32 v124, v124, s22, v151
  v_fma_f32 v125, v125, s22, v151
  s_waitcnt lgkmcnt(2)
  v_mfma_f32_32x32x16_bf16 v[48:63], a[76:79], v[112:115], v[48:63]
  ds_read_b128 v[96:99], v5 offset:21504
  ds_read_b128 v[100:103], v5 offset:54272
  s_add_u32 m0, s49, 4096
  s_mov_b32 s48, 384
  buffer_load_dwordx4 v167, s[44:47], s48 offen offset:3072 lds
  v_fma_f32 v126, v126, s22, v151
  v_fma_f32 v127, v127, s22, v151
  v_mfma_f32_32x32x16_bf16 v[64:79], a[76:79], v[116:119], v[64:79]
  v_mul_f32 v120, v120, v32
  v_mul_f32 v121, v121, v33
  v_mul_f32 v122, v122, v34
  v_mul_f32 v123, v123, v35
  v_mul_f32 v124, v124, v36
  v_mul_f32 v125, v125, v37
  s_waitcnt lgkmcnt(2)
  v_mfma_f32_32x32x16_bf16 v[48:63], a[80:83], v[88:91], v[48:63]
  s_waitcnt vmcnt(8)
  ds_read_b128 a[160:163], v168 offset:0
  ds_read_b128 a[164:167], v168 offset:2048
  ds_read_b128 a[168:171], v168 offset:4096
  ds_read_b128 a[172:175], v168 offset:6144
  ds_read_b128 v[104:107], v5 offset:22528
  ds_read_b128 v[108:111], v5 offset:55296
  s_add_u32 m0, s49, 8192
  s_mov_b32 s48, 512
  buffer_load_dwordx4 v160, s[44:47], s48 offen offset:0 lds
  v_mul_f32 v126, v126, v38
  v_mfma_f32_32x32x16_bf16 v[64:79], a[80:83], v[92:95], v[64:79]
  v_mul_f32 v127, v127, v39
  v_exp_f32 v120, v120
  v_exp_f32 v121, v121
  v_exp_f32 v122, v122
  v_exp_f32 v123, v123
  v_exp_f32 v124, v124
  s_waitcnt lgkmcnt(2)
  v_mfma_f32_32x32x16_bf16 v[48:63], a[84:87], v[96:99], v[48:63]
  ds_read_b128 a[176:179], v169 offset:0
  ds_read_b128 a[180:183], v169 offset:2048
  ds_read_b128 a[184:187], v169 offset:4096
  ds_read_b128 a[188:191], v169 offset:6144
  ds_read_b128 v[112:115], v5 offset:23552
  ds_read_b128 v[116:119], v5 offset:56320
  s_add_u32 m0, s49, 8192
  s_mov_b32 s48, 512
  buffer_load_dwordx4 v161, s[44:47], s48 offen offset:1024 lds
  v_exp_f32 v125, v125
  v_mfma_f32_32x32x16_bf16 v[64:79], a[84:87], v[100:103], v[64:79]
  v_exp_f32 v126, v126
  v_exp_f32 v127, v127
  v_add_f32 v120, 1.0, v120
  v_add_f32 v121, 1.0, v121
  v_add_f32 v122, 1.0, v122
  v_add_f32 v123, 1.0, v123
  v_add_f32 v124, 1.0, v124
  s_waitcnt lgkmcnt(2)
  v_mfma_f32_32x32x16_bf16 v[48:63], a[88:91], v[104:107], v[48:63]
  s_waitcnt vmcnt(26)
  s_barrier
  ds_read_b128 v[88:91], v5 offset:24576
  ds_read_b128 v[92:95], v5 offset:57344
  s_add_u32 m0, s49, 8192
  s_mov_b32 s48, 512
  buffer_load_dwordx4 v162, s[44:47], s48 offen offset:2048 lds
  v_add_f32 v125, 1.0, v125
  v_add_f32 v126, 1.0, v126
  v_mfma_f32_32x32x16_bf16 v[64:79], a[88:91], v[108:111], v[64:79]
  v_add_f32 v127, 1.0, v127
  v_rcp_f32 v120, v120
  v_rcp_f32 v121, v121
  v_rcp_f32 v122, v122
  v_rcp_f32 v123, v123
  s_waitcnt lgkmcnt(2)
  v_mfma_f32_32x32x16_bf16 v[48:63], a[92:95], v[112:115], v[48:63]
  ds_read_b128 v[96:99], v5 offset:25600
  ds_read_b128 v[100:103], v5 offset:58368
  s_add_u32 m0, s49, 8192
  s_mov_b32 s48, 512
  buffer_load_dwordx4 v163, s[44:47], s48 offen offset:3072 lds
  v_rcp_f32 v124, v124
  v_rcp_f32 v125, v125
  v_mfma_f32_32x32x16_bf16 v[64:79], a[92:95], v[116:119], v[64:79]
  v_rcp_f32 v126, v126
  v_rcp_f32 v127, v127
  v_mul_f32 v32, v32, v120
  v_mul_f32 v33, v33, v121
  v_mul_f32 v34, v34, v122
  v_mul_f32 v35, v35, v123
  s_waitcnt lgkmcnt(2)
  v_mfma_f32_32x32x16_bf16 v[48:63], a[96:99], v[88:91], v[48:63]
  ds_read_b128 v[104:107], v5 offset:26624
  ds_read_b128 v[108:111], v5 offset:59392
  s_add_u32 m0, s49, 12288
  s_mov_b32 s48, 512
  buffer_load_dwordx4 v164, s[44:47], s48 offen offset:0 lds
  v_mul_f32 v36, v36, v124
  v_mfma_f32_32x32x16_bf16 v[64:79], a[96:99], v[92:95], v[64:79]
  v_mul_f32 v37, v37, v125
  v_mul_f32 v38, v38, v126
  v_mul_f32 v39, v39, v127
  v_mul_f32 v120, v40, v40
  v_mul_f32 v121, v41, v41
  v_mul_f32 v122, v42, v42
  s_waitcnt lgkmcnt(2)
  v_mfma_f32_32x32x16_bf16 v[48:63], a[100:103], v[96:99], v[48:63]
  ds_read_b128 v[112:115], v5 offset:27648
  ds_read_b128 v[116:119], v5 offset:60416
  s_add_u32 m0, s49, 12288
  s_mov_b32 s48, 512
  buffer_load_dwordx4 v165, s[44:47], s48 offen offset:1024 lds
  v_mul_f32 v123, v43, v43
  v_mul_f32 v124, v44, v44
  v_mfma_f32_32x32x16_bf16 v[64:79], a[100:103], v[100:103], v[64:79]
  v_mul_f32 v125, v45, v45
  v_mul_f32 v126, v46, v46
  v_mul_f32 v127, v47, v47
  v_fma_f32 v120, v120, s22, v151
  v_fma_f32 v121, v121, s22, v151
  v_fma_f32 v122, v122, s22, v151
  s_waitcnt lgkmcnt(2)
  v_mfma_f32_32x32x16_bf16 v[48:63], a[104:107], v[104:107], v[48:63]
  ds_read_b128 v[88:91], v5 offset:28672
  ds_read_b128 v[92:95], v5 offset:61440
  s_add_u32 m0, s49, 12288
  s_mov_b32 s48, 512
  buffer_load_dwordx4 v166, s[44:47], s48 offen offset:2048 lds
  v_fma_f32 v123, v123, s22, v151
  v_mfma_f32_32x32x16_bf16 v[64:79], a[104:107], v[108:111], v[64:79]
  v_fma_f32 v124, v124, s22, v151
  v_fma_f32 v125, v125, s22, v151
  v_fma_f32 v126, v126, s22, v151
  v_fma_f32 v127, v127, s22, v151
  v_mul_f32 v120, v120, v40
  v_mul_f32 v121, v121, v41
  s_waitcnt lgkmcnt(2)
  v_mfma_f32_32x32x16_bf16 v[48:63], a[108:111], v[112:115], v[48:63]
  ds_read_b128 v[96:99], v5 offset:29696
  ds_read_b128 v[100:103], v5 offset:62464
  s_add_u32 m0, s49, 12288
  s_mov_b32 s48, 512
  buffer_load_dwordx4 v167, s[44:47], s48 offen offset:3072 lds
  v_mul_f32 v122, v122, v42
  v_mul_f32 v123, v123, v43
  v_mul_f32 v124, v124, v44
  v_mfma_f32_32x32x16_bf16 v[64:79], a[108:111], v[116:119], v[64:79]
  v_mul_f32 v125, v125, v45
  v_mul_f32 v126, v126, v46
  v_mul_f32 v127, v127, v47
  v_exp_f32 v120, v120
  v_exp_f32 v121, v121
  s_waitcnt lgkmcnt(2)
  v_mfma_f32_32x32x16_bf16 v[48:63], a[112:115], v[88:91], v[48:63]
  ds_read_b128 v[104:107], v5 offset:30720
  ds_read_b128 v[108:111], v5 offset:63488
  s_add_u32 m0, s13, 0
  s_mov_b32 s48, 256
  buffer_load_dwordx4 v160, s[44:47], s48 offen offset:0 lds
  v_exp_f32 v122, v122
  v_exp_f32 v123, v123
  v_mfma_f32_32x32x16_bf16 v[64:79], a[112:115], v[92:95], v[64:79]
  v_exp_f32 v124, v124
  v_exp_f32 v125, v125
  v_exp_f32 v126, v126
  v_exp_f32 v127, v127
  v_add_f32 v120, 1.0, v120
  s_waitcnt lgkmcnt(2)
  v_mfma_f32_32x32x16_bf16 v[48:63], a[116:119], v[96:99], v[48:63]
  ds_read_b128 v[112:115], v5 offset:31744
  ds_read_b128 v[116:119], v5 offset:64512
  s_add_u32 m0, s13, 0
  s_mov_b32 s48, 256
  buffer_load_dwordx4 v161, s[44:47], s48 offen offset:1024 lds
  v_add_f32 v121, 1.0, v121
  v_add_f32 v122, 1.0, v122
  v_mfma_f32_32x32x16_bf16 v[64:79], a[116:119], v[100:103], v[64:79]
  v_add_f32 v123, 1.0, v123
  v_add_f32 v124, 1.0, v124
  v_add_f32 v125, 1.0, v125
  v_add_f32 v126, 1.0, v126
  v_add_f32 v127, 1.0, v127
  v_rcp_f32 v120, v120
  s_waitcnt lgkmcnt(2)
  v_mfma_f32_32x32x16_bf16 v[48:63], a[120:123], v[104:107], v[48:63]
  s_add_u32 m0, s13, 0
  s_mov_b32 s48, 256
  buffer_load_dwordx4 v162, s[44:47], s48 offen offset:2048 lds
  v_rcp_f32 v121, v121
  v_rcp_f32 v122, v122
  v_rcp_f32 v123, v123
  v_mfma_f32_32x32x16_bf16 v[64:79], a[120:123], v[108:111], v[64:79]
  v_rcp_f32 v124, v124
  v_rcp_f32 v125, v125
  v_rcp_f32 v126, v126
  v_rcp_f32 v127, v127
  s_waitcnt lgkmcnt(0)
  v_mfma_f32_32x32x16_bf16 v[48:63], a[124:127], v[112:115], v[48:63]
  s_add_u32 m0, s13, 0
  s_mov_b32 s48, 256
  buffer_load_dwordx4 v163, s[44:47], s48 offen offset:3072 lds
  v_mul_f32 v40, v40, v120
  v_mul_f32 v41, v41, v121
  v_mul_f32 v42, v42, v122
  v_mfma_f32_32x32x16_bf16 v[64:79], a[124:127], v[116:119], v[64:79]
  v_mul_f32 v43, v43, v123
  v_mul_f32 v44, v44, v124
  v_mul_f32 v45, v45, v125
  v_mul_f32 v46, v46, v126
  v_mul_f32 v47, v47, v127
  s_lshr_b32 s20, s2, 3
  s_lshl_b32 s20, s20, 2
  s_add_u32 s20, s20, s8
  s_lshl_b32 s20, s20, 10
  s_getpc_b64 s[28:29]
K3_PC:
  s_add_u32 s28, s28, K45_SEG-K3_PC
  s_addc_u32 s29, s29, 0
  s_mov_b32 s30, CODE_END-K45_SEG
  s_mov_b32 s31, 0x20000
  buffer_load_dwordx4 v[80:83], v7, s[28:31], s20 offen
  s_barrier
  v_mul_f32 v120, v48, v48
  v_mul_f32 v121, v49, v49
  v_mul_f32 v122, v50, v50
  v_mul_f32 v123, v51, v51
  v_mul_f32 v124, v52, v52
  v_mul_f32 v125, v53, v53
  v_mul_f32 v126, v54, v54
  v_mul_f32 v127, v55, v55
  s_add_u32 m0, s13, 4096
  s_mov_b32 s48, 256
  buffer_load_dwordx4 v164, s[44:47], s48 offen offset:0 lds
  v_fma_f32 v120, v120, s22, v151
  v_fma_f32 v121, v121, s22, v151
  v_fma_f32 v122, v122, s22, v151
  v_fma_f32 v123, v123, s22, v151
  v_fma_f32 v124, v124, s22, v151
  v_fma_f32 v125, v125, s22, v151
  v_fma_f32 v126, v126, s22, v151
  v_fma_f32 v127, v127, s22, v151
  v_mul_f32 v120, v120, v48
  v_mul_f32 v121, v121, v49
  v_mul_f32 v122, v122, v50
  v_mul_f32 v123, v123, v51
  v_mul_f32 v124, v124, v52
  v_mul_f32 v125, v125, v53
  v_mul_f32 v126, v126, v54
  v_mul_f32 v127, v127, v55
  s_add_u32 m0, s13, 4096
  s_mov_b32 s48, 256
  buffer_load_dwordx4 v165, s[44:47], s48 offen offset:1024 lds
  v_exp_f32 v120, v120
  v_exp_f32 v121, v121
  v_exp_f32 v122, v122
  v_exp_f32 v123, v123
  v_exp_f32 v124, v124
  v_exp_f32 v125, v125
  v_exp_f32 v126, v126
  v_exp_f32 v127, v127
  v_add_f32 v120, 1.0, v120
  v_add_f32 v121, 1.0, v121
  v_add_f32 v122, 1.0, v122
  v_add_f32 v123, 1.0, v123
  v_add_f32 v124, 1.0, v124
  v_add_f32 v125, 1.0, v125
  v_add_f32 v126, 1.0, v126
  v_add_f32 v127, 1.0, v127
  s_add_u32 m0, s13, 4096
  s_mov_b32 s48, 256
  buffer_load_dwordx4 v166, s[44:47], s48 offen offset:2048 lds
  v_rcp_f32 v120, v120
  v_rcp_f32 v121, v121
  v_rcp_f32 v122, v122
  v_rcp_f32 v123, v123
  v_rcp_f32 v124, v124
  v_rcp_f32 v125, v125
  v_rcp_f32 v126, v126
  v_rcp_f32 v127, v127
  v_mul_f32 v48, v48, v120
  v_mul_f32 v49, v49, v121
  v_mul_f32 v50, v50, v122
  v_mul_f32 v51, v51, v123
  v_mul_f32 v52, v52, v124
  v_mul_f32 v53, v53, v125
  v_mul_f32 v54, v54, v126
  v_mul_f32 v55, v55, v127
  s_add_u32 m0, s13, 4096
  s_mov_b32 s48, 256
  buffer_load_dwordx4 v167, s[44:47], s48 offen offset:3072 lds
  v_mul_f32 v120, v56, v56
  v_mul_f32 v121, v57, v57
  v_mul_f32 v122, v58, v58
  v_mul_f32 v123, v59, v59
  v_mul_f32 v124, v60, v60
  v_mul_f32 v125, v61, v61
  v_mul_f32 v126, v62, v62
  v_mul_f32 v127, v63, v63
  s_add_u32 m0, s49, 73728
  s_mov_b32 s48, 640
  buffer_load_dwordx4 v160, s[44:47], s48 offen offset:0 lds
  v_fma_f32 v120, v120, s22, v151
  v_fma_f32 v121, v121, s22, v151
  v_fma_f32 v122, v122, s22, v151
  v_fma_f32 v123, v123, s22, v151
  v_fma_f32 v124, v124, s22, v151
  v_fma_f32 v125, v125, s22, v151
  v_fma_f32 v126, v126, s22, v151
  v_fma_f32 v127, v127, s22, v151
  v_mul_f32 v120, v120, v56
  v_mul_f32 v121, v121, v57
  v_mul_f32 v122, v122, v58
  v_mul_f32 v123, v123, v59
  v_mul_f32 v124, v124, v60
  v_mul_f32 v125, v125, v61
  v_mul_f32 v126, v126, v62
  v_mul_f32 v127, v127, v63
  s_add_u32 m0, s49, 73728
  s_mov_b32 s48, 640
  buffer_load_dwordx4 v161, s[44:47], s48 offen offset:1024 lds
  v_exp_f32 v120, v120
  v_exp_f32 v121, v121
  v_exp_f32 v122, v122
  v_exp_f32 v123, v123
  v_exp_f32 v124, v124
  v_exp_f32 v125, v125
  v_exp_f32 v126, v126
  v_exp_f32 v127, v127
  v_add_f32 v120, 1.0, v120
  v_add_f32 v121, 1.0, v121
  v_add_f32 v122, 1.0, v122
  v_add_f32 v123, 1.0, v123
  v_add_f32 v124, 1.0, v124
  v_add_f32 v125, 1.0, v125
  v_add_f32 v126, 1.0, v126
  v_add_f32 v127, 1.0, v127
  s_add_u32 m0, s49, 73728
  s_mov_b32 s48, 640
  buffer_load_dwordx4 v162, s[44:47], s48 offen offset:2048 lds
  v_rcp_f32 v120, v120
  v_rcp_f32 v121, v121
  v_rcp_f32 v122, v122
  v_rcp_f32 v123, v123
  v_rcp_f32 v124, v124
  v_rcp_f32 v125, v125
  v_rcp_f32 v126, v126
  v_rcp_f32 v127, v127
  v_mul_f32 v56, v56, v120
  v_mul_f32 v57, v57, v121
  v_mul_f32 v58, v58, v122
  v_mul_f32 v59, v59, v123
  v_mul_f32 v60, v60, v124
  v_mul_f32 v61, v61, v125
  v_mul_f32 v62, v62, v126
  v_mul_f32 v63, v63, v127
  s_add_u32 m0, s49, 73728
  s_mov_b32 s48, 640
  buffer_load_dwordx4 v163, s[44:47], s48 offen offset:3072 lds
  v_mul_f32 v120, v64, v64
  v_mul_f32 v121, v65, v65
  v_mul_f32 v122, v66, v66
  v_mul_f32 v123, v67, v67
  v_mul_f32 v124, v68, v68
  v_mul_f32 v125, v69, v69
  v_mul_f32 v126, v70, v70
  v_mul_f32 v127, v71, v71
  s_add_u32 m0, s49, 77824
  s_mov_b32 s48, 640
  buffer_load_dwordx4 v164, s[44:47], s48 offen offset:0 lds
  v_fma_f32 v120, v120, s22, v151
  v_fma_f32 v121, v121, s22, v151
  v_fma_f32 v122, v122, s22, v151
  v_fma_f32 v123, v123, s22, v151
  v_fma_f32 v124, v124, s22, v151
  v_fma_f32 v125, v125, s22, v151
  v_fma_f32 v126, v126, s22, v151
  v_fma_f32 v127, v127, s22, v151
  v_mul_f32 v120, v120, v64
  v_mul_f32 v121, v121, v65
  v_mul_f32 v122, v122, v66
  v_mul_f32 v123, v123, v67
  v_mul_f32 v124, v124, v68
  v_mul_f32 v125, v125, v69
  v_mul_f32 v126, v126, v70
  v_mul_f32 v127, v127, v71
  s_add_u32 m0, s49, 77824
  s_mov_b32 s48, 640
  buffer_load_dwordx4 v165, s[44:47], s48 offen offset:1024 lds
  v_exp_f32 v120, v120
  v_exp_f32 v121, v121
  v_exp_f32 v122, v122
  v_exp_f32 v123, v123
  v_exp_f32 v124, v124
  v_exp_f32 v125, v125
  v_exp_f32 v126, v126
  v_exp_f32 v127, v127
  v_add_f32 v120, 1.0, v120
  v_add_f32 v121, 1.0, v121
  v_add_f32 v122, 1.0, v122
  v_add_f32 v123, 1.0, v123
  v_add_f32 v124, 1.0, v124
  v_add_f32 v125, 1.0, v125
  v_add_f32 v126, 1.0, v126
  v_add_f32 v127, 1.0, v127
  s_add_u32 m0, s49, 77824
  s_mov_b32 s48, 640
  buffer_load_dwordx4 v166, s[44:47], s48 offen offset:2048 lds
  v_rcp_f32 v120, v120
  v_rcp_f32 v121, v121
  v_rcp_f32 v122, v122
  v_rcp_f32 v123, v123
  v_rcp_f32 v124, v124
  v_rcp_f32 v125, v125
  v_rcp_f32 v126, v126
  v_rcp_f32 v127, v127
  v_mul_f32 v64, v64, v120
  v_mul_f32 v65, v65, v121
  v_mul_f32 v66, v66, v122
  v_mul_f32 v67, v67, v123
  v_mul_f32 v68, v68, v124
  v_mul_f32 v69, v69, v125
  v_mul_f32 v70, v70, v126
  v_mul_f32 v71, v71, v127
  s_add_u32 m0, s49, 77824
  s_mov_b32 s48, 640
  buffer_load_dwordx4 v167, s[44:47], s48 offen offset:3072 lds
  v_mul_f32 v120, v72, v72
  v_mul_f32 v121, v73, v73
  v_mul_f32 v122, v74, v74
  v_mul_f32 v123, v75, v75
  v_mul_f32 v124, v76, v76
  v_mul_f32 v125, v77, v77
  v_mul_f32 v126, v78, v78
  v_mul_f32 v127, v79, v79
  v_fma_f32 v120, v120, s22, v151
  v_fma_f32 v121, v121, s22, v151
  v_fma_f32 v122, v122, s22, v151
  v_fma_f32 v123, v123, s22, v151
  v_fma_f32 v124, v124, s22, v151
  v_fma_f32 v125, v125, s22, v151
  v_fma_f32 v126, v126, s22, v151
  v_fma_f32 v127, v127, s22, v151
  v_mul_f32 v120, v120, v72
  v_mul_f32 v121, v121, v73
  v_mul_f32 v122, v122, v74
  v_mul_f32 v123, v123, v75
  v_mul_f32 v124, v124, v76
  v_mul_f32 v125, v125, v77
  v_mul_f32 v126, v126, v78
  v_mul_f32 v127, v127, v79
  v_exp_f32 v120, v120
  v_exp_f32 v121, v121
  v_exp_f32 v122, v122
  v_exp_f32 v123, v123
  v_exp_f32 v124, v124
  v_exp_f32 v125, v125
  v_exp_f32 v126, v126
  v_exp_f32 v127, v127
  v_add_f32 v120, 1.0, v120
  v_add_f32 v121, 1.0, v121
  v_add_f32 v122, 1.0, v122
  v_add_f32 v123, 1.0, v123
  v_add_f32 v124, 1.0, v124
  v_add_f32 v125, 1.0, v125
  v_add_f32 v126, 1.0, v126
  v_add_f32 v127, 1.0, v127
  v_rcp_f32 v120, v120
  v_rcp_f32 v121, v121
  v_rcp_f32 v122, v122
  v_rcp_f32 v123, v123
  v_rcp_f32 v124, v124
  v_rcp_f32 v125, v125
  v_rcp_f32 v126, v126
  v_rcp_f32 v127, v127
  v_mul_f32 v72, v72, v120
  v_mul_f32 v73, v73, v121
  v_mul_f32 v74, v74, v122
  v_mul_f32 v75, v75, v123
  v_mul_f32 v76, v76, v124
  v_mul_f32 v77, v77, v125
  v_mul_f32 v78, v78, v126
  v_mul_f32 v79, v79, v127
  s_waitcnt vmcnt(8)
  ds_read_b128 a[192:195], v168 offset:0
  ds_read_b128 a[196:199], v168 offset:2048
  ds_read_b128 a[200:203], v168 offset:4096
  ds_read_b128 a[204:207], v168 offset:6144
  ds_read_b128 a[208:211], v169 offset:0
  ds_read_b128 a[212:215], v169 offset:2048
  ds_read_b128 a[216:219], v169 offset:4096
  ds_read_b128 a[220:223], v169 offset:6144
  s_waitcnt lgkmcnt(0)
  s_cmp_ge_u32 s11, 7
  s_cbranch_scc1 K3_Z2
  s_mul_i32 s20, s12, 229376
  s_lshl_b32 s21, s11, 12
  s_add_u32 s20, s20, s21
  s_lshl_b32 s21, s8, 10
  s_add_u32 s20, s20, s21
  s_add_u32 s32, s62, 0x800000
  s_addc_u32 s33, s63, 0
  s_add_u32 s32, s32, s20
  s_addc_u32 s33, s33, 0
  s_mov_b32 s34, 0x31400
  s_mov_b32 s35, 0x20000
  v_bfe_u32 v8, v1, 4, 1
  v_mul_u32_u24 v8, 28672, v8
  v_lshrrev_b32 v9, 5, v1
  v_lshl_add_u32 v8, v9, 8, v8
  v_and_b32 v9, 15, v1
  v_lshl_add_u32 v6, v9, 4, v8
  s_mov_b32 s20, 0
  v_cvt_pk_bf16_f32 v88, v16, v17
  v_cvt_pk_bf16_f32 v89, v18, v19
  v_cvt_pk_bf16_f32 v90, v20, v21
  v_cvt_pk_bf16_f32 v91, v22, v23
  buffer_store_dwordx4 v[88:91], v6, s[32:35], s20 offen offset:0 sc1
  v_cvt_pk_bf16_f32 v92, v24, v25
  v_cvt_pk_bf16_f32 v93, v26, v27
  v_cvt_pk_bf16_f32 v94, v28, v29
  v_cvt_pk_bf16_f32 v95, v30, v31
  buffer_store_dwordx4 v[92:95], v6, s[32:35], s20 offen offset:512 sc1
  s_mov_b32 s21, 57344
  v_cvt_pk_bf16_f32 v96, v32, v33
  v_cvt_pk_bf16_f32 v97, v34, v35
  v_cvt_pk_bf16_f32 v98, v36, v37
  v_cvt_pk_bf16_f32 v99, v38, v39
  buffer_store_dwordx4 v[96:99], v6, s[32:35], s21 offen offset:0 sc1
  v_cvt_pk_bf16_f32 v100, v40, v41
  v_cvt_pk_bf16_f32 v101, v42, v43
  v_cvt_pk_bf16_f32 v102, v44, v45
  v_cvt_pk_bf16_f32 v103, v46, v47
  buffer_store_dwordx4 v[100:103], v6, s[32:35], s21 offen offset:512 sc1
  s_mov_b32 s20, 114688
  v_cvt_pk_bf16_f32 v104, v48, v49
  v_cvt_pk_bf16_f32 v105, v50, v51
  v_cvt_pk_bf16_f32 v106, v52, v53
  v_cvt_pk_bf16_f32 v107, v54, v55
  buffer_store_dwordx4 v[104:107], v6, s[32:35], s20 offen offset:0 sc1
  v_cvt_pk_bf16_f32 v108, v56, v57
  v_cvt_pk_bf16_f32 v109, v58, v59
  v_cvt_pk_bf16_f32 v110, v60, v61
  v_cvt_pk_bf16_f32 v111, v62, v63
  buffer_store_dwordx4 v[108:111], v6, s[32:35], s20 offen offset:512 sc1
  s_mov_b32 s21, 172032
  v_cvt_pk_bf16_f32 v112, v64, v65
  v_cvt_pk_bf16_f32 v113, v66, v67
  v_cvt_pk_bf16_f32 v114, v68, v69
  v_cvt_pk_bf16_f32 v115, v70, v71
  buffer_store_dwordx4 v[112:115], v6, s[32:35], s21 offen offset:0 sc1
  v_cvt_pk_bf16_f32 v116, v72, v73
  v_cvt_pk_bf16_f32 v117, v74, v75
  v_cvt_pk_bf16_f32 v118, v76, v77
  v_cvt_pk_bf16_f32 v119, v78, v79
  buffer_store_dwordx4 v[116:119], v6, s[32:35], s21 offen offset:512 sc1
  s_branch K3_FIN
K3_Z2:
  v_pk_add_f32 v[88:89], v[16:17], 0 op_sel_hi:[1,0]
  v_pk_mul_f32 v[90:91], v[16:17], v[16:17]
  v_pk_add_f32 v[88:89], v[88:89], v[18:19]
  v_pk_fma_f32 v[90:91], v[18:19], v[18:19], v[90:91]
  v_pk_add_f32 v[88:89], v[88:89], v[20:21]
  v_pk_fma_f32 v[90:91], v[20:21], v[20:21], v[90:91]
  v_pk_add_f32 v[88:89], v[88:89], v[22:23]
  v_pk_fma_f32 v[90:91], v[22:23], v[22:23], v[90:91]
  v_pk_add_f32 v[88:89], v[88:89], v[24:25]
  v_pk_fma_f32 v[90:91], v[24:25], v[24:25], v[90:91]
  v_pk_add_f32 v[88:89], v[88:89], v[26:27]
  v_pk_fma_f32 v[90:91], v[26:27], v[26:27], v[90:91]
  v_pk_add_f32 v[88:89], v[88:89], v[28:29]
  v_pk_fma_f32 v[90:91], v[28:29], v[28:29], v[90:91]
  v_pk_add_f32 v[88:89], v[88:89], v[30:31]
  v_pk_fma_f32 v[90:91], v[30:31], v[30:31], v[90:91]
  v_pk_add_f32 v[92:93], v[32:33], 0 op_sel_hi:[1,0]
  v_pk_mul_f32 v[94:95], v[32:33], v[32:33]
  v_pk_add_f32 v[92:93], v[92:93], v[34:35]
  v_pk_fma_f32 v[94:95], v[34:35], v[34:35], v[94:95]
  v_pk_add_f32 v[92:93], v[92:93], v[36:37]
  v_pk_fma_f32 v[94:95], v[36:37], v[36:37], v[94:95]
  v_pk_add_f32 v[92:93], v[92:93], v[38:39]
  v_pk_fma_f32 v[94:95], v[38:39], v[38:39], v[94:95]
  v_pk_add_f32 v[92:93], v[92:93], v[40:41]
  v_pk_fma_f32 v[94:95], v[40:41], v[40:41], v[94:95]
  v_pk_add_f32 v[92:93], v[92:93], v[42:43]
  v_pk_fma_f32 v[94:95], v[42:43], v[42:43], v[94:95]
  v_pk_add_f32 v[92:93], v[92:93], v[44:45]
  v_pk_fma_f32 v[94:95], v[44:45], v[44:45], v[94:95]
  v_pk_add_f32 v[92:93], v[92:93], v[46:47]
  v_pk_fma_f32 v[94:95], v[46:47], v[46:47], v[94:95]
  v_pk_add_f32 v[96:97], v[48:49], 0 op_sel_hi:[1,0]
  v_pk_mul_f32 v[98:99], v[48:49], v[48:49]
  v_pk_add_f32 v[96:97], v[96:97], v[50:51]
  v_pk_fma_f32 v[98:99], v[50:51], v[50:51], v[98:99]
  v_pk_add_f32 v[96:97], v[96:97], v[52:53]
  v_pk_fma_f32 v[98:99], v[52:53], v[52:53], v[98:99]
  v_pk_add_f32 v[96:97], v[96:97], v[54:55]
  v_pk_fma_f32 v[98:99], v[54:55], v[54:55], v[98:99]
  v_pk_add_f32 v[96:97], v[96:97], v[56:57]
  v_pk_fma_f32 v[98:99], v[56:57], v[56:57], v[98:99]
  v_pk_add_f32 v[96:97], v[96:97], v[58:59]
  v_pk_fma_f32 v[98:99], v[58:59], v[58:59], v[98:99]
  v_pk_add_f32 v[96:97], v[96:97], v[60:61]
  v_pk_fma_f32 v[98:99], v[60:61], v[60:61], v[98:99]
  v_pk_add_f32 v[96:97], v[96:97], v[62:63]
  v_pk_fma_f32 v[98:99], v[62:63], v[62:63], v[98:99]
  v_pk_add_f32 v[100:101], v[64:65], 0 op_sel_hi:[1,0]
  v_pk_mul_f32 v[102:103], v[64:65], v[64:65]
  v_pk_add_f32 v[100:101], v[100:101], v[66:67]
  v_pk_fma_f32 v[102:103], v[66:67], v[66:67], v[102:103]
  v_pk_add_f32 v[100:101], v[100:101], v[68:69]
  v_pk_fma_f32 v[102:103], v[68:69], v[68:69], v[102:103]
  v_pk_add_f32 v[100:101], v[100:101], v[70:71]
  v_pk_fma_f32 v[102:103], v[70:71], v[70:71], v[102:103]
  v_pk_add_f32 v[100:101], v[100:101], v[72:73]
  v_pk_fma_f32 v[102:103], v[72:73], v[72:73], v[102:103]
  v_pk_add_f32 v[100:101], v[100:101], v[74:75]
  v_pk_fma_f32 v[102:103], v[74:75], v[74:75], v[102:103]
  v_pk_add_f32 v[100:101], v[100:101], v[76:77]
  v_pk_fma_f32 v[102:103], v[76:77], v[76:77], v[102:103]
  v_pk_add_f32 v[100:101], v[100:101], v[78:79]
  v_pk_fma_f32 v[102:103], v[78:79], v[78:79], v[102:103]
  v_add_f32 v120, v88, v89
  v_add_f32 v121, v90, v91
  v_add_f32 v122, v92, v93
  v_add_f32 v123, v94, v95
  v_add_f32 v124, v96, v97
  v_add_f32 v125, v98, v99
  v_add_f32 v126, v100, v101
  v_add_f32 v127, v102, v103
  v_mov_b32 v128, v120
  v_mov_b32 v129, v121
  v_mov_b32 v130, v122
  v_mov_b32 v131, v123
  v_mov_b32 v132, v124
  v_mov_b32 v133, v125
  v_mov_b32 v134, v126
  v_mov_b32 v135, v127
  v_permlane32_swap_b32 v120, v128
  v_permlane32_swap_b32 v121, v129
  v_permlane32_swap_b32 v122, v130
  v_permlane32_swap_b32 v123, v131
  v_permlane32_swap_b32 v124, v132
  v_permlane32_swap_b32 v125, v133
  v_permlane32_swap_b32 v126, v134
  v_permlane32_swap_b32 v127, v135
  v_add_f32 v120, v120, v128
  v_add_f32 v121, v121, v129
  v_add_f32 v122, v122, v130
  v_add_f32 v123, v123, v131
  v_add_f32 v124, v124, v132
  v_add_f32 v125, v125, v133
  v_add_f32 v126, v126, v134
  v_add_f32 v127, v127, v135
  v_and_b32 v8, 31, v1
  v_lshlrev_b32 v8, 3, v8
  v_add_u32 v9, s13, v8
  ds_write_b64 v9, v[120:121] offset:0
  ds_write_b64 v9, v[122:123] offset:256
  ds_write_b64 v9, v[124:125] offset:512
  ds_write_b64 v9, v[126:127] offset:768
  s_mul_i32 s20, s12, 7168
  s_add_u32 s24, s62, 0x10000
  s_addc_u32 s25, s63, 0
  s_add_u32 s24, s24, s20
  s_addc_u32 s25, s25, 0
  s_mov_b32 s26, 0x1c00
  s_mov_b32 s27, 0x20000
  s_waitcnt lgkmcnt(0)
  s_barrier
  s_cmp_lg_u32 s8, 0
  s_cbranch_scc1 K3_WAIT
  v_add_u32 v9, 131072, v7
  ds_read_b128 v[88:91], v9 offset:0
  ds_read_b128 v[92:95], v9 offset:8192
  ds_read_b128 v[96:99], v9 offset:16384
  ds_read_b128 v[100:103], v9 offset:24576
  s_sub_u32 s20, s11, 7
  s_lshl_b32 s20, s20, 10
  s_mov_b32 s21, 4096
  s_mov_b32 s14, 0
  s_waitcnt lgkmcnt(0)
  v_pk_add_f32 v[88:89], v[88:89], v[96:97]
  v_pk_add_f32 v[90:91], v[90:91], v[98:99]
  v_pk_add_f32 v[92:93], v[92:93], v[100:101]
  v_pk_add_f32 v[94:95], v[94:95], v[102:103]
  v_pk_add_f32 v[88:89], v[88:89], v[92:93]
  v_pk_add_f32 v[90:91], v[90:91], v[94:95]
  v_or_b32 v89, 1, v89
  v_or_b32 v91, 1, v91
  buffer_store_dwordx4 v[88:91], v7, s[24:27], s20 offen sc1
  s_nop 0
K3_POLL:
  buffer_load_dwordx4 v[88:91], v7, s[24:27], 0 offen offset:0 sc1
  buffer_load_dwordx4 v[92:95], v7, s[24:27], 0 offen offset:1024 sc1
  buffer_load_dwordx4 v[96:99], v7, s[24:27], 0 offen offset:2048 sc1
  buffer_load_dwordx4 v[100:103], v7, s[24:27], 0 offen offset:3072 sc1
  buffer_load_dwordx4 v[104:107], v7, s[24:27], s21 offen offset:0 sc1
  buffer_load_dwordx4 v[108:111], v7, s[24:27], s21 offen offset:1024 sc1
  buffer_load_dwordx4 v[112:115], v7, s[24:27], s21 offen offset:2048 sc1
  s_waitcnt vmcnt(0)
  v_and_b32 v10, v89, v91
  v_and_b32 v10, v10, v93
  v_and_b32 v10, v10, v95
  v_and_b32 v10, v10, v97
  v_and_b32 v10, v10, v99
  v_and_b32 v10, v10, v101
  v_and_b32 v10, v10, v103
  v_and_b32 v10, v10, v105
  v_and_b32 v10, v10, v107
  v_and_b32 v10, v10, v109
  v_and_b32 v10, v10, v111
  v_and_b32 v10, v10, v113
  v_and_b32 v10, v10, v115
  v_and_b32 v10, 1, v10
  v_cmp_eq_u32 vcc, 0, v10
  s_add_u32 s14, s14, 1
  s_nop 3
  s_cbranch_vccz K3_GOT
  s_cmp_lt_u32 s14, 0x40000
  s_cbranch_scc1 K3_POLL
K3_GOT:
  v_pk_add_f32 v[88:89], v[88:89], v[92:93]
  v_pk_add_f32 v[90:91], v[90:91], v[94:95]
  v_pk_add_f32 v[88:89], v[88:89], v[96:97]
  v_pk_add_f32 v[90:91], v[90:91], v[98:99]
  v_pk_add_f32 v[88:89], v[88:89], v[100:101]
  v_pk_add_f32 v[90:91], v[90:91], v[102:103]
  v_pk_add_f32 v[88:89], v[88:89], v[104:105]
  v_pk_add_f32 v[90:91], v[90:91], v[106:107]
  v_pk_add_f32 v[88:89], v[88:89], v[108:109]
  v_pk_add_f32 v[90:91], v[90:91], v[110:111]
  v_pk_add_f32 v[88:89], v[88:89], v[112:113]
  v_pk_add_f32 v[90:91], v[90:91], v[114:115]
  v_mul_f32 v88, 0x3a924925, v88
  v_mul_f32 v89, 0x3a924925, v89
  v_mul_f32 v90, 0x3a924925, v90
  v_mul_f32 v91, 0x3a924925, v91
  v_fma_f32 v89, -v88, v88, v89
  v_fma_f32 v91, -v90, v90, v91
  v_max_f32 v89, 0, v89
  v_max_f32 v91, 0, v91
  v_add_f32 v89, 0x3727c5ac, v89
  v_add_f32 v91, 0x3727c5ac, v91
  v_rsq_f32 v89, v89
  v_rsq_f32 v91, v91
  s_nop 0
  v_mul_f32_e64 v88, -v88, v89
  v_mul_f32_e64 v90, -v90, v91
  ds_write_b128 v5, v[88:91]
  s_waitcnt lgkmcnt(0)
K3_WAIT:
  s_barrier
  v_add_u32 v8, 0x10000, v8
  ds_read_b64 v[120:121], v8 offset:0
  ds_read_b64 v[122:123], v8 offset:256
  ds_read_b64 v[124:125], v8 offset:512
  ds_read_b64 v[126:127], v8 offset:768
  v_and_b32 v9, 31, v1
  v_lshlrev_b32 v9, 6, v9
  v_lshrrev_b32 v10, 5, v1
  v_lshl_add_u32 v9, v10, 4, v9
  v_add_u32 v9, s13, v9
  v_lshrrev_b32 v10, 4, v1
  v_lshlrev_b32 v10, 9, v10
  v_bfe_u32 v11, v1, 2, 2
  v_lshl_add_u32 v10, v11, 6, v10
  v_and_b32 v11, 3, v1
  v_lshl_add_u32 v10, v11, 3, v10
  v_add_u32 v10, s13, v10
  s_sub_u32 s20, s11, 7
  s_lshl_b32 s20, s20, 19
  s_lshl_b32 s21, s8, 17
  s_add_u32 s20, s20, s21
  s_lshl_b32 s21, s12, 12
  s_add_u32 s20, s20, s21
  s_add_u32 s32, s62, 0x1000000
  s_addc_u32 s33, s63, 0
  s_add_u32 s32, s32, s20
  s_addc_u32 s33, s33, 0
  s_mov_b32 s34, 0x11000
  s_mov_b32 s35, 0x20000
  s_mov_b32 s20, 65536
  s_waitcnt lgkmcnt(0)
  v_pk_fma_f32 v[16:17], v[16:17], v[120:121], v[120:121] op_sel:[0,1,0] op_sel_hi:[1,1,0]
  v_pk_fma_f32 v[18:19], v[18:19], v[120:121], v[120:121] op_sel:[0,1,0] op_sel_hi:[1,1,0]
  v_pk_fma_f32 v[20:21], v[20:21], v[120:121], v[120:121] op_sel:[0,1,0] op_sel_hi:[1,1,0]
  v_pk_fma_f32 v[22:23], v[22:23], v[120:121], v[120:121] op_sel:[0,1,0] op_sel_hi:[1,1,0]
  v_pk_fma_f32 v[24:25], v[24:25], v[120:121], v[120:121] op_sel:[0,1,0] op_sel_hi:[1,1,0]
  v_pk_fma_f32 v[26:27], v[26:27], v[120:121], v[120:121] op_sel:[0,1,0] op_sel_hi:[1,1,0]
  v_pk_fma_f32 v[28:29], v[28:29], v[120:121], v[120:121] op_sel:[0,1,0] op_sel_hi:[1,1,0]
  v_pk_fma_f32 v[30:31], v[30:31], v[120:121], v[120:121] op_sel:[0,1,0] op_sel_hi:[1,1,0]
  v_cvt_pk_bf16_f32 v88, v16, v17
  v_cvt_pk_bf16_f32 v89, v18, v19
  v_cvt_pk_bf16_f32 v90, v20, v21
  v_cvt_pk_bf16_f32 v91, v22, v23
  ds_write_b128 v9, v[88:91] offset:0
  v_cvt_pk_bf16_f32 v92, v24, v25
  v_cvt_pk_bf16_f32 v93, v26, v27
  v_cvt_pk_bf16_f32 v94, v28, v29
  v_cvt_pk_bf16_f32 v95, v30, v31
  ds_write_b128 v9, v[92:95] offset:32
  v_pk_fma_f32 v[32:33], v[32:33], v[122:123], v[122:123] op_sel:[0,1,0] op_sel_hi:[1,1,0]
  v_pk_fma_f32 v[34:35], v[34:35], v[122:123], v[122:123] op_sel:[0,1,0] op_sel_hi:[1,1,0]
  v_pk_fma_f32 v[36:37], v[36:37], v[122:123], v[122:123] op_sel:[0,1,0] op_sel_hi:[1,1,0]
  v_pk_fma_f32 v[38:39], v[38:39], v[122:123], v[122:123] op_sel:[0,1,0] op_sel_hi:[1,1,0]
  v_pk_fma_f32 v[40:41], v[40:41], v[122:123], v[122:123] op_sel:[0,1,0] op_sel_hi:[1,1,0]
  v_pk_fma_f32 v[42:43], v[42:43], v[122:123], v[122:123] op_sel:[0,1,0] op_sel_hi:[1,1,0]
  v_pk_fma_f32 v[44:45], v[44:45], v[122:123], v[122:123] op_sel:[0,1,0] op_sel_hi:[1,1,0]
  v_pk_fma_f32 v[46:47], v[46:47], v[122:123], v[122:123] op_sel:[0,1,0] op_sel_hi:[1,1,0]
  v_cvt_pk_bf16_f32 v96, v32, v33
  v_cvt_pk_bf16_f32 v97, v34, v35
  v_cvt_pk_bf16_f32 v98, v36, v37
  v_cvt_pk_bf16_f32 v99, v38, v39
  ds_write_b128 v9, v[96:99] offset:2048
  v_cvt_pk_bf16_f32 v100, v40, v41
  v_cvt_pk_bf16_f32 v101, v42, v43
  v_cvt_pk_bf16_f32 v102, v44, v45
  v_cvt_pk_bf16_f32 v103, v46, v47
  ds_write_b128 v9, v[100:103] offset:2080
  v_pk_fma_f32 v[48:49], v[48:49], v[124:125], v[124:125] op_sel:[0,1,0] op_sel_hi:[1,1,0]
  v_pk_fma_f32 v[50:51], v[50:51], v[124:125], v[124:125] op_sel:[0,1,0] op_sel_hi:[1,1,0]
  v_pk_fma_f32 v[52:53], v[52:53], v[124:125], v[124:125] op_sel:[0,1,0] op_sel_hi:[1,1,0]
  v_pk_fma_f32 v[54:55], v[54:55], v[124:125], v[124:125] op_sel:[0,1,0] op_sel_hi:[1,1,0]
  v_pk_fma_f32 v[56:57], v[56:57], v[124:125], v[124:125] op_sel:[0,1,0] op_sel_hi:[1,1,0]
  v_pk_fma_f32 v[58:59], v[58:59], v[124:125], v[124:125] op_sel:[0,1,0] op_sel_hi:[1,1,0]
  v_pk_fma_f32 v[60:61], v[60:61], v[124:125], v[124:125] op_sel:[0,1,0] op_sel_hi:[1,1,0]
  v_pk_fma_f32 v[62:63], v[62:63], v[124:125], v[124:125] op_sel:[0,1,0] op_sel_hi:[1,1,0]
  v_cvt_pk_bf16_f32 v104, v48, v49
  v_cvt_pk_bf16_f32 v105, v50, v51
  v_cvt_pk_bf16_f32 v106, v52, v53
  v_cvt_pk_bf16_f32 v107, v54, v55
  ds_write_b128 v9, v[104:107] offset:4096
  v_cvt_pk_bf16_f32 v108, v56, v57
  v_cvt_pk_bf16_f32 v109, v58, v59
  v_cvt_pk_bf16_f32 v110, v60, v61
  v_cvt_pk_bf16_f32 v111, v62, v63
  ds_write_b128 v9, v[108:111] offset:4128
  v_pk_fma_f32 v[64:65], v[64:65], v[126:127], v[126:127] op_sel:[0,1,0] op_sel_hi:[1,1,0]
  v_pk_fma_f32 v[66:67], v[66:67], v[126:127], v[126:127] op_sel:[0,1,0] op_sel_hi:[1,1,0]
  v_pk_fma_f32 v[68:69], v[68:69], v[126:127], v[126:127] op_sel:[0,1,0] op_sel_hi:[1,1,0]
  v_pk_fma_f32 v[70:71], v[70:71], v[126:127], v[126:127] op_sel:[0,1,0] op_sel_hi:[1,1,0]
  v_pk_fma_f32 v[72:73], v[72:73], v[126:127], v[126:127] op_sel:[0,1,0] op_sel_hi:[1,1,0]
  v_pk_fma_f32 v[74:75], v[74:75], v[126:127], v[126:127] op_sel:[0,1,0] op_sel_hi:[1,1,0]
  v_pk_fma_f32 v[76:77], v[76:77], v[126:127], v[126:127] op_sel:[0,1,0] op_sel_hi:[1,1,0]
  v_pk_fma_f32 v[78:79], v[78:79], v[126:127], v[126:127] op_sel:[0,1,0] op_sel_hi:[1,1,0]
  v_cvt_pk_bf16_f32 v112, v64, v65
  v_cvt_pk_bf16_f32 v113, v66, v67
  v_cvt_pk_bf16_f32 v114, v68, v69
  v_cvt_pk_bf16_f32 v115, v70, v71
  ds_write_b128 v9, v[112:115] offset:6144
  v_cvt_pk_bf16_f32 v116, v72, v73
  v_cvt_pk_bf16_f32 v117, v74, v75
  v_cvt_pk_bf16_f32 v118, v76, v77
  v_cvt_pk_bf16_f32 v119, v78, v79
  ds_write_b128 v9, v[116:119] offset:6176
  s_waitcnt lgkmcnt(0)
  ds_read_b64_tr_b16 v[16:17], v10 offset:0
  ds_read_b64_tr_b16 v[18:19], v10 offset:256
  ds_read_b64_tr_b16 v[20:21], v10 offset:32
  ds_read_b64_tr_b16 v[22:23], v10 offset:288
  ds_read_b64_tr_b16 v[24:25], v10 offset:2048
  ds_read_b64_tr_b16 v[26:27], v10 offset:2304
  ds_read_b64_tr_b16 v[28:29], v10 offset:2080
  ds_read_b64_tr_b16 v[30:31], v10 offset:2336
  ds_read_b64_tr_b16 v[32:33], v10 offset:4096
  ds_read_b64_tr_b16 v[34:35], v10 offset:4352
  ds_read_b64_tr_b16 v[36:37], v10 offset:4128
  ds_read_b64_tr_b16 v[38:39], v10 offset:4384
  ds_read_b64_tr_b16 v[40:41], v10 offset:6144
  ds_read_b64_tr_b16 v[42:43], v10 offset:6400
  ds_read_b64_tr_b16 v[44:45], v10 offset:6176
  ds_read_b64_tr_b16 v[46:47], v10 offset:6432
  s_waitcnt lgkmcnt(14)
  buffer_store_dwordx4 v[16:19], v7, s[32:35], 0 offen offset:0 sc1
  s_waitcnt lgkmcnt(12)
  buffer_store_dwordx4 v[20:23], v7, s[32:35], s20 offen offset:0 sc1
  s_waitcnt lgkmcnt(10)
  buffer_store_dwordx4 v[24:27], v7, s[32:35], 0 offen offset:1024 sc1
  s_waitcnt lgkmcnt(8)
  buffer_store_dwordx4 v[28:31], v7, s[32:35], s20 offen offset:1024 sc1
  s_waitcnt lgkmcnt(6)
  buffer_store_dwordx4 v[32:35], v7, s[32:35], 0 offen offset:2048 sc1
  s_waitcnt lgkmcnt(4)
  buffer_store_dwordx4 v[36:39], v7, s[32:35], s20 offen offset:2048 sc1
  s_waitcnt lgkmcnt(2)
  buffer_store_dwordx4 v[40:43], v7, s[32:35], 0 offen offset:3072 sc1
  s_waitcnt lgkmcnt(0)
  buffer_store_dwordx4 v[44:47], v7, s[32:35], s20 offen offset:3072 sc1
  s_branch K3_FIN
K3_WOF:
  s_load_dwordx2 s[50:51], s[0:1], 72
  s_sub_u32 s3, s2, 224
  s_lshr_b32 s20, s3, 2
  s_and_b32 s3, s3, 3
  v_bfe_u32 v8, v1, 2, 2
  v_lshlrev_b32 v8, 4, v8
  v_and_b32 v9, 3, v1
  v_lshl_add_u32 v8, v9, 1, v8
  v_lshrrev_b32 v9, 4, v1
  v_lshl_add_u32 v8, v9, 12, v8
  s_lshl_b32 s21, s20, 7
  s_lshr_b32 s14, s8, 1
  s_lshl_b32 s14, s14, 6
  s_add_u32 s21, s21, s14
  s_and_b32 s14, s8, 1
  s_lshl_b32 s14, s14, 3
  s_add_u32 s21, s21, s14
  s_mul_i32 s14, s3, 229376
  s_add_u32 s21, s21, s14
  v_add_u32 v8, s21, v8
  v_add_u32 v9, 16384, v8
  s_mul_i32 s20, s20, 28
  s_mul_i32 s3, s3, 7
  s_add_u32 s20, s20, s3
  s_lshl_b32 s20, s20, 12
  s_lshl_b32 s21, s8, 10
  s_add_u32 s20, s20, s21
  s_waitcnt lgkmcnt(0) vmcnt(0)
  s_mov_b32 s24, s50
  s_mov_b32 s25, s51
  s_mov_b32 s26, 0xe0000
  s_mov_b32 s27, 0x20000
  s_add_u32 s28, s62, 0x1800000
  s_addc_u32 s29, s63, 0
  s_add_u32 s28, s28, s20
  s_addc_u32 s29, s29, 0
  s_mov_b32 s30, 0x6400
  s_mov_b32 s31, 0x20000
  s_mov_b32 s20, 0
  buffer_load_ushort v16, v8, s[24:27], s20 offen offset:0
  buffer_load_ushort v17, v8, s[24:27], s20 offen offset:1024
  buffer_load_ushort v18, v8, s[24:27], s20 offen offset:2048
  buffer_load_ushort v19, v8, s[24:27], s20 offen offset:3072
  buffer_load_ushort v20, v9, s[24:27], s20 offen offset:0
  buffer_load_ushort v21, v9, s[24:27], s20 offen offset:1024
  buffer_load_ushort v22, v9, s[24:27], s20 offen offset:2048
  buffer_load_ushort v23, v9, s[24:27], s20 offen offset:3072
  s_mov_b32 s20, 32768
  buffer_load_ushort v24, v8, s[24:27], s20 offen offset:0
  buffer_load_ushort v25, v8, s[24:27], s20 offen offset:1024
  buffer_load_ushort v26, v8, s[24:27], s20 offen offset:2048
  buffer_load_ushort v27, v8, s[24:27], s20 offen offset:3072
  buffer_load_ushort v28, v9, s[24:27], s20 offen offset:0
  buffer_load_ushort v29, v9, s[24:27], s20 offen offset:1024
  buffer_load_ushort v30, v9, s[24:27], s20 offen offset:2048
  buffer_load_ushort v31, v9, s[24:27], s20 offen offset:3072
  s_mov_b32 s20, 65536
  buffer_load_ushort v32, v8, s[24:27], s20 offen offset:0
  buffer_load_ushort v33, v8, s[24:27], s20 offen offset:1024
  buffer_load_ushort v34, v8, s[24:27], s20 offen offset:2048
  buffer_load_ushort v35, v8, s[24:27], s20 offen offset:3072
  buffer_load_ushort v36, v9, s[24:27], s20 offen offset:0
  buffer_load_ushort v37, v9, s[24:27], s20 offen offset:1024
  buffer_load_ushort v38, v9, s[24:27], s20 offen offset:2048
  buffer_load_ushort v39, v9, s[24:27], s20 offen offset:3072
  s_mov_b32 s20, 98304
  buffer_load_ushort v40, v8, s[24:27], s20 offen offset:0
  buffer_load_ushort v41, v8, s[24:27], s20 offen offset:1024
  buffer_load_ushort v42, v8, s[24:27], s20 offen offset:2048
  buffer_load_ushort v43, v8, s[24:27], s20 offen offset:3072
  buffer_load_ushort v44, v9, s[24:27], s20 offen offset:0
  buffer_load_ushort v45, v9, s[24:27], s20 offen offset:1024
  buffer_load_ushort v46, v9, s[24:27], s20 offen offset:2048
  buffer_load_ushort v47, v9, s[24:27], s20 offen offset:3072
  s_mov_b32 s20, 131072
  buffer_load_ushort v48, v8, s[24:27], s20 offen offset:0
  buffer_load_ushort v49, v8, s[24:27], s20 offen offset:1024
  buffer_load_ushort v50, v8, s[24:27], s20 offen offset:2048
  buffer_load_ushort v51, v8, s[24:27], s20 offen offset:3072
  buffer_load_ushort v52, v9, s[24:27], s20 offen offset:0
  buffer_load_ushort v53, v9, s[24:27], s20 offen offset:1024
  buffer_load_ushort v54, v9, s[24:27], s20 offen offset:2048
  buffer_load_ushort v55, v9, s[24:27], s20 offen offset:3072
  s_mov_b32 s20, 163840
  buffer_load_ushort v56, v8, s[24:27], s20 offen offset:0
  buffer_load_ushort v57, v8, s[24:27], s20 offen offset:1024
  buffer_load_ushort v58, v8, s[24:27], s20 offen offset:2048
  buffer_load_ushort v59, v8, s[24:27], s20 offen offset:3072
  buffer_load_ushort v60, v9, s[24:27], s20 offen offset:0
  buffer_load_ushort v61, v9, s[24:27], s20 offen offset:1024
  buffer_load_ushort v62, v9, s[24:27], s20 offen offset:2048
  buffer_load_ushort v63, v9, s[24:27], s20 offen offset:3072
  s_mov_b32 s20, 196608
  buffer_load_ushort v64, v8, s[24:27], s20 offen offset:0
  buffer_load_ushort v65, v8, s[24:27], s20 offen offset:1024
  buffer_load_ushort v66, v8, s[24:27], s20 offen offset:2048
  buffer_load_ushort v67, v8, s[24:27], s20 offen offset:3072
  buffer_load_ushort v68, v9, s[24:27], s20 offen offset:0
  buffer_load_ushort v69, v9, s[24:27], s20 offen offset:1024
  buffer_load_ushort v70, v9, s[24:27], s20 offen offset:2048
  buffer_load_ushort v71, v9, s[24:27], s20 offen offset:3072
  s_waitcnt vmcnt(48)
  s_mov_b32 s20, 0
  v_lshl_or_b32 v80, v17, 16, v16
  v_lshl_or_b32 v81, v19, 16, v18
  v_lshl_or_b32 v82, v21, 16, v20
  v_lshl_or_b32 v83, v23, 16, v22
  buffer_store_dwordx4 v[80:83], v7, s[28:31], s20 offen sc1
  s_waitcnt vmcnt(41)
  s_mov_b32 s20, 4096
  v_lshl_or_b32 v84, v25, 16, v24
  v_lshl_or_b32 v85, v27, 16, v26
  v_lshl_or_b32 v86, v29, 16, v28
  v_lshl_or_b32 v87, v31, 16, v30
  buffer_store_dwordx4 v[84:87], v7, s[28:31], s20 offen sc1
  s_waitcnt vmcnt(34)
  s_mov_b32 s20, 8192
  v_lshl_or_b32 v88, v33, 16, v32
  v_lshl_or_b32 v89, v35, 16, v34
  v_lshl_or_b32 v90, v37, 16, v36
  v_lshl_or_b32 v91, v39, 16, v38
  buffer_store_dwordx4 v[88:91], v7, s[28:31], s20 offen sc1
  s_waitcnt vmcnt(27)
  s_mov_b32 s20, 12288
  v_lshl_or_b32 v92, v41, 16, v40
  v_lshl_or_b32 v93, v43, 16, v42
  v_lshl_or_b32 v94, v45, 16, v44
  v_lshl_or_b32 v95, v47, 16, v46
  buffer_store_dwordx4 v[92:95], v7, s[28:31], s20 offen sc1
  s_waitcnt vmcnt(20)
  s_mov_b32 s20, 16384
  v_lshl_or_b32 v96, v49, 16, v48
  v_lshl_or_b32 v97, v51, 16, v50
  v_lshl_or_b32 v98, v53, 16, v52
  v_lshl_or_b32 v99, v55, 16, v54
  buffer_store_dwordx4 v[96:99], v7, s[28:31], s20 offen sc1
  s_waitcnt vmcnt(13)
  s_mov_b32 s20, 20480
  v_lshl_or_b32 v100, v57, 16, v56
  v_lshl_or_b32 v101, v59, 16, v58
  v_lshl_or_b32 v102, v61, 16, v60
  v_lshl_or_b32 v103, v63, 16, v62
  buffer_store_dwordx4 v[100:103], v7, s[28:31], s20 offen sc1
  s_waitcnt vmcnt(6)
  s_mov_b32 s20, 24576
  v_lshl_or_b32 v104, v65, 16, v64
  v_lshl_or_b32 v105, v67, 16, v66
  v_lshl_or_b32 v106, v69, 16, v68
  v_lshl_or_b32 v107, v71, 16, v70
  buffer_store_dwordx4 v[104:107], v7, s[28:31], s20 offen sc1
  s_add_u32 m0, s13, 0
  s_mov_b32 s48, 0
  buffer_load_dwordx4 v160, s[44:47], s48 offen offset:0 lds
  buffer_load_dwordx4 v161, s[44:47], s48 offen offset:1024 lds
  buffer_load_dwordx4 v162, s[44:47], s48 offen offset:2048 lds
  buffer_load_dwordx4 v163, s[44:47], s48 offen offset:3072 lds
  s_add_u32 m0, s13, 4096
  s_mov_b32 s48, 0
  buffer_load_dwordx4 v164, s[44:47], s48 offen offset:0 lds
  buffer_load_dwordx4 v165, s[44:47], s48 offen offset:1024 lds
  buffer_load_dwordx4 v166, s[44:47], s48 offen offset:2048 lds
  buffer_load_dwordx4 v167, s[44:47], s48 offen offset:3072 lds
  s_waitcnt vmcnt(0)
  ds_read_b128 a[128:131], v168 offset:0
  ds_read_b128 a[132:135], v168 offset:2048
  ds_read_b128 a[136:139], v168 offset:4096
  ds_read_b128 a[140:143], v168 offset:6144
  ds_read_b128 a[144:147], v169 offset:0
  ds_read_b128 a[148:151], v169 offset:2048
  ds_read_b128 a[152:155], v169 offset:4096
  ds_read_b128 a[156:159], v169 offset:6144
  s_waitcnt lgkmcnt(0)
  s_add_u32 m0, s13, 0
  s_mov_b32 s48, 128
  buffer_load_dwordx4 v160, s[44:47], s48 offen offset:0 lds
  buffer_load_dwordx4 v161, s[44:47], s48 offen offset:1024 lds
  buffer_load_dwordx4 v162, s[44:47], s48 offen offset:2048 lds
  buffer_load_dwordx4 v163, s[44:47], s48 offen offset:3072 lds
  s_add_u32 m0, s13, 4096
  s_mov_b32 s48, 128
  buffer_load_dwordx4 v164, s[44:47], s48 offen offset:0 lds
  buffer_load_dwordx4 v165, s[44:47], s48 offen offset:1024 lds
  buffer_load_dwordx4 v166, s[44:47], s48 offen offset:2048 lds
  buffer_load_dwordx4 v167, s[44:47], s48 offen offset:3072 lds
  s_waitcnt vmcnt(0)
  ds_read_b128 a[160:163], v168 offset:0
  ds_read_b128 a[164:167], v168 offset:2048
  ds_read_b128 a[168:171], v168 offset:4096
  ds_read_b128 a[172:175], v168 offset:6144
  ds_read_b128 a[176:179], v169 offset:0
  ds_read_b128 a[180:183], v169 offset:2048
  ds_read_b128 a[184:187], v169 offset:4096
  ds_read_b128 a[188:191], v169 offset:6144
  s_waitcnt lgkmcnt(0)
  s_add_u32 m0, s13, 0
  s_mov_b32 s48, 256
  buffer_load_dwordx4 v160, s[44:47], s48 offen offset:0 lds
  buffer_load_dwordx4 v161, s[44:47], s48 offen offset:1024 lds
  buffer_load_dwordx4 v162, s[44:47], s48 offen offset:2048 lds
  buffer_load_dwordx4 v163, s[44:47], s48 offen offset:3072 lds
  s_add_u32 m0, s13, 4096
  s_mov_b32 s48, 256
  buffer_load_dwordx4 v164, s[44:47], s48 offen offset:0 lds
  buffer_load_dwordx4 v165, s[44:47], s48 offen offset:1024 lds
  buffer_load_dwordx4 v166, s[44:47], s48 offen offset:2048 lds
  buffer_load_dwordx4 v167, s[44:47], s48 offen offset:3072 lds
  s_waitcnt vmcnt(0)
  ds_read_b128 a[192:195], v168 offset:0
  ds_read_b128 a[196:199], v168 offset:2048
  ds_read_b128 a[200:203], v168 offset:4096
  ds_read_b128 a[204:207], v168 offset:6144
  ds_read_b128 a[208:211], v169 offset:0
  ds_read_b128 a[212:215], v169 offset:2048
  ds_read_b128 a[216:219], v169 offset:4096
  ds_read_b128 a[220:223], v169 offset:6144
  s_waitcnt lgkmcnt(0)
  s_add_u32 m0, s49, 0
  s_mov_b32 s48, 384
  buffer_load_dwordx4 v160, s[44:47], s48 offen offset:0 lds
  buffer_load_dwordx4 v161, s[44:47], s48 offen offset:1024 lds
  buffer_load_dwordx4 v162, s[44:47], s48 offen offset:2048 lds
  buffer_load_dwordx4 v163, s[44:47], s48 offen offset:3072 lds
  s_add_u32 m0, s49, 4096
  s_mov_b32 s48, 384
  buffer_load_dwordx4 v164, s[44:47], s48 offen offset:0 lds
  buffer_load_dwordx4 v165, s[44:47], s48 offen offset:1024 lds
  buffer_load_dwordx4 v166, s[44:47], s48 offen offset:2048 lds
  buffer_load_dwordx4 v167, s[44:47], s48 offen offset:3072 lds
  s_add_u32 m0, s49, 8192
  s_mov_b32 s48, 512
  buffer_load_dwordx4 v160, s[44:47], s48 offen offset:0 lds
  buffer_load_dwordx4 v161, s[44:47], s48 offen offset:1024 lds
  buffer_load_dwordx4 v162, s[44:47], s48 offen offset:2048 lds
  buffer_load_dwordx4 v163, s[44:47], s48 offen offset:3072 lds
  s_add_u32 m0, s49, 12288
  s_mov_b32 s48, 512
  buffer_load_dwordx4 v164, s[44:47], s48 offen offset:0 lds
  buffer_load_dwordx4 v165, s[44:47], s48 offen offset:1024 lds
  buffer_load_dwordx4 v166, s[44:47], s48 offen offset:2048 lds
  buffer_load_dwordx4 v167, s[44:47], s48 offen offset:3072 lds
  s_add_u32 m0, s49, 73728
  s_mov_b32 s48, 640
  buffer_load_dwordx4 v160, s[44:47], s48 offen offset:0 lds
  buffer_load_dwordx4 v161, s[44:47], s48 offen offset:1024 lds
  buffer_load_dwordx4 v162, s[44:47], s48 offen offset:2048 lds
  buffer_load_dwordx4 v163, s[44:47], s48 offen offset:3072 lds
  s_add_u32 m0, s49, 77824
  s_mov_b32 s48, 640
  buffer_load_dwordx4 v164, s[44:47], s48 offen offset:0 lds
  buffer_load_dwordx4 v165, s[44:47], s48 offen offset:1024 lds
  buffer_load_dwordx4 v166, s[44:47], s48 offen offset:2048 lds
  buffer_load_dwordx4 v167, s[44:47], s48 offen offset:3072 lds
K3_FIN:
K45_SEG:
  s_load_dwordx4 s[16:19], s[0:1], 56
  s_load_dwordx2 s[20:21], s[0:1], 112
  s_load_dwordx2 s[50:51], s[0:1], 96
  v_and_b32 v1, 63, v0
  v_lshrrev_b32 v2, 6, v0
  s_nop 0
  v_readfirstlane_b32 s32, v2
  s_bfe_u32 s33, s2, 0x20001
  s_lshl_b32 s33, s33, 3
  s_bfe_u32 s35, s2, 0x30003
  s_add_u32 s33, s33, s35
  s_and_b32 s34, s2, 1
  s_lshl_b32 s34, s34, 2
  s_lshr_b32 s35, s2, 6
  s_add_u32 s34, s34, s35
  v_lshlrev_b32 v3, 4, v1
  v_and_b32 v5, 15, v1
  v_lshrrev_b32 v6, 4, v1
  v_lshrrev_b32 v7, 3, v1
  v_lshlrev_b32 v7, 12, v7
  v_and_b32 v8, 7, v1
  v_xor_b32 v8, v8, v6
  v_lshl_add_u32 v16, v8, 4, v7
  v_xor_b32 v8, 4, v8
  v_lshl_add_u32 v17, v8, 4, v7
  v_add_u32 v17, 31744, v17
  v_add_u32 v18, 63488, v16
  v_add_u32 v19, 63488, v17
  v_add_u32 v20, 131072, v16
  v_add_u32 v21, 131072, v17
  v_add_u32 v22, 194560, v16
  v_add_u32 v23, 194560, v17
  s_mov_b32 s41, 65536
  s_mov_b32 s42, 131072
  s_mov_b32 s43, 196608
  s_mov_b32 s44, 262144
  s_mov_b32 s45, 327680
  s_mov_b32 s46, 393216
  s_lshl_b32 s39, s32, 15
  s_mov_b32 s47, 768
  s_lshl_b32 s48, s32, 14
  s_lshl_b32 s49, s32, 13
  s_add_u32 s49, s49, 131072
  s_waitcnt lgkmcnt(0)
  s_mul_i32 s35, s34, 458752
  s_lshl_b32 s36, s32, 14
  s_add_u32 s35, s35, s36
  s_add_u32 s4, s20, 0x1000000
  s_addc_u32 s5, s21, 0
  s_add_u32 s4, s4, s35
  s_addc_u32 s5, s5, 0
  s_mov_b32 s6, 0x64000
  s_mov_b32 s7, 0x20000
  s_lshl_b32 s35, s33, 18
  s_lshl_b32 s36, s32, 10
  s_add_u32 s35, s35, s36
  s_add_u32 s8, s16, s35
  s_addc_u32 s9, s17, 0
  s_mov_b32 s10, 0x3f400
  s_mov_b32 s11, 0x20000
  s_bfe_u32 s35, s2, 0x20001
  s_lshl_b32 s35, s35, 11
  s_add_u32 s35, s35, 0x31000
  v_lshlrev_b32 v26, 8, v1
  v_add_u32 v26, s35, v26
  v_mov_b32 v27, 1
  s_waitcnt vmcnt(0)
  s_barrier
  s_cmp_lg_u32 s32, 0
  s_cbranch_scc1 K4_NOPUB
  s_mov_b64 exec, 0xff
  global_atomic_add v26, v27, s[20:21]
  s_mov_b64 exec, -1
K4_NOPUB:
  s_add_u32 m0, s48, 65536
  s_nop 0
  buffer_load_dwordx4 v16, s[8:11], s47 offen offset:0 lds
  buffer_load_dwordx4 v17, s[8:11], s47 offen offset:1024 lds
  buffer_load_dwordx4 v18, s[8:11], s47 offen offset:2048 lds
  buffer_load_dwordx4 v19, s[8:11], s47 offen offset:3072 lds
  s_add_u32 m0, s48, 69632
  s_nop 0
  buffer_load_dwordx4 v20, s[8:11], s47 offen offset:0 lds
  buffer_load_dwordx4 v21, s[8:11], s47 offen offset:1024 lds
  buffer_load_dwordx4 v22, s[8:11], s47 offen offset:2048 lds
  buffer_load_dwordx4 v23, s[8:11], s47 offen offset:3072 lds
  s_add_u32 s47, s47, 128
  s_add_u32 m0, s49, 0
  s_nop 0
  buffer_load_dwordx4 v16, s[8:11], s47 offen offset:0 lds
  buffer_load_dwordx4 v17, s[8:11], s47 offen offset:1024 lds
  buffer_load_dwordx4 v18, s[8:11], s47 offen offset:2048 lds
  buffer_load_dwordx4 v19, s[8:11], s47 offen offset:3072 lds
  s_add_u32 m0, s49, 4096
  s_nop 0
  buffer_load_dwordx4 v20, s[8:11], s47 offen offset:0 lds
  buffer_load_dwordx4 v21, s[8:11], s47 offen offset:1024 lds
  buffer_load_dwordx4 v22, s[8:11], s47 offen offset:2048 lds
  buffer_load_dwordx4 v23, s[8:11], s47 offen offset:3072 lds
  s_add_u32 s47, s47, 128
  v_lshrrev_b32 v7, 1, v5
  v_xor_b32 v7, v7, v6
  v_lshlrev_b32 v8, 7, v5
  v_lshl_add_u32 v24, v7, 4, v8
  v_xor_b32 v7, 4, v7
  v_lshl_add_u32 v25, v7, 4, v8
  v_add_u32 v30, s49, v24
  v_add_u32 v24, s48, v24
  v_add_u32 v28, 0x10000, v24
  v_add_u32 v31, s49, v25
  v_add_u32 v25, s48, v25
  v_add_u32 v29, 0x10000, v25
  s_lshl_b32 s35, s33, 2
  s_add_u32 s35, s35, s32
  s_mul_i32 s36, s35, 56
  s_mul_i32 s37, s34, 7
  s_add_u32 s36, s36, s37
  s_lshl_b32 s36, s36, 9
  s_add_u32 s12, s20, 0x800000
  s_addc_u32 s13, s21, 0
  s_add_u32 s12, s12, s36
  s_addc_u32 s13, s13, 0
  s_mov_b32 s14, 0xe00
  s_mov_b32 s15, 0x20000
  v_lshrrev_b32 v7, 1, v6
  v_lshlrev_b32 v7, 8, v7
  v_lshl_add_u32 v7, v5, 4, v7
  v_and_b32 v8, 1, v6
  v_lshl_add_u32 v7, v8, 3, v7
  s_mul_i32 s36, s35, 28672
  s_add_u32 s24, s20, 0x1400000
  s_addc_u32 s25, s21, 0
  s_add_u32 s24, s24, s36
  s_addc_u32 s25, s25, 0
  s_mov_b32 s26, 0x7000
  s_mov_b32 s27, 0x20000
  s_lshl_b32 s36, s35, 5
  s_add_u32 s28, s18, s36
  s_addc_u32 s29, s19, 0
  s_mov_b32 s30, 0x20
  s_mov_b32 s31, 0x20000
  v_lshlrev_b32 v8, 1, v5
  v_lshlrev_b32 v9, 4, v1
  s_mov_b32 s38, 0xffff0000
  s_mul_i32 s35, s34, 28
  s_mul_i32 s36, s32, 7
  s_add_u32 s35, s35, s36
  s_lshl_b32 s35, s35, 12
  s_add_u32 s52, s20, 0x1800000
  s_addc_u32 s53, s21, 0
  s_add_u32 s52, s52, s35
  s_addc_u32 s53, s53, 0
  s_mov_b32 s54, 0x7000
  s_mov_b32 s55, 0x20000
  s_cmp_lg_u32 s32, 0
  s_cbranch_scc1 K4_NOPOLL
  s_and_b32 s35, s2, 7
  s_lshl_b32 s35, s35, 8
  s_add_u32 s35, s35, 0x31000
  v_lshlrev_b32 v26, 11, v1
  v_add_u32 v26, s35, v26
  s_mov_b32 s36, 0
  s_mov_b64 exec, 15
K4_POLL:
  global_load_dword v27, v26, s[20:21] sc1
  s_waitcnt vmcnt(0)
  v_cmp_gt_u32 vcc, 64, v27
  s_add_u32 s36, s36, 1
  s_nop 3
  s_cbranch_vccz K4_POLL_OK
  s_cmp_lt_u32 s36, 0x100000
  s_cbranch_scc1 K4_POLL
K4_POLL_OK:
  s_mov_b64 exec, -1
K4_NOPOLL:
  s_barrier
  buffer_load_dwordx4 v[32:35], v3, s[4:7], 0 offen offset:0 sc1
  buffer_load_dwordx4 v[36:39], v3, s[4:7], s41 offen offset:0 sc1
  buffer_load_dwordx4 v[40:43], v3, s[4:7], s42 offen offset:0 sc1
  buffer_load_dwordx4 v[44:47], v3, s[4:7], s43 offen offset:0 sc1
  buffer_load_dwordx4 v[48:51], v3, s[4:7], s44 offen offset:0 sc1
  buffer_load_dwordx4 v[52:55], v3, s[4:7], s45 offen offset:0 sc1
  buffer_load_dwordx4 v[56:59], v3, s[4:7], s46 offen offset:0 sc1
  buffer_load_dwordx4 v[60:63], v3, s[4:7], 0 offen offset:1024 sc1
  buffer_load_dwordx4 v[64:67], v3, s[4:7], s41 offen offset:1024 sc1
  buffer_load_dwordx4 v[68:71], v3, s[4:7], s42 offen offset:1024 sc1
  buffer_load_dwordx4 v[72:75], v3, s[4:7], s43 offen offset:1024 sc1
  buffer_load_dwordx4 v[76:79], v3, s[4:7], s44 offen offset:1024 sc1
  buffer_load_dwordx4 v[80:83], v3, s[4:7], s45 offen offset:1024 sc1
  buffer_load_dwordx4 v[84:87], v3, s[4:7], s46 offen offset:1024 sc1
  s_waitcnt vmcnt(7) lgkmcnt(0)
  v_mfma_f32_16x16x32_bf16 a[0:3], v[32:35], a[128:131], 0
  buffer_load_dwordx4 v[88:91], v3, s[4:7], 0 offen offset:2048 sc1
  v_mfma_f32_16x16x32_bf16 a[28:31], v[32:35], a[132:135], 0
  buffer_load_dwordx4 v[92:95], v3, s[4:7], s41 offen offset:2048 sc1
  v_mfma_f32_16x16x32_bf16 a[56:59], v[32:35], a[136:139], 0
  v_mfma_f32_16x16x32_bf16 a[84:87], v[32:35], a[140:143], 0
  buffer_load_dwordx4 v[96:99], v3, s[4:7], s42 offen offset:2048 sc1
  v_mfma_f32_16x16x32_bf16 a[4:7], v[36:39], a[128:131], 0
  buffer_load_dwordx4 v[100:103], v3, s[4:7], s43 offen offset:2048 sc1
  v_mfma_f32_16x16x32_bf16 a[32:35], v[36:39], a[132:135], 0
  buffer_load_dwordx4 v[104:107], v3, s[4:7], s44 offen offset:2048 sc1
  v_mfma_f32_16x16x32_bf16 a[60:63], v[36:39], a[136:139], 0
  v_mfma_f32_16x16x32_bf16 a[88:91], v[36:39], a[140:143], 0
  buffer_load_dwordx4 v[108:111], v3, s[4:7], s45 offen offset:2048 sc1
  v_mfma_f32_16x16x32_bf16 a[8:11], v[40:43], a[128:131], 0
  buffer_load_dwordx4 v[112:115], v3, s[4:7], s46 offen offset:2048 sc1
  v_mfma_f32_16x16x32_bf16 a[36:39], v[40:43], a[132:135], 0
  buffer_load_dwordx4 v[116:119], v3, s[4:7], 0 offen offset:3072 sc1
  v_mfma_f32_16x16x32_bf16 a[64:67], v[40:43], a[136:139], 0
  v_mfma_f32_16x16x32_bf16 a[92:95], v[40:43], a[140:143], 0
  buffer_load_dwordx4 v[120:123], v3, s[4:7], s41 offen offset:3072 sc1
  v_mfma_f32_16x16x32_bf16 a[12:15], v[44:47], a[128:131], 0
  buffer_load_dwordx4 v[124:127], v3, s[4:7], s42 offen offset:3072 sc1
  v_mfma_f32_16x16x32_bf16 a[40:43], v[44:47], a[132:135], 0
  buffer_load_dwordx4 v[128:131], v3, s[4:7], s43 offen offset:3072 sc1
  v_mfma_f32_16x16x32_bf16 a[68:71], v[44:47], a[136:139], 0
  v_mfma_f32_16x16x32_bf16 a[96:99], v[44:47], a[140:143], 0
  buffer_load_dwordx4 v[132:135], v3, s[4:7], s44 offen offset:3072 sc1
  v_mfma_f32_16x16x32_bf16 a[16:19], v[48:51], a[128:131], 0
  buffer_load_dwordx4 v[136:139], v3, s[4:7], s45 offen offset:3072 sc1
  v_mfma_f32_16x16x32_bf16 a[44:47], v[48:51], a[132:135], 0
  buffer_load_dwordx4 v[140:143], v3, s[4:7], s46 offen offset:3072 sc1
  v_mfma_f32_16x16x32_bf16 a[72:75], v[48:51], a[136:139], 0
  v_mfma_f32_16x16x32_bf16 a[100:103], v[48:51], a[140:143], 0
  v_add_u32 v3, 4096, v3
  buffer_load_dwordx4 v[144:147], v3, s[4:7], 0 offen offset:0 sc1
  v_mfma_f32_16x16x32_bf16 a[20:23], v[52:55], a[128:131], 0
  v_mfma_f32_16x16x32_bf16 a[48:51], v[52:55], a[132:135], 0
  buffer_load_dwordx4 v[148:151], v3, s[4:7], s41 offen offset:0 sc1
  v_mfma_f32_16x16x32_bf16 a[76:79], v[52:55], a[136:139], 0
  v_mfma_f32_16x16x32_bf16 a[104:107], v[52:55], a[140:143], 0
  buffer_load_dwordx4 v[152:155], v3, s[4:7], s42 offen offset:0 sc1
  v_mfma_f32_16x16x32_bf16 a[24:27], v[56:59], a[128:131], 0
  buffer_load_dwordx4 v[156:159], v3, s[4:7], s43 offen offset:0 sc1
  v_mfma_f32_16x16x32_bf16 a[52:55], v[56:59], a[132:135], 0
  buffer_load_dwordx4 v[160:163], v3, s[4:7], s44 offen offset:0 sc1
  v_mfma_f32_16x16x32_bf16 a[80:83], v[56:59], a[136:139], 0
  v_mfma_f32_16x16x32_bf16 a[108:111], v[56:59], a[140:143], 0
  buffer_load_dwordx4 v[164:167], v3, s[4:7], s45 offen offset:0 sc1
  s_waitcnt vmcnt(20) lgkmcnt(0)
  v_mfma_f32_16x16x32_bf16 a[0:3], v[60:63], a[144:147], a[0:3]
  v_mfma_f32_16x16x32_bf16 a[28:31], v[60:63], a[148:151], a[28:31]
  buffer_load_dwordx4 v[168:171], v3, s[4:7], s46 offen offset:0 sc1
  v_mfma_f32_16x16x32_bf16 a[56:59], v[60:63], a[152:155], a[56:59]
  v_mfma_f32_16x16x32_bf16 a[84:87], v[60:63], a[156:159], a[84:87]
  v_mfma_f32_16x16x32_bf16 a[4:7], v[64:67], a[144:147], a[4:7]
  v_mfma_f32_16x16x32_bf16 a[32:35], v[64:67], a[148:151], a[32:35]
  buffer_load_dwordx4 v[32:35], v3, s[4:7], 0 offen offset:1024 sc1
  v_mfma_f32_16x16x32_bf16 a[60:63], v[64:67], a[152:155], a[60:63]
  v_mfma_f32_16x16x32_bf16 a[88:91], v[64:67], a[156:159], a[88:91]
  v_mfma_f32_16x16x32_bf16 a[8:11], v[68:71], a[144:147], a[8:11]
  buffer_load_dwordx4 v[36:39], v3, s[4:7], s41 offen offset:1024 sc1
  v_mfma_f32_16x16x32_bf16 a[36:39], v[68:71], a[148:151], a[36:39]
  v_mfma_f32_16x16x32_bf16 a[64:67], v[68:71], a[152:155], a[64:67]
  v_mfma_f32_16x16x32_bf16 a[92:95], v[68:71], a[156:159], a[92:95]
  v_mfma_f32_16x16x32_bf16 a[12:15], v[72:75], a[144:147], a[12:15]
  buffer_load_dwordx4 v[40:43], v3, s[4:7], s42 offen offset:1024 sc1
  v_mfma_f32_16x16x32_bf16 a[40:43], v[72:75], a[148:151], a[40:43]
  v_mfma_f32_16x16x32_bf16 a[68:71], v[72:75], a[152:155], a[68:71]
  v_mfma_f32_16x16x32_bf16 a[96:99], v[72:75], a[156:159], a[96:99]
  buffer_load_dwordx4 v[44:47], v3, s[4:7], s43 offen offset:1024 sc1
  v_mfma_f32_16x16x32_bf16 a[16:19], v[76:79], a[144:147], a[16:19]
  v_mfma_f32_16x16x32_bf16 a[44:47], v[76:79], a[148:151], a[44:47]
  v_mfma_f32_16x16x32_bf16 a[72:75], v[76:79], a[152:155], a[72:75]
  v_mfma_f32_16x16x32_bf16 a[100:103], v[76:79], a[156:159], a[100:103]
  buffer_load_dwordx4 v[48:51], v3, s[4:7], s44 offen offset:1024 sc1
  v_mfma_f32_16x16x32_bf16 a[20:23], v[80:83], a[144:147], a[20:23]
  v_mfma_f32_16x16x32_bf16 a[48:51], v[80:83], a[148:151], a[48:51]
  v_mfma_f32_16x16x32_bf16 a[76:79], v[80:83], a[152:155], a[76:79]
  buffer_load_dwordx4 v[52:55], v3, s[4:7], s45 offen offset:1024 sc1
  v_mfma_f32_16x16x32_bf16 a[104:107], v[80:83], a[156:159], a[104:107]
  v_mfma_f32_16x16x32_bf16 a[24:27], v[84:87], a[144:147], a[24:27]
  v_mfma_f32_16x16x32_bf16 a[52:55], v[84:87], a[148:151], a[52:55]
  v_mfma_f32_16x16x32_bf16 a[80:83], v[84:87], a[152:155], a[80:83]
  buffer_load_dwordx4 v[56:59], v3, s[4:7], s46 offen offset:1024 sc1
  v_mfma_f32_16x16x32_bf16 a[108:111], v[84:87], a[156:159], a[108:111]
  s_waitcnt vmcnt(21) lgkmcnt(0)
  v_mfma_f32_16x16x32_bf16 a[0:3], v[88:91], a[160:163], a[0:3]
  v_mfma_f32_16x16x32_bf16 a[28:31], v[88:91], a[164:167], a[28:31]
  buffer_load_dwordx4 v[60:63], v3, s[4:7], 0 offen offset:2048 sc1
  v_mfma_f32_16x16x32_bf16 a[56:59], v[88:91], a[168:171], a[56:59]
  v_mfma_f32_16x16x32_bf16 a[84:87], v[88:91], a[172:175], a[84:87]
  v_mfma_f32_16x16x32_bf16 a[4:7], v[92:95], a[160:163], a[4:7]
  v_mfma_f32_16x16x32_bf16 a[32:35], v[92:95], a[164:167], a[32:35]
  buffer_load_dwordx4 v[64:67], v3, s[4:7], s41 offen offset:2048 sc1
  v_mfma_f32_16x16x32_bf16 a[60:63], v[92:95], a[168:171], a[60:63]
  v_mfma_f32_16x16x32_bf16 a[88:91], v[92:95], a[172:175], a[88:91]
  v_mfma_f32_16x16x32_bf16 a[8:11], v[96:99], a[160:163], a[8:11]
  v_mfma_f32_16x16x32_bf16 a[36:39], v[96:99], a[164:167], a[36:39]
  buffer_load_dwordx4 v[68:71], v3, s[4:7], s42 offen offset:2048 sc1
  v_mfma_f32_16x16x32_bf16 a[64:67], v[96:99], a[168:171], a[64:67]
  v_mfma_f32_16x16x32_bf16 a[92:95], v[96:99], a[172:175], a[92:95]
  v_mfma_f32_16x16x32_bf16 a[12:15], v[100:103], a[160:163], a[12:15]
  v_mfma_f32_16x16x32_bf16 a[40:43], v[100:103], a[164:167], a[40:43]
  buffer_load_dwordx4 v[72:75], v3, s[4:7], s43 offen offset:2048 sc1
  v_mfma_f32_16x16x32_bf16 a[68:71], v[100:103], a[168:171], a[68:71]
  v_mfma_f32_16x16x32_bf16 a[96:99], v[100:103], a[172:175], a[96:99]
  v_mfma_f32_16x16x32_bf16 a[16:19], v[104:107], a[160:163], a[16:19]
  v_mfma_f32_16x16x32_bf16 a[44:47], v[104:107], a[164:167], a[44:47]
  buffer_load_dwordx4 v[76:79], v3, s[4:7], s44 offen offset:2048 sc1
  v_mfma_f32_16x16x32_bf16 a[72:75], v[104:107], a[168:171], a[72:75]
  v_mfma_f32_16x16x32_bf16 a[100:103], v[104:107], a[172:175], a[100:103]
  v_mfma_f32_16x16x32_bf16 a[20:23], v[108:111], a[160:163], a[20:23]
  v_mfma_f32_16x16x32_bf16 a[48:51], v[108:111], a[164:167], a[48:51]
  buffer_load_dwordx4 v[80:83], v3, s[4:7], s45 offen offset:2048 sc1
  v_mfma_f32_16x16x32_bf16 a[76:79], v[108:111], a[168:171], a[76:79]
  v_mfma_f32_16x16x32_bf16 a[104:107], v[108:111], a[172:175], a[104:107]
  v_mfma_f32_16x16x32_bf16 a[24:27], v[112:115], a[160:163], a[24:27]
  v_mfma_f32_16x16x32_bf16 a[52:55], v[112:115], a[164:167], a[52:55]
  buffer_load_dwordx4 v[84:87], v3, s[4:7], s46 offen offset:2048 sc1
  v_mfma_f32_16x16x32_bf16 a[80:83], v[112:115], a[168:171], a[80:83]
  v_mfma_f32_16x16x32_bf16 a[108:111], v[112:115], a[172:175], a[108:111]
  s_waitcnt vmcnt(21) lgkmcnt(0)
  v_mfma_f32_16x16x32_bf16 a[0:3], v[116:119], a[176:179], a[0:3]
  v_mfma_f32_16x16x32_bf16 a[28:31], v[116:119], a[180:183], a[28:31]
  buffer_load_dwordx4 v[88:91], v3, s[4:7], 0 offen offset:3072 sc1
  v_mfma_f32_16x16x32_bf16 a[56:59], v[116:119], a[184:187], a[56:59]
  v_mfma_f32_16x16x32_bf16 a[84:87], v[116:119], a[188:191], a[84:87]
  v_mfma_f32_16x16x32_bf16 a[4:7], v[120:123], a[176:179], a[4:7]
  v_mfma_f32_16x16x32_bf16 a[32:35], v[120:123], a[180:183], a[32:35]
  buffer_load_dwordx4 v[92:95], v3, s[4:7], s41 offen offset:3072 sc1
  v_mfma_f32_16x16x32_bf16 a[60:63], v[120:123], a[184:187], a[60:63]
  v_mfma_f32_16x16x32_bf16 a[88:91], v[120:123], a[188:191], a[88:91]
  v_mfma_f32_16x16x32_bf16 a[8:11], v[124:127], a[176:179], a[8:11]
  v_mfma_f32_16x16x32_bf16 a[36:39], v[124:127], a[180:183], a[36:39]
  buffer_load_dwordx4 v[96:99], v3, s[4:7], s42 offen offset:3072 sc1
  v_mfma_f32_16x16x32_bf16 a[64:67], v[124:127], a[184:187], a[64:67]
  v_mfma_f32_16x16x32_bf16 a[92:95], v[124:127], a[188:191], a[92:95]
  v_mfma_f32_16x16x32_bf16 a[12:15], v[128:131], a[176:179], a[12:15]
  v_mfma_f32_16x16x32_bf16 a[40:43], v[128:131], a[180:183], a[40:43]
  buffer_load_dwordx4 v[100:103], v3, s[4:7], s43 offen offset:3072 sc1
  v_mfma_f32_16x16x32_bf16 a[68:71], v[128:131], a[184:187], a[68:71]
  v_mfma_f32_16x16x32_bf16 a[96:99], v[128:131], a[188:191], a[96:99]
  v_mfma_f32_16x16x32_bf16 a[16:19], v[132:135], a[176:179], a[16:19]
  v_mfma_f32_16x16x32_bf16 a[44:47], v[132:135], a[180:183], a[44:47]
  buffer_load_dwordx4 v[104:107], v3, s[4:7], s44 offen offset:3072 sc1
  v_mfma_f32_16x16x32_bf16 a[72:75], v[132:135], a[184:187], a[72:75]
  v_mfma_f32_16x16x32_bf16 a[100:103], v[132:135], a[188:191], a[100:103]
  v_mfma_f32_16x16x32_bf16 a[20:23], v[136:139], a[176:179], a[20:23]
  v_mfma_f32_16x16x32_bf16 a[48:51], v[136:139], a[180:183], a[48:51]
  buffer_load_dwordx4 v[108:111], v3, s[4:7], s45 offen offset:3072 sc1
  v_mfma_f32_16x16x32_bf16 a[76:79], v[136:139], a[184:187], a[76:79]
  v_mfma_f32_16x16x32_bf16 a[104:107], v[136:139], a[188:191], a[104:107]
  v_mfma_f32_16x16x32_bf16 a[24:27], v[140:143], a[176:179], a[24:27]
  v_mfma_f32_16x16x32_bf16 a[52:55], v[140:143], a[180:183], a[52:55]
  buffer_load_dwordx4 v[112:115], v3, s[4:7], s46 offen offset:3072 sc1
  v_mfma_f32_16x16x32_bf16 a[80:83], v[140:143], a[184:187], a[80:83]
  v_mfma_f32_16x16x32_bf16 a[108:111], v[140:143], a[188:191], a[108:111]
  s_waitcnt vmcnt(21) lgkmcnt(0)
  v_mfma_f32_16x16x32_bf16 a[0:3], v[144:147], a[192:195], a[0:3]
  v_mfma_f32_16x16x32_bf16 a[28:31], v[144:147], a[196:199], a[28:31]
  v_mfma_f32_16x16x32_bf16 a[56:59], v[144:147], a[200:203], a[56:59]
  v_mfma_f32_16x16x32_bf16 a[84:87], v[144:147], a[204:207], a[84:87]
  v_add_u32 v3, 4096, v3
  buffer_load_dwordx4 v[116:119], v3, s[4:7], 0 offen offset:0 sc1
  v_mfma_f32_16x16x32_bf16 a[4:7], v[148:151], a[192:195], a[4:7]
  v_mfma_f32_16x16x32_bf16 a[32:35], v[148:151], a[196:199], a[32:35]
  v_mfma_f32_16x16x32_bf16 a[60:63], v[148:151], a[200:203], a[60:63]
  v_mfma_f32_16x16x32_bf16 a[88:91], v[148:151], a[204:207], a[88:91]
  v_mfma_f32_16x16x32_bf16 a[8:11], v[152:155], a[192:195], a[8:11]
  buffer_load_dwordx4 v[120:123], v3, s[4:7], s41 offen offset:0 sc1
  v_mfma_f32_16x16x32_bf16 a[36:39], v[152:155], a[196:199], a[36:39]
  v_mfma_f32_16x16x32_bf16 a[64:67], v[152:155], a[200:203], a[64:67]
  v_mfma_f32_16x16x32_bf16 a[92:95], v[152:155], a[204:207], a[92:95]
  v_mfma_f32_16x16x32_bf16 a[12:15], v[156:159], a[192:195], a[12:15]
  buffer_load_dwordx4 v[124:127], v3, s[4:7], s42 offen offset:0 sc1
  v_mfma_f32_16x16x32_bf16 a[40:43], v[156:159], a[196:199], a[40:43]
  v_mfma_f32_16x16x32_bf16 a[68:71], v[156:159], a[200:203], a[68:71]
  v_mfma_f32_16x16x32_bf16 a[96:99], v[156:159], a[204:207], a[96:99]
  buffer_load_dwordx4 v[128:131], v3, s[4:7], s43 offen offset:0 sc1
  v_mfma_f32_16x16x32_bf16 a[16:19], v[160:163], a[192:195], a[16:19]
  v_mfma_f32_16x16x32_bf16 a[44:47], v[160:163], a[196:199], a[44:47]
  v_mfma_f32_16x16x32_bf16 a[72:75], v[160:163], a[200:203], a[72:75]
  v_mfma_f32_16x16x32_bf16 a[100:103], v[160:163], a[204:207], a[100:103]
  buffer_load_dwordx4 v[132:135], v3, s[4:7], s44 offen offset:0 sc1
  v_mfma_f32_16x16x32_bf16 a[20:23], v[164:167], a[192:195], a[20:23]
  v_mfma_f32_16x16x32_bf16 a[48:51], v[164:167], a[196:199], a[48:51]
  v_mfma_f32_16x16x32_bf16 a[76:79], v[164:167], a[200:203], a[76:79]
  buffer_load_dwordx4 v[136:139], v3, s[4:7], s45 offen offset:0 sc1
  v_mfma_f32_16x16x32_bf16 a[104:107], v[164:167], a[204:207], a[104:107]
  v_mfma_f32_16x16x32_bf16 a[24:27], v[168:171], a[192:195], a[24:27]
  v_mfma_f32_16x16x32_bf16 a[52:55], v[168:171], a[196:199], a[52:55]
  v_mfma_f32_16x16x32_bf16 a[80:83], v[168:171], a[200:203], a[80:83]
  buffer_load_dwordx4 v[140:143], v3, s[4:7], s46 offen offset:0 sc1
  v_mfma_f32_16x16x32_bf16 a[108:111], v[168:171], a[204:207], a[108:111]
  s_waitcnt vmcnt(21) lgkmcnt(0)
  v_mfma_f32_16x16x32_bf16 a[0:3], v[32:35], a[208:211], a[0:3]
  v_mfma_f32_16x16x32_bf16 a[28:31], v[32:35], a[212:215], a[28:31]
  ds_read_b128 v[172:175], v24 offset:0
  v_mfma_f32_16x16x32_bf16 a[56:59], v[32:35], a[216:219], a[56:59]
  v_mfma_f32_16x16x32_bf16 a[84:87], v[32:35], a[220:223], a[84:87]
  ds_read_b128 v[176:179], v24 offset:2048
  v_mfma_f32_16x16x32_bf16 a[4:7], v[36:39], a[208:211], a[4:7]
  v_mfma_f32_16x16x32_bf16 a[32:35], v[36:39], a[212:215], a[32:35]
  v_mfma_f32_16x16x32_bf16 a[60:63], v[36:39], a[216:219], a[60:63]
  ds_read_b128 v[180:183], v24 offset:4096
  v_mfma_f32_16x16x32_bf16 a[88:91], v[36:39], a[220:223], a[88:91]
  v_mfma_f32_16x16x32_bf16 a[8:11], v[40:43], a[208:211], a[8:11]
  ds_read_b128 v[184:187], v24 offset:6144
  v_mfma_f32_16x16x32_bf16 a[36:39], v[40:43], a[212:215], a[36:39]
  v_mfma_f32_16x16x32_bf16 a[64:67], v[40:43], a[216:219], a[64:67]
  v_mfma_f32_16x16x32_bf16 a[92:95], v[40:43], a[220:223], a[92:95]
  buffer_load_dwordx4 v[144:147], v3, s[4:7], 0 offen offset:1024 sc1
  v_mfma_f32_16x16x32_bf16 a[12:15], v[44:47], a[208:211], a[12:15]
  v_mfma_f32_16x16x32_bf16 a[40:43], v[44:47], a[212:215], a[40:43]
  buffer_load_dwordx4 v[148:151], v3, s[4:7], s41 offen offset:1024 sc1
  v_mfma_f32_16x16x32_bf16 a[68:71], v[44:47], a[216:219], a[68:71]
  v_mfma_f32_16x16x32_bf16 a[96:99], v[44:47], a[220:223], a[96:99]
  v_mfma_f32_16x16x32_bf16 a[16:19], v[48:51], a[208:211], a[16:19]
  buffer_load_dwordx4 v[152:155], v3, s[4:7], s42 offen offset:1024 sc1
  v_mfma_f32_16x16x32_bf16 a[44:47], v[48:51], a[212:215], a[44:47]
  v_mfma_f32_16x16x32_bf16 a[72:75], v[48:51], a[216:219], a[72:75]
  v_mfma_f32_16x16x32_bf16 a[100:103], v[48:51], a[220:223], a[100:103]
  buffer_load_dwordx4 v[156:159], v3, s[4:7], s43 offen offset:1024 sc1
  v_mfma_f32_16x16x32_bf16 a[20:23], v[52:55], a[208:211], a[20:23]
  v_mfma_f32_16x16x32_bf16 a[48:51], v[52:55], a[212:215], a[48:51]
  buffer_load_dwordx4 v[160:163], v3, s[4:7], s44 offen offset:1024 sc1
  v_mfma_f32_16x16x32_bf16 a[76:79], v[52:55], a[216:219], a[76:79]
  v_mfma_f32_16x16x32_bf16 a[104:107], v[52:55], a[220:223], a[104:107]
  v_mfma_f32_16x16x32_bf16 a[24:27], v[56:59], a[208:211], a[24:27]
  buffer_load_dwordx4 v[164:167], v3, s[4:7], s45 offen offset:1024 sc1
  v_mfma_f32_16x16x32_bf16 a[52:55], v[56:59], a[212:215], a[52:55]
  v_mfma_f32_16x16x32_bf16 a[80:83], v[56:59], a[216:219], a[80:83]
  buffer_load_dwordx4 v[168:171], v3, s[4:7], s46 offen offset:1024 sc1
  v_mfma_f32_16x16x32_bf16 a[108:111], v[56:59], a[220:223], a[108:111]
  s_waitcnt vmcnt(21) lgkmcnt(0)
  v_mfma_f32_16x16x32_bf16 a[0:3], v[60:63], v[172:175], a[0:3]
  v_mfma_f32_16x16x32_bf16 a[28:31], v[60:63], v[176:179], a[28:31]
  ds_read_b128 v[188:191], v25 offset:0
  v_mfma_f32_16x16x32_bf16 a[56:59], v[60:63], v[180:183], a[56:59]
  v_mfma_f32_16x16x32_bf16 a[84:87], v[60:63], v[184:187], a[84:87]
  ds_read_b128 v[192:195], v25 offset:2048
  v_mfma_f32_16x16x32_bf16 a[4:7], v[64:67], v[172:175], a[4:7]
  v_mfma_f32_16x16x32_bf16 a[32:35], v[64:67], v[176:179], a[32:35]
  v_mfma_f32_16x16x32_bf16 a[60:63], v[64:67], v[180:183], a[60:63]
  ds_read_b128 v[196:199], v25 offset:4096
  v_mfma_f32_16x16x32_bf16 a[88:91], v[64:67], v[184:187], a[88:91]
  v_mfma_f32_16x16x32_bf16 a[8:11], v[68:71], v[172:175], a[8:11]
  ds_read_b128 v[200:203], v25 offset:6144
  v_mfma_f32_16x16x32_bf16 a[36:39], v[68:71], v[176:179], a[36:39]
  v_mfma_f32_16x16x32_bf16 a[64:67], v[68:71], v[180:183], a[64:67]
  v_mfma_f32_16x16x32_bf16 a[92:95], v[68:71], v[184:187], a[92:95]
  buffer_load_dwordx4 v[32:35], v3, s[4:7], 0 offen offset:2048 sc1
  v_mfma_f32_16x16x32_bf16 a[12:15], v[72:75], v[172:175], a[12:15]
  v_mfma_f32_16x16x32_bf16 a[40:43], v[72:75], v[176:179], a[40:43]
  buffer_load_dwordx4 v[36:39], v3, s[4:7], s41 offen offset:2048 sc1
  v_mfma_f32_16x16x32_bf16 a[68:71], v[72:75], v[180:183], a[68:71]
  v_mfma_f32_16x16x32_bf16 a[96:99], v[72:75], v[184:187], a[96:99]
  v_mfma_f32_16x16x32_bf16 a[16:19], v[76:79], v[172:175], a[16:19]
  buffer_load_dwordx4 v[40:43], v3, s[4:7], s42 offen offset:2048 sc1
  v_mfma_f32_16x16x32_bf16 a[44:47], v[76:79], v[176:179], a[44:47]
  v_mfma_f32_16x16x32_bf16 a[72:75], v[76:79], v[180:183], a[72:75]
  v_mfma_f32_16x16x32_bf16 a[100:103], v[76:79], v[184:187], a[100:103]
  buffer_load_dwordx4 v[44:47], v3, s[4:7], s43 offen offset:2048 sc1
  v_mfma_f32_16x16x32_bf16 a[20:23], v[80:83], v[172:175], a[20:23]
  v_mfma_f32_16x16x32_bf16 a[48:51], v[80:83], v[176:179], a[48:51]
  buffer_load_dwordx4 v[48:51], v3, s[4:7], s44 offen offset:2048 sc1
  v_mfma_f32_16x16x32_bf16 a[76:79], v[80:83], v[180:183], a[76:79]
  v_mfma_f32_16x16x32_bf16 a[104:107], v[80:83], v[184:187], a[104:107]
  v_mfma_f32_16x16x32_bf16 a[24:27], v[84:87], v[172:175], a[24:27]
  buffer_load_dwordx4 v[52:55], v3, s[4:7], s45 offen offset:2048 sc1
  v_mfma_f32_16x16x32_bf16 a[52:55], v[84:87], v[176:179], a[52:55]
  v_mfma_f32_16x16x32_bf16 a[80:83], v[84:87], v[180:183], a[80:83]
  buffer_load_dwordx4 v[56:59], v3, s[4:7], s46 offen offset:2048 sc1
  v_mfma_f32_16x16x32_bf16 a[108:111], v[84:87], v[184:187], a[108:111]
  s_waitcnt vmcnt(21) lgkmcnt(0)
  v_mfma_f32_16x16x32_bf16 a[0:3], v[88:91], v[188:191], a[0:3]
  v_mfma_f32_16x16x32_bf16 a[28:31], v[88:91], v[192:195], a[28:31]
  ds_read_b128 v[172:175], v24 offset:8192
  v_mfma_f32_16x16x32_bf16 a[56:59], v[88:91], v[196:199], a[56:59]
  v_mfma_f32_16x16x32_bf16 a[84:87], v[88:91], v[200:203], a[84:87]
  ds_read_b128 v[176:179], v24 offset:10240
  v_mfma_f32_16x16x32_bf16 a[4:7], v[92:95], v[188:191], a[4:7]
  v_mfma_f32_16x16x32_bf16 a[32:35], v[92:95], v[192:195], a[32:35]
  v_mfma_f32_16x16x32_bf16 a[60:63], v[92:95], v[196:199], a[60:63]
  ds_read_b128 v[180:183], v24 offset:12288
  v_mfma_f32_16x16x32_bf16 a[88:91], v[92:95], v[200:203], a[88:91]
  v_mfma_f32_16x16x32_bf16 a[8:11], v[96:99], v[188:191], a[8:11]
  ds_read_b128 v[184:187], v24 offset:14336
  v_mfma_f32_16x16x32_bf16 a[36:39], v[96:99], v[192:195], a[36:39]
  v_mfma_f32_16x16x32_bf16 a[64:67], v[96:99], v[196:199], a[64:67]
  v_mfma_f32_16x16x32_bf16 a[92:95], v[96:99], v[200:203], a[92:95]
  buffer_load_dwordx4 v[60:63], v3, s[4:7], 0 offen offset:3072 sc1
  v_mfma_f32_16x16x32_bf16 a[12:15], v[100:103], v[188:191], a[12:15]
  v_mfma_f32_16x16x32_bf16 a[40:43], v[100:103], v[192:195], a[40:43]
  buffer_load_dwordx4 v[64:67], v3, s[4:7], s41 offen offset:3072 sc1
  v_mfma_f32_16x16x32_bf16 a[68:71], v[100:103], v[196:199], a[68:71]
  v_mfma_f32_16x16x32_bf16 a[96:99], v[100:103], v[200:203], a[96:99]
  v_mfma_f32_16x16x32_bf16 a[16:19], v[104:107], v[188:191], a[16:19]
  buffer_load_dwordx4 v[68:71], v3, s[4:7], s42 offen offset:3072 sc1
  v_mfma_f32_16x16x32_bf16 a[44:47], v[104:107], v[192:195], a[44:47]
  v_mfma_f32_16x16x32_bf16 a[72:75], v[104:107], v[196:199], a[72:75]
  v_mfma_f32_16x16x32_bf16 a[100:103], v[104:107], v[200:203], a[100:103]
  buffer_load_dwordx4 v[72:75], v3, s[4:7], s43 offen offset:3072 sc1
  v_mfma_f32_16x16x32_bf16 a[20:23], v[108:111], v[188:191], a[20:23]
  v_mfma_f32_16x16x32_bf16 a[48:51], v[108:111], v[192:195], a[48:51]
  buffer_load_dwordx4 v[76:79], v3, s[4:7], s44 offen offset:3072 sc1
  v_mfma_f32_16x16x32_bf16 a[76:79], v[108:111], v[196:199], a[76:79]
  v_mfma_f32_16x16x32_bf16 a[104:107], v[108:111], v[200:203], a[104:107]
  v_mfma_f32_16x16x32_bf16 a[24:27], v[112:115], v[188:191], a[24:27]
  buffer_load_dwordx4 v[80:83], v3, s[4:7], s45 offen offset:3072 sc1
  v_mfma_f32_16x16x32_bf16 a[52:55], v[112:115], v[192:195], a[52:55]
  v_mfma_f32_16x16x32_bf16 a[80:83], v[112:115], v[196:199], a[80:83]
  buffer_load_dwordx4 v[84:87], v3, s[4:7], s46 offen offset:3072 sc1
  v_mfma_f32_16x16x32_bf16 a[108:111], v[112:115], v[200:203], a[108:111]
  s_waitcnt vmcnt(21) lgkmcnt(0)
  v_mfma_f32_16x16x32_bf16 a[0:3], v[116:119], v[172:175], a[0:3]
  v_mfma_f32_16x16x32_bf16 a[28:31], v[116:119], v[176:179], a[28:31]
  ds_read_b128 v[188:191], v25 offset:8192
  v_mfma_f32_16x16x32_bf16 a[56:59], v[116:119], v[180:183], a[56:59]
  v_mfma_f32_16x16x32_bf16 a[84:87], v[116:119], v[184:187], a[84:87]
  ds_read_b128 v[192:195], v25 offset:10240
  v_mfma_f32_16x16x32_bf16 a[4:7], v[120:123], v[172:175], a[4:7]
  v_mfma_f32_16x16x32_bf16 a[32:35], v[120:123], v[176:179], a[32:35]
  ds_read_b128 v[196:199], v25 offset:12288
  v_mfma_f32_16x16x32_bf16 a[60:63], v[120:123], v[180:183], a[60:63]
  v_mfma_f32_16x16x32_bf16 a[88:91], v[120:123], v[184:187], a[88:91]
  v_mfma_f32_16x16x32_bf16 a[8:11], v[124:127], v[172:175], a[8:11]
  ds_read_b128 v[200:203], v25 offset:14336
  v_mfma_f32_16x16x32_bf16 a[36:39], v[124:127], v[176:179], a[36:39]
  v_mfma_f32_16x16x32_bf16 a[64:67], v[124:127], v[180:183], a[64:67]
  v_mfma_f32_16x16x32_bf16 a[92:95], v[124:127], v[184:187], a[92:95]
  v_add_u32 v3, 4096, v3
  buffer_load_dwordx4 v[88:91], v3, s[4:7], 0 offen offset:0 sc1
  v_mfma_f32_16x16x32_bf16 a[12:15], v[128:131], v[172:175], a[12:15]
  v_mfma_f32_16x16x32_bf16 a[40:43], v[128:131], v[176:179], a[40:43]
  v_mfma_f32_16x16x32_bf16 a[68:71], v[128:131], v[180:183], a[68:71]
  v_mfma_f32_16x16x32_bf16 a[96:99], v[128:131], v[184:187], a[96:99]
  buffer_load_dwordx4 v[92:95], v3, s[4:7], s41 offen offset:0 sc1
  v_mfma_f32_16x16x32_bf16 a[16:19], v[132:135], v[172:175], a[16:19]
  v_mfma_f32_16x16x32_bf16 a[44:47], v[132:135], v[176:179], a[44:47]
  buffer_load_dwordx4 v[96:99], v3, s[4:7], s42 offen offset:0 sc1
  v_mfma_f32_16x16x32_bf16 a[72:75], v[132:135], v[180:183], a[72:75]
  v_mfma_f32_16x16x32_bf16 a[100:103], v[132:135], v[184:187], a[100:103]
  buffer_load_dwordx4 v[100:103], v3, s[4:7], s43 offen offset:0 sc1
  v_mfma_f32_16x16x32_bf16 a[20:23], v[136:139], v[172:175], a[20:23]
  v_mfma_f32_16x16x32_bf16 a[48:51], v[136:139], v[176:179], a[48:51]
  v_mfma_f32_16x16x32_bf16 a[76:79], v[136:139], v[180:183], a[76:79]
  buffer_load_dwordx4 v[104:107], v3, s[4:7], s44 offen offset:0 sc1
  v_mfma_f32_16x16x32_bf16 a[104:107], v[136:139], v[184:187], a[104:107]
  v_mfma_f32_16x16x32_bf16 a[24:27], v[140:143], v[172:175], a[24:27]
  buffer_load_dwordx4 v[108:111], v3, s[4:7], s45 offen offset:0 sc1
  v_mfma_f32_16x16x32_bf16 a[52:55], v[140:143], v[176:179], a[52:55]
  v_mfma_f32_16x16x32_bf16 a[80:83], v[140:143], v[180:183], a[80:83]
  buffer_load_dwordx4 v[112:115], v3, s[4:7], s46 offen offset:0 sc1
  v_mfma_f32_16x16x32_bf16 a[108:111], v[140:143], v[184:187], a[108:111]
  s_waitcnt vmcnt(21) lgkmcnt(0)
  v_mfma_f32_16x16x32_bf16 a[0:3], v[144:147], v[188:191], a[0:3]
  v_mfma_f32_16x16x32_bf16 a[28:31], v[144:147], v[192:195], a[28:31]
  ds_read_b128 v[172:175], v28 offset:8192
  v_mfma_f32_16x16x32_bf16 a[56:59], v[144:147], v[196:199], a[56:59]
  v_mfma_f32_16x16x32_bf16 a[84:87], v[144:147], v[200:203], a[84:87]
  ds_read_b128 v[176:179], v28 offset:10240
  v_mfma_f32_16x16x32_bf16 a[4:7], v[148:151], v[188:191], a[4:7]
  v_mfma_f32_16x16x32_bf16 a[32:35], v[148:151], v[192:195], a[32:35]
  v_mfma_f32_16x16x32_bf16 a[60:63], v[148:151], v[196:199], a[60:63]
  ds_read_b128 v[180:183], v28 offset:12288
  v_mfma_f32_16x16x32_bf16 a[88:91], v[148:151], v[200:203], a[88:91]
  v_mfma_f32_16x16x32_bf16 a[8:11], v[152:155], v[188:191], a[8:11]
  ds_read_b128 v[184:187], v28 offset:14336
  v_mfma_f32_16x16x32_bf16 a[36:39], v[152:155], v[192:195], a[36:39]
  v_mfma_f32_16x16x32_bf16 a[64:67], v[152:155], v[196:199], a[64:67]
  v_mfma_f32_16x16x32_bf16 a[92:95], v[152:155], v[200:203], a[92:95]
  buffer_load_dwordx4 v[116:119], v3, s[4:7], 0 offen offset:1024 sc1
  v_mfma_f32_16x16x32_bf16 a[12:15], v[156:159], v[188:191], a[12:15]
  v_mfma_f32_16x16x32_bf16 a[40:43], v[156:159], v[192:195], a[40:43]
  buffer_load_dwordx4 v[120:123], v3, s[4:7], s41 offen offset:1024 sc1
  v_mfma_f32_16x16x32_bf16 a[68:71], v[156:159], v[196:199], a[68:71]
  v_mfma_f32_16x16x32_bf16 a[96:99], v[156:159], v[200:203], a[96:99]
  v_mfma_f32_16x16x32_bf16 a[16:19], v[160:163], v[188:191], a[16:19]
  buffer_load_dwordx4 v[124:127], v3, s[4:7], s42 offen offset:1024 sc1
  v_mfma_f32_16x16x32_bf16 a[44:47], v[160:163], v[192:195], a[44:47]
  v_mfma_f32_16x16x32_bf16 a[72:75], v[160:163], v[196:199], a[72:75]
  v_mfma_f32_16x16x32_bf16 a[100:103], v[160:163], v[200:203], a[100:103]
  buffer_load_dwordx4 v[128:131], v3, s[4:7], s43 offen offset:1024 sc1
  v_mfma_f32_16x16x32_bf16 a[20:23], v[164:167], v[188:191], a[20:23]
  v_mfma_f32_16x16x32_bf16 a[48:51], v[164:167], v[192:195], a[48:51]
  buffer_load_dwordx4 v[132:135], v3, s[4:7], s44 offen offset:1024 sc1
  v_mfma_f32_16x16x32_bf16 a[76:79], v[164:167], v[196:199], a[76:79]
  v_mfma_f32_16x16x32_bf16 a[104:107], v[164:167], v[200:203], a[104:107]
  v_mfma_f32_16x16x32_bf16 a[24:27], v[168:171], v[188:191], a[24:27]
  buffer_load_dwordx4 v[136:139], v3, s[4:7], s45 offen offset:1024 sc1
  v_mfma_f32_16x16x32_bf16 a[52:55], v[168:171], v[192:195], a[52:55]
  v_mfma_f32_16x16x32_bf16 a[80:83], v[168:171], v[196:199], a[80:83]
  buffer_load_dwordx4 v[140:143], v3, s[4:7], s46 offen offset:1024 sc1
  v_mfma_f32_16x16x32_bf16 a[108:111], v[168:171], v[200:203], a[108:111]
  s_waitcnt vmcnt(21) lgkmcnt(0)
  v_mfma_f32_16x16x32_bf16 a[0:3], v[32:35], v[172:175], a[0:3]
  v_mfma_f32_16x16x32_bf16 a[28:31], v[32:35], v[176:179], a[28:31]
  ds_read_b128 v[188:191], v29 offset:8192
  v_mfma_f32_16x16x32_bf16 a[56:59], v[32:35], v[180:183], a[56:59]
  v_mfma_f32_16x16x32_bf16 a[84:87], v[32:35], v[184:187], a[84:87]
  ds_read_b128 v[192:195], v29 offset:10240
  v_mfma_f32_16x16x32_bf16 a[4:7], v[36:39], v[172:175], a[4:7]
  v_mfma_f32_16x16x32_bf16 a[32:35], v[36:39], v[176:179], a[32:35]
  v_mfma_f32_16x16x32_bf16 a[60:63], v[36:39], v[180:183], a[60:63]
  ds_read_b128 v[196:199], v29 offset:12288
  v_mfma_f32_16x16x32_bf16 a[88:91], v[36:39], v[184:187], a[88:91]
  v_mfma_f32_16x16x32_bf16 a[8:11], v[40:43], v[172:175], a[8:11]
  ds_read_b128 v[200:203], v29 offset:14336
  v_mfma_f32_16x16x32_bf16 a[36:39], v[40:43], v[176:179], a[36:39]
  v_mfma_f32_16x16x32_bf16 a[64:67], v[40:43], v[180:183], a[64:67]
  v_mfma_f32_16x16x32_bf16 a[92:95], v[40:43], v[184:187], a[92:95]
  buffer_load_dwordx4 v[144:147], v3, s[4:7], 0 offen offset:2048 sc1
  v_mfma_f32_16x16x32_bf16 a[12:15], v[44:47], v[172:175], a[12:15]
  v_mfma_f32_16x16x32_bf16 a[40:43], v[44:47], v[176:179], a[40:43]
  buffer_load_dwordx4 v[148:151], v3, s[4:7], s41 offen offset:2048 sc1
  v_mfma_f32_16x16x32_bf16 a[68:71], v[44:47], v[180:183], a[68:71]
  v_mfma_f32_16x16x32_bf16 a[96:99], v[44:47], v[184:187], a[96:99]
  v_mfma_f32_16x16x32_bf16 a[16:19], v[48:51], v[172:175], a[16:19]
  buffer_load_dwordx4 v[152:155], v3, s[4:7], s42 offen offset:2048 sc1
  v_mfma_f32_16x16x32_bf16 a[44:47], v[48:51], v[176:179], a[44:47]
  v_mfma_f32_16x16x32_bf16 a[72:75], v[48:51], v[180:183], a[72:75]
  v_mfma_f32_16x16x32_bf16 a[100:103], v[48:51], v[184:187], a[100:103]
  buffer_load_dwordx4 v[156:159], v3, s[4:7], s43 offen offset:2048 sc1
  v_mfma_f32_16x16x32_bf16 a[20:23], v[52:55], v[172:175], a[20:23]
  v_mfma_f32_16x16x32_bf16 a[48:51], v[52:55], v[176:179], a[48:51]
  buffer_load_dwordx4 v[160:163], v3, s[4:7], s44 offen offset:2048 sc1
  v_mfma_f32_16x16x32_bf16 a[76:79], v[52:55], v[180:183], a[76:79]
  v_mfma_f32_16x16x32_bf16 a[104:107], v[52:55], v[184:187], a[104:107]
  v_mfma_f32_16x16x32_bf16 a[24:27], v[56:59], v[172:175], a[24:27]
  buffer_load_dwordx4 v[164:167], v3, s[4:7], s45 offen offset:2048 sc1
  v_mfma_f32_16x16x32_bf16 a[52:55], v[56:59], v[176:179], a[52:55]
  v_mfma_f32_16x16x32_bf16 a[80:83], v[56:59], v[180:183], a[80:83]
  buffer_load_dwordx4 v[168:171], v3, s[4:7], s46 offen offset:2048 sc1
  v_mfma_f32_16x16x32_bf16 a[108:111], v[56:59], v[184:187], a[108:111]
  s_waitcnt vmcnt(21) lgkmcnt(0)
  v_mfma_f32_16x16x32_bf16 a[0:3], v[60:63], v[188:191], a[0:3]
  v_mfma_f32_16x16x32_bf16 a[28:31], v[60:63], v[192:195], a[28:31]
  ds_read_b128 v[172:175], v28 offset:0
  v_mfma_f32_16x16x32_bf16 a[56:59], v[60:63], v[196:199], a[56:59]
  v_mfma_f32_16x16x32_bf16 a[84:87], v[60:63], v[200:203], a[84:87]
  ds_read_b128 v[176:179], v28 offset:2048
  v_mfma_f32_16x16x32_bf16 a[4:7], v[64:67], v[188:191], a[4:7]
  v_mfma_f32_16x16x32_bf16 a[32:35], v[64:67], v[192:195], a[32:35]
  v_mfma_f32_16x16x32_bf16 a[60:63], v[64:67], v[196:199], a[60:63]
  ds_read_b128 v[180:183], v28 offset:4096
  v_mfma_f32_16x16x32_bf16 a[88:91], v[64:67], v[200:203], a[88:91]
  v_mfma_f32_16x16x32_bf16 a[8:11], v[68:71], v[188:191], a[8:11]
  ds_read_b128 v[184:187], v28 offset:6144
  v_mfma_f32_16x16x32_bf16 a[36:39], v[68:71], v[192:195], a[36:39]
  v_mfma_f32_16x16x32_bf16 a[64:67], v[68:71], v[196:199], a[64:67]
  v_mfma_f32_16x16x32_bf16 a[92:95], v[68:71], v[200:203], a[92:95]
  buffer_load_dwordx4 v[32:35], v3, s[4:7], 0 offen offset:3072 sc1
  v_mfma_f32_16x16x32_bf16 a[12:15], v[72:75], v[188:191], a[12:15]
  v_mfma_f32_16x16x32_bf16 a[40:43], v[72:75], v[192:195], a[40:43]
  buffer_load_dwordx4 v[36:39], v3, s[4:7], s41 offen offset:3072 sc1
  v_mfma_f32_16x16x32_bf16 a[68:71], v[72:75], v[196:199], a[68:71]
  v_mfma_f32_16x16x32_bf16 a[96:99], v[72:75], v[200:203], a[96:99]
  v_mfma_f32_16x16x32_bf16 a[16:19], v[76:79], v[188:191], a[16:19]
  buffer_load_dwordx4 v[40:43], v3, s[4:7], s42 offen offset:3072 sc1
  v_mfma_f32_16x16x32_bf16 a[44:47], v[76:79], v[192:195], a[44:47]
  v_mfma_f32_16x16x32_bf16 a[72:75], v[76:79], v[196:199], a[72:75]
  v_mfma_f32_16x16x32_bf16 a[100:103], v[76:79], v[200:203], a[100:103]
  buffer_load_dwordx4 v[44:47], v3, s[4:7], s43 offen offset:3072 sc1
  v_mfma_f32_16x16x32_bf16 a[20:23], v[80:83], v[188:191], a[20:23]
  v_mfma_f32_16x16x32_bf16 a[48:51], v[80:83], v[192:195], a[48:51]
  buffer_load_dwordx4 v[48:51], v3, s[4:7], s44 offen offset:3072 sc1
  v_mfma_f32_16x16x32_bf16 a[76:79], v[80:83], v[196:199], a[76:79]
  v_mfma_f32_16x16x32_bf16 a[104:107], v[80:83], v[200:203], a[104:107]
  v_mfma_f32_16x16x32_bf16 a[24:27], v[84:87], v[188:191], a[24:27]
  buffer_load_dwordx4 v[52:55], v3, s[4:7], s45 offen offset:3072 sc1
  v_mfma_f32_16x16x32_bf16 a[52:55], v[84:87], v[192:195], a[52:55]
  v_mfma_f32_16x16x32_bf16 a[80:83], v[84:87], v[196:199], a[80:83]
  buffer_load_dwordx4 v[56:59], v3, s[4:7], s46 offen offset:3072 sc1
  v_mfma_f32_16x16x32_bf16 a[108:111], v[84:87], v[200:203], a[108:111]
  s_waitcnt vmcnt(21) lgkmcnt(0)
  v_mfma_f32_16x16x32_bf16 a[0:3], v[88:91], v[172:175], a[0:3]
  v_mfma_f32_16x16x32_bf16 a[28:31], v[88:91], v[176:179], a[28:31]
  ds_read_b128 v[188:191], v29 offset:0
  v_mfma_f32_16x16x32_bf16 a[56:59], v[88:91], v[180:183], a[56:59]
  v_mfma_f32_16x16x32_bf16 a[84:87], v[88:91], v[184:187], a[84:87]
  ds_read_b128 v[192:195], v29 offset:2048
  v_mfma_f32_16x16x32_bf16 a[4:7], v[92:95], v[172:175], a[4:7]
  v_mfma_f32_16x16x32_bf16 a[32:35], v[92:95], v[176:179], a[32:35]
  ds_read_b128 v[196:199], v29 offset:4096
  v_mfma_f32_16x16x32_bf16 a[60:63], v[92:95], v[180:183], a[60:63]
  v_mfma_f32_16x16x32_bf16 a[88:91], v[92:95], v[184:187], a[88:91]
  v_mfma_f32_16x16x32_bf16 a[8:11], v[96:99], v[172:175], a[8:11]
  ds_read_b128 v[200:203], v29 offset:6144
  v_mfma_f32_16x16x32_bf16 a[36:39], v[96:99], v[176:179], a[36:39]
  v_mfma_f32_16x16x32_bf16 a[64:67], v[96:99], v[180:183], a[64:67]
  buffer_load_dwordx2 v[240:241], v7, s[12:15], 0 offen offset:0 sc1
  v_mfma_f32_16x16x32_bf16 a[92:95], v[96:99], v[184:187], a[92:95]
  v_mfma_f32_16x16x32_bf16 a[12:15], v[100:103], v[172:175], a[12:15]
  buffer_load_dwordx2 v[242:243], v7, s[12:15], 0 offen offset:512 sc1
  v_mfma_f32_16x16x32_bf16 a[40:43], v[100:103], v[176:179], a[40:43]
  v_mfma_f32_16x16x32_bf16 a[68:71], v[100:103], v[180:183], a[68:71]
  v_mfma_f32_16x16x32_bf16 a[96:99], v[100:103], v[184:187], a[96:99]
  buffer_load_dwordx2 v[244:245], v7, s[12:15], 0 offen offset:1024 sc1
  v_mfma_f32_16x16x32_bf16 a[16:19], v[104:107], v[172:175], a[16:19]
  v_mfma_f32_16x16x32_bf16 a[44:47], v[104:107], v[176:179], a[44:47]
  buffer_load_dwordx2 v[246:247], v7, s[12:15], 0 offen offset:1536 sc1
  v_mfma_f32_16x16x32_bf16 a[72:75], v[104:107], v[180:183], a[72:75]
  v_mfma_f32_16x16x32_bf16 a[100:103], v[104:107], v[184:187], a[100:103]
  buffer_load_dwordx2 v[248:249], v7, s[12:15], 0 offen offset:2048 sc1
  v_mfma_f32_16x16x32_bf16 a[20:23], v[108:111], v[172:175], a[20:23]
  v_mfma_f32_16x16x32_bf16 a[48:51], v[108:111], v[176:179], a[48:51]
  v_mfma_f32_16x16x32_bf16 a[76:79], v[108:111], v[180:183], a[76:79]
  buffer_load_dwordx2 v[250:251], v7, s[12:15], 0 offen offset:2560 sc1
  v_mfma_f32_16x16x32_bf16 a[104:107], v[108:111], v[184:187], a[104:107]
  v_mfma_f32_16x16x32_bf16 a[24:27], v[112:115], v[172:175], a[24:27]
  buffer_load_dwordx2 v[252:253], v7, s[12:15], 0 offen offset:3072 sc1
  v_mfma_f32_16x16x32_bf16 a[52:55], v[112:115], v[176:179], a[52:55]
  v_mfma_f32_16x16x32_bf16 a[80:83], v[112:115], v[180:183], a[80:83]
  buffer_load_ushort v254, v8, s[28:31], 0 offen
  v_mfma_f32_16x16x32_bf16 a[108:111], v[112:115], v[184:187], a[108:111]
  s_waitcnt vmcnt(22) lgkmcnt(0)
  v_mfma_f32_16x16x32_bf16 a[0:3], v[116:119], v[188:191], a[0:3]
  v_mfma_f32_16x16x32_bf16 a[28:31], v[116:119], v[192:195], a[28:31]
  v_mfma_f32_16x16x32_bf16 a[56:59], v[116:119], v[196:199], a[56:59]
  v_mfma_f32_16x16x32_bf16 a[84:87], v[116:119], v[200:203], a[84:87]
  ds_read_b128 v[172:175], v30 offset:0
  v_mfma_f32_16x16x32_bf16 a[4:7], v[120:123], v[188:191], a[4:7]
  v_mfma_f32_16x16x32_bf16 a[32:35], v[120:123], v[192:195], a[32:35]
  v_mfma_f32_16x16x32_bf16 a[60:63], v[120:123], v[196:199], a[60:63]
  v_mfma_f32_16x16x32_bf16 a[88:91], v[120:123], v[200:203], a[88:91]
  v_mfma_f32_16x16x32_bf16 a[8:11], v[124:127], v[188:191], a[8:11]
  v_mfma_f32_16x16x32_bf16 a[36:39], v[124:127], v[192:195], a[36:39]
  v_mfma_f32_16x16x32_bf16 a[64:67], v[124:127], v[196:199], a[64:67]
  ds_read_b128 v[176:179], v30 offset:2048
  v_mfma_f32_16x16x32_bf16 a[92:95], v[124:127], v[200:203], a[92:95]
  v_mfma_f32_16x16x32_bf16 a[12:15], v[128:131], v[188:191], a[12:15]
  v_mfma_f32_16x16x32_bf16 a[40:43], v[128:131], v[192:195], a[40:43]
  v_mfma_f32_16x16x32_bf16 a[68:71], v[128:131], v[196:199], a[68:71]
  v_mfma_f32_16x16x32_bf16 a[96:99], v[128:131], v[200:203], a[96:99]
  v_mfma_f32_16x16x32_bf16 a[16:19], v[132:135], v[188:191], a[16:19]
  v_mfma_f32_16x16x32_bf16 a[44:47], v[132:135], v[192:195], a[44:47]
  ds_read_b128 v[180:183], v30 offset:4096
  v_mfma_f32_16x16x32_bf16 a[72:75], v[132:135], v[196:199], a[72:75]
  v_mfma_f32_16x16x32_bf16 a[100:103], v[132:135], v[200:203], a[100:103]
  v_mfma_f32_16x16x32_bf16 a[20:23], v[136:139], v[188:191], a[20:23]
  v_mfma_f32_16x16x32_bf16 a[48:51], v[136:139], v[192:195], a[48:51]
  v_mfma_f32_16x16x32_bf16 a[76:79], v[136:139], v[196:199], a[76:79]
  v_mfma_f32_16x16x32_bf16 a[104:107], v[136:139], v[200:203], a[104:107]
  v_mfma_f32_16x16x32_bf16 a[24:27], v[140:143], v[188:191], a[24:27]
  ds_read_b128 v[184:187], v30 offset:6144
  v_mfma_f32_16x16x32_bf16 a[52:55], v[140:143], v[192:195], a[52:55]
  v_mfma_f32_16x16x32_bf16 a[80:83], v[140:143], v[196:199], a[80:83]
  v_mfma_f32_16x16x32_bf16 a[108:111], v[140:143], v[200:203], a[108:111]
  s_waitcnt vmcnt(15) lgkmcnt(0)
  v_mfma_f32_16x16x32_bf16 a[0:3], v[144:147], v[172:175], a[0:3]
  v_mfma_f32_16x16x32_bf16 a[28:31], v[144:147], v[176:179], a[28:31]
  v_mfma_f32_16x16x32_bf16 a[56:59], v[144:147], v[180:183], a[56:59]
  v_mfma_f32_16x16x32_bf16 a[84:87], v[144:147], v[184:187], a[84:87]
  ds_read_b128 v[188:191], v31 offset:0
  v_mfma_f32_16x16x32_bf16 a[4:7], v[148:151], v[172:175], a[4:7]
  v_mfma_f32_16x16x32_bf16 a[32:35], v[148:151], v[176:179], a[32:35]
  v_mfma_f32_16x16x32_bf16 a[60:63], v[148:151], v[180:183], a[60:63]
  v_mfma_f32_16x16x32_bf16 a[88:91], v[148:151], v[184:187], a[88:91]
  v_mfma_f32_16x16x32_bf16 a[8:11], v[152:155], v[172:175], a[8:11]
  v_mfma_f32_16x16x32_bf16 a[36:39], v[152:155], v[176:179], a[36:39]
  v_mfma_f32_16x16x32_bf16 a[64:67], v[152:155], v[180:183], a[64:67]
  ds_read_b128 v[192:195], v31 offset:2048
  v_mfma_f32_16x16x32_bf16 a[92:95], v[152:155], v[184:187], a[92:95]
  v_mfma_f32_16x16x32_bf16 a[12:15], v[156:159], v[172:175], a[12:15]
  v_mfma_f32_16x16x32_bf16 a[40:43], v[156:159], v[176:179], a[40:43]
  v_mfma_f32_16x16x32_bf16 a[68:71], v[156:159], v[180:183], a[68:71]
  v_mfma_f32_16x16x32_bf16 a[96:99], v[156:159], v[184:187], a[96:99]
  v_mfma_f32_16x16x32_bf16 a[16:19], v[160:163], v[172:175], a[16:19]
  v_mfma_f32_16x16x32_bf16 a[44:47], v[160:163], v[176:179], a[44:47]
  ds_read_b128 v[196:199], v31 offset:4096
  v_mfma_f32_16x16x32_bf16 a[72:75], v[160:163], v[180:183], a[72:75]
  v_mfma_f32_16x16x32_bf16 a[100:103], v[160:163], v[184:187], a[100:103]
  v_mfma_f32_16x16x32_bf16 a[20:23], v[164:167], v[172:175], a[20:23]
  v_mfma_f32_16x16x32_bf16 a[48:51], v[164:167], v[176:179], a[48:51]
  v_mfma_f32_16x16x32_bf16 a[76:79], v[164:167], v[180:183], a[76:79]
  v_mfma_f32_16x16x32_bf16 a[104:107], v[164:167], v[184:187], a[104:107]
  v_mfma_f32_16x16x32_bf16 a[24:27], v[168:171], v[172:175], a[24:27]
  ds_read_b128 v[200:203], v31 offset:6144
  v_mfma_f32_16x16x32_bf16 a[52:55], v[168:171], v[176:179], a[52:55]
  v_mfma_f32_16x16x32_bf16 a[80:83], v[168:171], v[180:183], a[80:83]
  v_mfma_f32_16x16x32_bf16 a[108:111], v[168:171], v[184:187], a[108:111]
  s_waitcnt vmcnt(8) lgkmcnt(0)
  v_mfma_f32_16x16x32_bf16 a[0:3], v[32:35], v[188:191], a[0:3]
  v_mfma_f32_16x16x32_bf16 a[28:31], v[32:35], v[192:195], a[28:31]
  v_mfma_f32_16x16x32_bf16 a[56:59], v[32:35], v[196:199], a[56:59]
  v_mfma_f32_16x16x32_bf16 a[84:87], v[32:35], v[200:203], a[84:87]
  v_mfma_f32_16x16x32_bf16 a[4:7], v[36:39], v[188:191], a[4:7]
  v_mfma_f32_16x16x32_bf16 a[32:35], v[36:39], v[192:195], a[32:35]
  v_mfma_f32_16x16x32_bf16 a[60:63], v[36:39], v[196:199], a[60:63]
  v_mfma_f32_16x16x32_bf16 a[88:91], v[36:39], v[200:203], a[88:91]
  v_mfma_f32_16x16x32_bf16 a[8:11], v[40:43], v[188:191], a[8:11]
  v_mfma_f32_16x16x32_bf16 a[36:39], v[40:43], v[192:195], a[36:39]
  v_mfma_f32_16x16x32_bf16 a[64:67], v[40:43], v[196:199], a[64:67]
  v_mfma_f32_16x16x32_bf16 a[92:95], v[40:43], v[200:203], a[92:95]
  v_mfma_f32_16x16x32_bf16 a[12:15], v[44:47], v[188:191], a[12:15]
  v_mfma_f32_16x16x32_bf16 a[40:43], v[44:47], v[192:195], a[40:43]
  v_mfma_f32_16x16x32_bf16 a[68:71], v[44:47], v[196:199], a[68:71]
  v_mfma_f32_16x16x32_bf16 a[96:99], v[44:47], v[200:203], a[96:99]
  v_mfma_f32_16x16x32_bf16 a[16:19], v[48:51], v[188:191], a[16:19]
  v_mfma_f32_16x16x32_bf16 a[44:47], v[48:51], v[192:195], a[44:47]
  v_mfma_f32_16x16x32_bf16 a[72:75], v[48:51], v[196:199], a[72:75]
  v_mfma_f32_16x16x32_bf16 a[100:103], v[48:51], v[200:203], a[100:103]
  v_mfma_f32_16x16x32_bf16 a[20:23], v[52:55], v[188:191], a[20:23]
  v_mfma_f32_16x16x32_bf16 a[48:51], v[52:55], v[192:195], a[48:51]
  v_mfma_f32_16x16x32_bf16 a[76:79], v[52:55], v[196:199], a[76:79]
  v_mfma_f32_16x16x32_bf16 a[104:107], v[52:55], v[200:203], a[104:107]
  v_mfma_f32_16x16x32_bf16 a[24:27], v[56:59], v[188:191], a[24:27]
  v_mfma_f32_16x16x32_bf16 a[52:55], v[56:59], v[192:195], a[52:55]
  v_mfma_f32_16x16x32_bf16 a[80:83], v[56:59], v[196:199], a[80:83]
  v_mfma_f32_16x16x32_bf16 a[108:111], v[56:59], v[200:203], a[108:111]
  v_add_u32 v10, s39, v9
  s_mul_i32 s36, s32, 7168
  v_add_u32 v11, s36, v9
  s_barrier
  s_nop 3
  s_mov_b32 s56, 0
  ds_write_b128 v10, a[0:3] offset:0
  buffer_load_dwordx4 a[112:115], v9, s[52:55], s56 offen offset:0 sc1
  ds_write_b128 v10, a[28:31] offset:7168
  buffer_load_dwordx4 a[116:119], v9, s[52:55], s56 offen offset:1024 sc1
  ds_write_b128 v10, a[56:59] offset:14336
  buffer_load_dwordx4 a[120:123], v9, s[52:55], s56 offen offset:2048 sc1
  ds_write_b128 v10, a[84:87] offset:21504
  buffer_load_dwordx4 a[124:127], v9, s[52:55], s56 offen offset:3072 sc1
  s_mov_b32 s56, 4096
  ds_write_b128 v10, a[4:7] offset:1024
  buffer_load_dwordx4 a[128:131], v9, s[52:55], s56 offen offset:0 sc1
  ds_write_b128 v10, a[32:35] offset:8192
  buffer_load_dwordx4 a[132:135], v9, s[52:55], s56 offen offset:1024 sc1
  ds_write_b128 v10, a[60:63] offset:15360
  buffer_load_dwordx4 a[136:139], v9, s[52:55], s56 offen offset:2048 sc1
  ds_write_b128 v10, a[88:91] offset:22528
  buffer_load_dwordx4 a[140:143], v9, s[52:55], s56 offen offset:3072 sc1
  s_mov_b32 s56, 8192
  ds_write_b128 v10, a[8:11] offset:2048
  buffer_load_dwordx4 a[144:147], v9, s[52:55], s56 offen offset:0 sc1
  ds_write_b128 v10, a[36:39] offset:9216
  buffer_load_dwordx4 a[148:151], v9, s[52:55], s56 offen offset:1024 sc1
  ds_write_b128 v10, a[64:67] offset:16384
  buffer_load_dwordx4 a[152:155], v9, s[52:55], s56 offen offset:2048 sc1
  ds_write_b128 v10, a[92:95] offset:23552
  buffer_load_dwordx4 a[156:159], v9, s[52:55], s56 offen offset:3072 sc1
  s_mov_b32 s56, 12288
  ds_write_b128 v10, a[12:15] offset:3072
  buffer_load_dwordx4 a[160:163], v9, s[52:55], s56 offen offset:0 sc1
  ds_write_b128 v10, a[40:43] offset:10240
  buffer_load_dwordx4 a[164:167], v9, s[52:55], s56 offen offset:1024 sc1
  ds_write_b128 v10, a[68:71] offset:17408
  buffer_load_dwordx4 a[168:171], v9, s[52:55], s56 offen offset:2048 sc1
  ds_write_b128 v10, a[96:99] offset:24576
  buffer_load_dwordx4 a[172:175], v9, s[52:55], s56 offen offset:3072 sc1
  s_mov_b32 s56, 16384
  ds_write_b128 v10, a[16:19] offset:4096
  buffer_load_dwordx4 a[176:179], v9, s[52:55], s56 offen offset:0 sc1
  ds_write_b128 v10, a[44:47] offset:11264
  buffer_load_dwordx4 a[180:183], v9, s[52:55], s56 offen offset:1024 sc1
  ds_write_b128 v10, a[72:75] offset:18432
  buffer_load_dwordx4 a[184:187], v9, s[52:55], s56 offen offset:2048 sc1
  ds_write_b128 v10, a[100:103] offset:25600
  buffer_load_dwordx4 a[188:191], v9, s[52:55], s56 offen offset:3072 sc1
  s_mov_b32 s56, 20480
  ds_write_b128 v10, a[20:23] offset:5120
  buffer_load_dwordx4 a[192:195], v9, s[52:55], s56 offen offset:0 sc1
  ds_write_b128 v10, a[48:51] offset:12288
  buffer_load_dwordx4 a[196:199], v9, s[52:55], s56 offen offset:1024 sc1
  ds_write_b128 v10, a[76:79] offset:19456
  buffer_load_dwordx4 a[200:203], v9, s[52:55], s56 offen offset:2048 sc1
  ds_write_b128 v10, a[104:107] offset:26624
  buffer_load_dwordx4 a[204:207], v9, s[52:55], s56 offen offset:3072 sc1
  s_mov_b32 s56, 24576
  ds_write_b128 v10, a[24:27] offset:6144
  buffer_load_dwordx4 a[208:211], v9, s[52:55], s56 offen offset:0 sc1
  ds_write_b128 v10, a[52:55] offset:13312
  buffer_load_dwordx4 a[212:215], v9, s[52:55], s56 offen offset:1024 sc1
  ds_write_b128 v10, a[80:83] offset:20480
  buffer_load_dwordx4 a[216:219], v9, s[52:55], s56 offen offset:2048 sc1
  ds_write_b128 v10, a[108:111] offset:27648
  buffer_load_dwordx4 a[220:223], v9, s[52:55], s56 offen offset:3072 sc1
  s_waitcnt vmcnt(28)
  v_add_u32 v12, 65536, v11
  v_lshlrev_b32 v254, 16, v254
  v_lshlrev_b32 v128, 16, v240
  v_and_b32 v129, s38, v240
  v_lshlrev_b32 v130, 16, v241
  v_and_b32 v131, s38, v241
  v_lshlrev_b32 v132, 16, v242
  v_and_b32 v133, s38, v242
  v_lshlrev_b32 v134, 16, v243
  v_and_b32 v135, s38, v243
  v_lshlrev_b32 v136, 16, v244
  v_and_b32 v137, s38, v244
  v_lshlrev_b32 v138, 16, v245
  v_and_b32 v139, s38, v245
  v_lshlrev_b32 v140, 16, v246
  v_and_b32 v141, s38, v246
  v_lshlrev_b32 v142, 16, v247
  v_and_b32 v143, s38, v247
  v_lshlrev_b32 v144, 16, v248
  v_and_b32 v145, s38, v248
  v_lshlrev_b32 v146, 16, v249
  v_and_b32 v147, s38, v249
  v_lshlrev_b32 v148, 16, v250
  v_and_b32 v149, s38, v250
  v_lshlrev_b32 v150, 16, v251
  v_and_b32 v151, s38, v251
  v_lshlrev_b32 v152, 16, v252
  v_and_b32 v153, s38, v252
  v_lshlrev_b32 v154, 16, v253
  v_and_b32 v155, s38, v253
  s_waitcnt lgkmcnt(0)
  s_barrier
  ds_read_b128 v[16:19], v11 offset:0
  ds_read_b128 v[20:23], v11 offset:1024
  ds_read_b128 v[24:27], v11 offset:2048
  ds_read_b128 v[28:31], v11 offset:3072
  ds_read_b128 v[32:35], v11 offset:4096
  ds_read_b128 v[36:39], v11 offset:5120
  ds_read_b128 v[40:43], v11 offset:6144
  ds_read_b128 v[44:47], v11 offset:32768
  ds_read_b128 v[48:51], v11 offset:33792
  ds_read_b128 v[52:55], v11 offset:34816
  ds_read_b128 v[56:59], v11 offset:35840
  ds_read_b128 v[60:63], v11 offset:36864
  ds_read_b128 v[64:67], v11 offset:37888
  ds_read_b128 v[68:71], v11 offset:38912
  ds_read_b128 v[72:75], v12 offset:0
  ds_read_b128 v[76:79], v12 offset:1024
  ds_read_b128 v[80:83], v12 offset:2048
  ds_read_b128 v[84:87], v12 offset:3072
  ds_read_b128 v[88:91], v12 offset:4096
  ds_read_b128 v[92:95], v12 offset:5120
  ds_read_b128 v[96:99], v12 offset:6144
  ds_read_b128 v[100:103], v12 offset:32768
  ds_read_b128 v[104:107], v12 offset:33792
  ds_read_b128 v[108:111], v12 offset:34816
  ds_read_b128 v[112:115], v12 offset:35840
  ds_read_b128 v[116:119], v12 offset:36864
  ds_read_b128 v[120:123], v12 offset:37888
  ds_read_b128 v[124:127], v12 offset:38912
  s_waitcnt lgkmcnt(14)
  v_pk_add_f32 v[16:17], v[16:17], v[44:45]
  v_pk_add_f32 v[18:19], v[18:19], v[46:47]
  v_pk_add_f32 v[20:21], v[20:21], v[48:49]
  v_pk_add_f32 v[22:23], v[22:23], v[50:51]
  v_pk_add_f32 v[24:25], v[24:25], v[52:53]
  v_pk_add_f32 v[26:27], v[26:27], v[54:55]
  v_pk_add_f32 v[28:29], v[28:29], v[56:57]
  v_pk_add_f32 v[30:31], v[30:31], v[58:59]
  v_pk_add_f32 v[32:33], v[32:33], v[60:61]
  v_pk_add_f32 v[34:35], v[34:35], v[62:63]
  v_pk_add_f32 v[36:37], v[36:37], v[64:65]
  v_pk_add_f32 v[38:39], v[38:39], v[66:67]
  v_pk_add_f32 v[40:41], v[40:41], v[68:69]
  v_pk_add_f32 v[42:43], v[42:43], v[70:71]
  s_waitcnt lgkmcnt(7)
  v_pk_add_f32 v[16:17], v[16:17], v[72:73]
  v_pk_add_f32 v[18:19], v[18:19], v[74:75]
  v_pk_add_f32 v[20:21], v[20:21], v[76:77]
  v_pk_add_f32 v[22:23], v[22:23], v[78:79]
  v_pk_add_f32 v[24:25], v[24:25], v[80:81]
  v_pk_add_f32 v[26:27], v[26:27], v[82:83]
  v_pk_add_f32 v[28:29], v[28:29], v[84:85]
  v_pk_add_f32 v[30:31], v[30:31], v[86:87]
  v_pk_add_f32 v[32:33], v[32:33], v[88:89]
  v_pk_add_f32 v[34:35], v[34:35], v[90:91]
  v_pk_add_f32 v[36:37], v[36:37], v[92:93]
  v_pk_add_f32 v[38:39], v[38:39], v[94:95]
  v_pk_add_f32 v[40:41], v[40:41], v[96:97]
  v_pk_add_f32 v[42:43], v[42:43], v[98:99]
  s_waitcnt lgkmcnt(0)
  v_pk_add_f32 v[16:17], v[16:17], v[100:101]
  v_pk_add_f32 v[18:19], v[18:19], v[102:103]
  v_pk_add_f32 v[20:21], v[20:21], v[104:105]
  v_pk_add_f32 v[22:23], v[22:23], v[106:107]
  v_pk_add_f32 v[24:25], v[24:25], v[108:109]
  v_pk_add_f32 v[26:27], v[26:27], v[110:111]
  v_pk_add_f32 v[28:29], v[28:29], v[112:113]
  v_pk_add_f32 v[30:31], v[30:31], v[114:115]
  v_pk_add_f32 v[32:33], v[32:33], v[116:117]
  v_pk_add_f32 v[34:35], v[34:35], v[118:119]
  v_pk_add_f32 v[36:37], v[36:37], v[120:121]
  v_pk_add_f32 v[38:39], v[38:39], v[122:123]
  v_pk_add_f32 v[40:41], v[40:41], v[124:125]
  v_pk_add_f32 v[42:43], v[42:43], v[126:127]
  v_pk_add_f32 v[16:17], v[16:17], v[254:255] op_sel_hi:[1,0]
  v_pk_add_f32 v[18:19], v[18:19], v[254:255] op_sel_hi:[1,0]
  v_pk_add_f32 v[20:21], v[20:21], v[254:255] op_sel_hi:[1,0]
  v_pk_add_f32 v[22:23], v[22:23], v[254:255] op_sel_hi:[1,0]
  v_pk_add_f32 v[24:25], v[24:25], v[254:255] op_sel_hi:[1,0]
  v_pk_add_f32 v[26:27], v[26:27], v[254:255] op_sel_hi:[1,0]
  v_pk_add_f32 v[28:29], v[28:29], v[254:255] op_sel_hi:[1,0]
  v_pk_add_f32 v[30:31], v[30:31], v[254:255] op_sel_hi:[1,0]
  v_pk_add_f32 v[32:33], v[32:33], v[254:255] op_sel_hi:[1,0]
  v_pk_add_f32 v[34:35], v[34:35], v[254:255] op_sel_hi:[1,0]
  v_pk_add_f32 v[36:37], v[36:37], v[254:255] op_sel_hi:[1,0]
  v_pk_add_f32 v[38:39], v[38:39], v[254:255] op_sel_hi:[1,0]
  v_pk_add_f32 v[40:41], v[40:41], v[254:255] op_sel_hi:[1,0]
  v_pk_add_f32 v[42:43], v[42:43], v[254:255] op_sel_hi:[1,0]
  v_pk_mul_f32 v[16:17], v[16:17], v[128:129]
  v_pk_mul_f32 v[18:19], v[18:19], v[130:131]
  v_pk_mul_f32 v[20:21], v[20:21], v[132:133]
  v_pk_mul_f32 v[22:23], v[22:23], v[134:135]
  v_pk_mul_f32 v[24:25], v[24:25], v[136:137]
  v_pk_mul_f32 v[26:27], v[26:27], v[138:139]
  v_pk_mul_f32 v[28:29], v[28:29], v[140:141]
  v_pk_mul_f32 v[30:31], v[30:31], v[142:143]
  v_pk_mul_f32 v[32:33], v[32:33], v[144:145]
  v_pk_mul_f32 v[34:35], v[34:35], v[146:147]
  v_pk_mul_f32 v[36:37], v[36:37], v[148:149]
  v_pk_mul_f32 v[38:39], v[38:39], v[150:151]
  v_pk_mul_f32 v[40:41], v[40:41], v[152:153]
  v_pk_mul_f32 v[42:43], v[42:43], v[154:155]
  v_cvt_pk_bf16_f32 v128, v16, v17
  v_cvt_pk_bf16_f32 v129, v18, v19
  v_cvt_pk_bf16_f32 v130, v20, v21
  v_cvt_pk_bf16_f32 v131, v22, v23
  v_cvt_pk_bf16_f32 v132, v24, v25
  v_cvt_pk_bf16_f32 v133, v26, v27
  v_cvt_pk_bf16_f32 v134, v28, v29
  v_cvt_pk_bf16_f32 v135, v30, v31
  v_cvt_pk_bf16_f32 v136, v32, v33
  v_cvt_pk_bf16_f32 v137, v34, v35
  v_cvt_pk_bf16_f32 v138, v36, v37
  v_cvt_pk_bf16_f32 v139, v38, v39
  v_cvt_pk_bf16_f32 v140, v40, v41
  v_cvt_pk_bf16_f32 v141, v42, v43
  s_add_u32 s36, s37, 1
  s_lshr_b32 s57, s36, 1
  s_lshl_b32 s57, s57, 10
  v_lshlrev_b32 v13, 3, v1
  s_bitcmp1_b32 s34, 0
  s_cbranch_scc1 K4_ODD
  buffer_store_dwordx4 v[128:131], v9, s[24:27], s57 offen offset:0 sc1
  buffer_store_dwordx4 v[132:135], v9, s[24:27], s57 offen offset:1024 sc1
  buffer_store_dwordx4 v[136:139], v9, s[24:27], s57 offen offset:2048 sc1
  buffer_store_dwordx2 v[140:141], v13, s[24:27], s57 offen offset:3072 sc1
  s_branch K4_FIN
K4_ODD:
  v_mov_b32 v16, v130
  v_mov_b32 v17, v131
  v_mov_b32 v18, v132
  v_mov_b32 v19, v133
  v_mov_b32 v20, v134
  v_mov_b32 v21, v135
  v_mov_b32 v22, v136
  v_mov_b32 v23, v137
  v_mov_b32 v24, v138
  v_mov_b32 v25, v139
  v_mov_b32 v26, v140
  v_mov_b32 v27, v141
  s_sub_u32 s36, s57, 512
  buffer_store_dwordx2 v[128:129], v13, s[24:27], s36 offen sc1
  buffer_store_dwordx4 v[16:19], v9, s[24:27], s57 offen offset:0 sc1
  buffer_store_dwordx4 v[20:23], v9, s[24:27], s57 offen offset:1024 sc1
  buffer_store_dwordx4 v[24:27], v9, s[24:27], s57 offen offset:2048 sc1
K4_FIN:
  s_lshl_b32 s35, s33, 8
  s_add_u32 s35, s35, 0x2d000
  v_mov_b32 v2, s35
  v_mov_b32 v3, 1
  s_waitcnt vmcnt(0)
  s_barrier
  s_cmp_lg_u32 s32, 0
  s_cbranch_scc1 K5_NOPUB
  s_mov_b64 exec, 1
  global_atomic_add v2, v3, s[20:21]
  s_mov_b64 exec, -1
K5_NOPUB:
  s_mov_b32 s41, 28672
  s_mov_b32 s42, 57344
  s_mov_b32 s43, 86016
  s_mul_i32 s35, s33, 114688
  s_mul_i32 s37, s32, 7168
  s_add_u32 s35, s35, s37
  s_add_u32 s8, s20, 0x1400000
  s_addc_u32 s9, s21, 0
  s_add_u32 s8, s8, s35
  s_addc_u32 s9, s9, 0
  s_mov_b32 s10, 0x16c00
  s_mov_b32 s11, 0x20000
  v_and_b32 v8, 15, v1
  v_lshrrev_b32 v10, 4, v1
  v_lshlrev_b32 v14, 10, v8
  v_lshl_add_u32 v14, v10, 4, v14
  v_lshlrev_b32 v15, 9, v10
  v_lshl_add_u32 v15, v8, 4, v15
  v_lshlrev_b32 v11, 5, v10
  s_lshl_b32 s35, s33, 2
  s_add_u32 s35, s35, s32
  s_lshl_b32 s37, s35, 14
  s_lshl_b32 s57, s34, 7
  s_add_u32 s37, s37, s57
  s_add_u32 s12, s50, s37
  s_addc_u32 s13, s51, 0
  s_mov_b32 s14, 0x3c80
  s_mov_b32 s15, 0x20000
  s_lshr_b32 s37, s35, 1
  s_lshl_b32 s37, s37, 15
  s_and_b32 s57, s35, 1
  s_lshl_b32 s57, s57, 8
  s_add_u32 s37, s37, s57
  s_lshl_b32 s57, s34, 12
  s_add_u32 s37, s37, s57
  s_add_u32 s24, s20, 0x400000
  s_addc_u32 s25, s21, 0
  s_add_u32 s24, s24, s37
  s_addc_u32 s25, s25, 0
  s_mov_b32 s26, 0xf00
  s_mov_b32 s27, 0x20000
  s_lshl_b32 s37, s34, 8
  s_add_u32 s28, s20, 0x2800
  s_addc_u32 s29, s21, 0
  s_add_u32 s28, s28, s37
  s_addc_u32 s29, s29, 0
  s_mov_b32 s30, 0x100
  s_mov_b32 s31, 0x20000
  buffer_load_dwordx4 v[208:211], v15, s[24:27], 0 offen offset:0 sc1
  buffer_load_dwordx4 v[212:215], v15, s[24:27], 0 offen offset:2048 sc1
  buffer_load_dwordx4 v[216:219], v11, s[28:31], 0 offen offset:0 sc1
  buffer_load_dwordx4 v[220:223], v11, s[28:31], 0 offen offset:16 sc1
  buffer_load_dwordx4 v[224:227], v11, s[28:31], 0 offen offset:128 sc1
  buffer_load_dwordx4 v[228:231], v11, s[28:31], 0 offen offset:144 sc1
  s_cmp_lg_u32 s32, 0
  s_cbranch_scc1 K5_NOPOLL
  s_mov_b32 s57, 0
K5_POLL:
  global_load_dword v3, v2, s[20:21] sc1
  s_waitcnt vmcnt(0)
  v_readfirstlane_b32 s37, v3
  s_add_u32 s57, s57, 1
  s_cmp_ge_u32 s37, 8
  s_cbranch_scc1 K5_NOPOLL
  s_cmp_lt_u32 s57, 0x100000
  s_cbranch_scc1 K5_POLL
K5_NOPOLL:
  s_barrier
  v_add_u32 v3, 4096, v9
  buffer_load_dwordx4 v[96:99], v9, s[8:11], 0 offen offset:0 sc1
  buffer_load_dwordx4 v[100:103], v9, s[8:11], s41 offen offset:0 sc1
  buffer_load_dwordx4 v[104:107], v9, s[8:11], s42 offen offset:0 sc1
  buffer_load_dwordx4 v[108:111], v9, s[8:11], s43 offen offset:0 sc1
  buffer_load_dwordx4 v[112:115], v9, s[8:11], 0 offen offset:1024 sc1
  buffer_load_dwordx4 v[116:119], v9, s[8:11], s41 offen offset:1024 sc1
  buffer_load_dwordx4 v[120:123], v9, s[8:11], s42 offen offset:1024 sc1
  buffer_load_dwordx4 v[124:127], v9, s[8:11], s43 offen offset:1024 sc1
  buffer_load_dwordx4 v[128:131], v9, s[8:11], 0 offen offset:2048 sc1
  buffer_load_dwordx4 v[132:135], v9, s[8:11], s41 offen offset:2048 sc1
  buffer_load_dwordx4 v[136:139], v9, s[8:11], s42 offen offset:2048 sc1
  buffer_load_dwordx4 v[140:143], v9, s[8:11], s43 offen offset:2048 sc1
  buffer_load_dwordx2 v[144:145], v13, s[8:11], 0 offen offset:3072 sc1
  buffer_load_dwordx2 v[146:147], v13, s[8:11], 0 offen offset:3584 sc1
  buffer_load_dwordx2 v[148:149], v13, s[8:11], s41 offen offset:3072 sc1
  buffer_load_dwordx2 v[150:151], v13, s[8:11], s41 offen offset:3584 sc1
  buffer_load_dwordx2 v[152:153], v13, s[8:11], s42 offen offset:3072 sc1
  buffer_load_dwordx2 v[154:155], v13, s[8:11], s42 offen offset:3584 sc1
  buffer_load_dwordx2 v[156:157], v13, s[8:11], s43 offen offset:3072 sc1
  buffer_load_dwordx2 v[158:159], v13, s[8:11], s43 offen offset:3584 sc1
  buffer_load_dwordx4 v[160:163], v3, s[8:11], 0 offen offset:0 sc1
  buffer_load_dwordx4 v[164:167], v3, s[8:11], s41 offen offset:0 sc1
  buffer_load_dwordx4 v[168:171], v3, s[8:11], s42 offen offset:0 sc1
  buffer_load_dwordx4 v[172:175], v3, s[8:11], s43 offen offset:0 sc1
  buffer_load_dwordx4 v[176:179], v3, s[8:11], 0 offen offset:1024 sc1
  buffer_load_dwordx4 v[180:183], v3, s[8:11], s41 offen offset:1024 sc1
  buffer_load_dwordx4 v[184:187], v3, s[8:11], s42 offen offset:1024 sc1
  buffer_load_dwordx4 v[188:191], v3, s[8:11], s43 offen offset:1024 sc1
  buffer_load_dwordx4 v[192:195], v3, s[8:11], 0 offen offset:2048 sc1
  buffer_load_dwordx4 v[196:199], v3, s[8:11], s41 offen offset:2048 sc1
  buffer_load_dwordx4 v[200:203], v3, s[8:11], s42 offen offset:2048 sc1
  buffer_load_dwordx4 v[204:207], v3, s[8:11], s43 offen offset:2048 sc1
  s_mov_b32 s38, 0xffff0000
  s_waitcnt vmcnt(32)
  v_lshlrev_b32 v64, 16, v208
  v_and_b32 v65, s38, v208
  v_lshlrev_b32 v66, 16, v209
  v_and_b32 v67, s38, v209
  v_lshlrev_b32 v68, 16, v210
  v_and_b32 v69, s38, v210
  v_lshlrev_b32 v70, 16, v211
  v_and_b32 v71, s38, v211
  v_lshlrev_b32 v72, 16, v212
  v_and_b32 v73, s38, v212
  v_lshlrev_b32 v74, 16, v213
  v_and_b32 v75, s38, v213
  v_lshlrev_b32 v76, 16, v214
  v_and_b32 v77, s38, v214
  v_lshlrev_b32 v78, 16, v215
  v_and_b32 v79, s38, v215
  s_waitcnt vmcnt(31)
  v_mfma_f32_16x16x32_bf16 a[0:3], a[112:115], v[96:99], 0
  v_mfma_f32_16x16x32_bf16 a[4:7], a[116:119], v[96:99], 0
  v_mfma_f32_16x16x32_bf16 a[8:11], a[120:123], v[96:99], 0
  v_mfma_f32_16x16x32_bf16 a[12:15], a[124:127], v[96:99], 0
  s_waitcnt vmcnt(30)
  v_mfma_f32_16x16x32_bf16 a[16:19], a[112:115], v[100:103], 0
  v_mfma_f32_16x16x32_bf16 a[20:23], a[116:119], v[100:103], 0
  v_mfma_f32_16x16x32_bf16 a[24:27], a[120:123], v[100:103], 0
  v_mfma_f32_16x16x32_bf16 a[28:31], a[124:127], v[100:103], 0
  s_waitcnt vmcnt(29)
  v_mfma_f32_16x16x32_bf16 a[32:35], a[112:115], v[104:107], 0
  v_mfma_f32_16x16x32_bf16 a[36:39], a[116:119], v[104:107], 0
  v_mfma_f32_16x16x32_bf16 a[40:43], a[120:123], v[104:107], 0
  v_mfma_f32_16x16x32_bf16 a[44:47], a[124:127], v[104:107], 0
  s_waitcnt vmcnt(28)
  v_mfma_f32_16x16x32_bf16 a[48:51], a[112:115], v[108:111], 0
  v_mfma_f32_16x16x32_bf16 a[52:55], a[116:119], v[108:111], 0
  v_mfma_f32_16x16x32_bf16 a[56:59], a[120:123], v[108:111], 0
  v_mfma_f32_16x16x32_bf16 a[60:63], a[124:127], v[108:111], 0
  s_waitcnt vmcnt(27)
  v_mfma_f32_16x16x32_bf16 a[0:3], a[128:131], v[112:115], a[0:3]
  v_mfma_f32_16x16x32_bf16 a[4:7], a[132:135], v[112:115], a[4:7]
  v_mfma_f32_16x16x32_bf16 a[8:11], a[136:139], v[112:115], a[8:11]
  v_mfma_f32_16x16x32_bf16 a[12:15], a[140:143], v[112:115], a[12:15]
  s_waitcnt vmcnt(26)
  v_mfma_f32_16x16x32_bf16 a[16:19], a[128:131], v[116:119], a[16:19]
  v_mfma_f32_16x16x32_bf16 a[20:23], a[132:135], v[116:119], a[20:23]
  v_mfma_f32_16x16x32_bf16 a[24:27], a[136:139], v[116:119], a[24:27]
  v_mfma_f32_16x16x32_bf16 a[28:31], a[140:143], v[116:119], a[28:31]
  s_waitcnt vmcnt(25)
  v_mfma_f32_16x16x32_bf16 a[32:35], a[128:131], v[120:123], a[32:35]
  v_mfma_f32_16x16x32_bf16 a[36:39], a[132:135], v[120:123], a[36:39]
  v_mfma_f32_16x16x32_bf16 a[40:43], a[136:139], v[120:123], a[40:43]
  v_mfma_f32_16x16x32_bf16 a[44:47], a[140:143], v[120:123], a[44:47]
  s_waitcnt vmcnt(24)
  v_mfma_f32_16x16x32_bf16 a[48:51], a[128:131], v[124:127], a[48:51]
  v_mfma_f32_16x16x32_bf16 a[52:55], a[132:135], v[124:127], a[52:55]
  v_mfma_f32_16x16x32_bf16 a[56:59], a[136:139], v[124:127], a[56:59]
  v_mfma_f32_16x16x32_bf16 a[60:63], a[140:143], v[124:127], a[60:63]
  s_waitcnt vmcnt(23)
  v_mfma_f32_16x16x32_bf16 a[0:3], a[144:147], v[128:131], a[0:3]
  v_mfma_f32_16x16x32_bf16 a[4:7], a[148:151], v[128:131], a[4:7]
  v_mfma_f32_16x16x32_bf16 a[8:11], a[152:155], v[128:131], a[8:11]
  v_mfma_f32_16x16x32_bf16 a[12:15], a[156:159], v[128:131], a[12:15]
  s_waitcnt vmcnt(22)
  v_mfma_f32_16x16x32_bf16 a[16:19], a[144:147], v[132:135], a[16:19]
  v_mfma_f32_16x16x32_bf16 a[20:23], a[148:151], v[132:135], a[20:23]
  v_mfma_f32_16x16x32_bf16 a[24:27], a[152:155], v[132:135], a[24:27]
  v_mfma_f32_16x16x32_bf16 a[28:31], a[156:159], v[132:135], a[28:31]
  s_waitcnt vmcnt(21)
  v_mfma_f32_16x16x32_bf16 a[32:35], a[144:147], v[136:139], a[32:35]
  v_mfma_f32_16x16x32_bf16 a[36:39], a[148:151], v[136:139], a[36:39]
  v_mfma_f32_16x16x32_bf16 a[40:43], a[152:155], v[136:139], a[40:43]
  v_mfma_f32_16x16x32_bf16 a[44:47], a[156:159], v[136:139], a[44:47]
  s_waitcnt vmcnt(20)
  v_mfma_f32_16x16x32_bf16 a[48:51], a[144:147], v[140:143], a[48:51]
  v_mfma_f32_16x16x32_bf16 a[52:55], a[148:151], v[140:143], a[52:55]
  v_mfma_f32_16x16x32_bf16 a[56:59], a[152:155], v[140:143], a[56:59]
  v_mfma_f32_16x16x32_bf16 a[60:63], a[156:159], v[140:143], a[60:63]
  s_waitcnt vmcnt(18)
  v_mfma_f32_16x16x32_bf16 a[0:3], a[160:163], v[144:147], a[0:3]
  v_mfma_f32_16x16x32_bf16 a[4:7], a[164:167], v[144:147], a[4:7]
  v_mfma_f32_16x16x32_bf16 a[8:11], a[168:171], v[144:147], a[8:11]
  v_mfma_f32_16x16x32_bf16 a[12:15], a[172:175], v[144:147], a[12:15]
  s_waitcnt vmcnt(16)
  v_mfma_f32_16x16x32_bf16 a[16:19], a[160:163], v[148:151], a[16:19]
  v_mfma_f32_16x16x32_bf16 a[20:23], a[164:167], v[148:151], a[20:23]
  v_mfma_f32_16x16x32_bf16 a[24:27], a[168:171], v[148:151], a[24:27]
  v_mfma_f32_16x16x32_bf16 a[28:31], a[172:175], v[148:151], a[28:31]
  s_waitcnt vmcnt(14)
  v_mfma_f32_16x16x32_bf16 a[32:35], a[160:163], v[152:155], a[32:35]
  v_mfma_f32_16x16x32_bf16 a[36:39], a[164:167], v[152:155], a[36:39]
  v_mfma_f32_16x16x32_bf16 a[40:43], a[168:171], v[152:155], a[40:43]
  v_mfma_f32_16x16x32_bf16 a[44:47], a[172:175], v[152:155], a[44:47]
  s_waitcnt vmcnt(12)
  v_mfma_f32_16x16x32_bf16 a[48:51], a[160:163], v[156:159], a[48:51]
  v_mfma_f32_16x16x32_bf16 a[52:55], a[164:167], v[156:159], a[52:55]
  v_mfma_f32_16x16x32_bf16 a[56:59], a[168:171], v[156:159], a[56:59]
  v_mfma_f32_16x16x32_bf16 a[60:63], a[172:175], v[156:159], a[60:63]
  s_waitcnt vmcnt(11)
  v_mfma_f32_16x16x32_bf16 a[0:3], a[176:179], v[160:163], a[0:3]
  v_mfma_f32_16x16x32_bf16 a[4:7], a[180:183], v[160:163], a[4:7]
  v_mfma_f32_16x16x32_bf16 a[8:11], a[184:187], v[160:163], a[8:11]
  v_mfma_f32_16x16x32_bf16 a[12:15], a[188:191], v[160:163], a[12:15]
  s_waitcnt vmcnt(10)
  v_mfma_f32_16x16x32_bf16 a[16:19], a[176:179], v[164:167], a[16:19]
  v_mfma_f32_16x16x32_bf16 a[20:23], a[180:183], v[164:167], a[20:23]
  v_mfma_f32_16x16x32_bf16 a[24:27], a[184:187], v[164:167], a[24:27]
  v_mfma_f32_16x16x32_bf16 a[28:31], a[188:191], v[164:167], a[28:31]
  s_waitcnt vmcnt(9)
  v_mfma_f32_16x16x32_bf16 a[32:35], a[176:179], v[168:171], a[32:35]
  v_mfma_f32_16x16x32_bf16 a[36:39], a[180:183], v[168:171], a[36:39]
  v_mfma_f32_16x16x32_bf16 a[40:43], a[184:187], v[168:171], a[40:43]
  v_mfma_f32_16x16x32_bf16 a[44:47], a[188:191], v[168:171], a[44:47]
  s_waitcnt vmcnt(8)
  v_mfma_f32_16x16x32_bf16 a[48:51], a[176:179], v[172:175], a[48:51]
  v_mfma_f32_16x16x32_bf16 a[52:55], a[180:183], v[172:175], a[52:55]
  v_mfma_f32_16x16x32_bf16 a[56:59], a[184:187], v[172:175], a[56:59]
  v_mfma_f32_16x16x32_bf16 a[60:63], a[188:191], v[172:175], a[60:63]
  s_waitcnt vmcnt(7)
  v_mfma_f32_16x16x32_bf16 a[0:3], a[192:195], v[176:179], a[0:3]
  v_mfma_f32_16x16x32_bf16 a[4:7], a[196:199], v[176:179], a[4:7]
  v_mfma_f32_16x16x32_bf16 a[8:11], a[200:203], v[176:179], a[8:11]
  v_mfma_f32_16x16x32_bf16 a[12:15], a[204:207], v[176:179], a[12:15]
  s_waitcnt vmcnt(6)
  v_mfma_f32_16x16x32_bf16 a[16:19], a[192:195], v[180:183], a[16:19]
  v_mfma_f32_16x16x32_bf16 a[20:23], a[196:199], v[180:183], a[20:23]
  v_mfma_f32_16x16x32_bf16 a[24:27], a[200:203], v[180:183], a[24:27]
  v_mfma_f32_16x16x32_bf16 a[28:31], a[204:207], v[180:183], a[28:31]
  s_waitcnt vmcnt(5)
  v_mfma_f32_16x16x32_bf16 a[32:35], a[192:195], v[184:187], a[32:35]
  v_mfma_f32_16x16x32_bf16 a[36:39], a[196:199], v[184:187], a[36:39]
  v_mfma_f32_16x16x32_bf16 a[40:43], a[200:203], v[184:187], a[40:43]
  v_mfma_f32_16x16x32_bf16 a[44:47], a[204:207], v[184:187], a[44:47]
  s_waitcnt vmcnt(4)
  v_mfma_f32_16x16x32_bf16 a[48:51], a[192:195], v[188:191], a[48:51]
  v_mfma_f32_16x16x32_bf16 a[52:55], a[196:199], v[188:191], a[52:55]
  v_mfma_f32_16x16x32_bf16 a[56:59], a[200:203], v[188:191], a[56:59]
  v_mfma_f32_16x16x32_bf16 a[60:63], a[204:207], v[188:191], a[60:63]
  s_waitcnt vmcnt(3)
  v_mfma_f32_16x16x32_bf16 a[0:3], a[208:211], v[192:195], a[0:3]
  v_mfma_f32_16x16x32_bf16 a[4:7], a[212:215], v[192:195], a[4:7]
  v_mfma_f32_16x16x32_bf16 a[8:11], a[216:219], v[192:195], a[8:11]
  v_mfma_f32_16x16x32_bf16 a[12:15], a[220:223], v[192:195], a[12:15]
  s_waitcnt vmcnt(2)
  v_mfma_f32_16x16x32_bf16 a[16:19], a[208:211], v[196:199], a[16:19]
  v_mfma_f32_16x16x32_bf16 a[20:23], a[212:215], v[196:199], a[20:23]
  v_mfma_f32_16x16x32_bf16 a[24:27], a[216:219], v[196:199], a[24:27]
  v_mfma_f32_16x16x32_bf16 a[28:31], a[220:223], v[196:199], a[28:31]
  s_waitcnt vmcnt(1)
  v_mfma_f32_16x16x32_bf16 a[32:35], a[208:211], v[200:203], a[32:35]
  v_mfma_f32_16x16x32_bf16 a[36:39], a[212:215], v[200:203], a[36:39]
  v_mfma_f32_16x16x32_bf16 a[40:43], a[216:219], v[200:203], a[40:43]
  v_mfma_f32_16x16x32_bf16 a[44:47], a[220:223], v[200:203], a[44:47]
  s_waitcnt vmcnt(0)
  v_mfma_f32_16x16x32_bf16 a[48:51], a[208:211], v[204:207], a[48:51]
  v_mfma_f32_16x16x32_bf16 a[52:55], a[212:215], v[204:207], a[52:55]
  v_mfma_f32_16x16x32_bf16 a[56:59], a[216:219], v[204:207], a[56:59]
  v_mfma_f32_16x16x32_bf16 a[60:63], a[220:223], v[204:207], a[60:63]
  v_add_u32 v4, s39, v9
  s_lshl_b32 s37, s32, 12
  v_add_u32 v5, s37, v9
  v_add_u32 v6, 65536, v5
  s_nop 3
  ds_write_b128 v4, a[0:3] offset:0
  ds_write_b128 v4, a[4:7] offset:1024
  ds_write_b128 v4, a[8:11] offset:2048
  ds_write_b128 v4, a[12:15] offset:3072
  ds_write_b128 v4, a[16:19] offset:4096
  ds_write_b128 v4, a[20:23] offset:5120
  ds_write_b128 v4, a[24:27] offset:6144
  ds_write_b128 v4, a[28:31] offset:7168
  ds_write_b128 v4, a[32:35] offset:8192
  ds_write_b128 v4, a[36:39] offset:9216
  ds_write_b128 v4, a[40:43] offset:10240
  ds_write_b128 v4, a[44:47] offset:11264
  ds_write_b128 v4, a[48:51] offset:12288
  ds_write_b128 v4, a[52:55] offset:13312
  ds_write_b128 v4, a[56:59] offset:14336
  ds_write_b128 v4, a[60:63] offset:15360
  s_waitcnt lgkmcnt(0)
  s_barrier
  ds_read_b128 v[96:99], v5 offset:0
  ds_read_b128 v[100:103], v5 offset:1024
  ds_read_b128 v[104:107], v5 offset:2048
  ds_read_b128 v[108:111], v5 offset:3072
  ds_read_b128 v[112:115], v5 offset:32768
  ds_read_b128 v[116:119], v5 offset:33792
  ds_read_b128 v[120:123], v5 offset:34816
  ds_read_b128 v[124:127], v5 offset:35840
  ds_read_b128 v[128:131], v6 offset:0
  ds_read_b128 v[132:135], v6 offset:1024
  ds_read_b128 v[136:139], v6 offset:2048
  ds_read_b128 v[140:143], v6 offset:3072
  ds_read_b128 v[144:147], v6 offset:32768
  ds_read_b128 v[148:151], v6 offset:33792
  ds_read_b128 v[152:155], v6 offset:34816
  ds_read_b128 v[156:159], v6 offset:35840
  s_waitcnt lgkmcnt(8)
  v_pk_add_f32 v[96:97], v[96:97], v[112:113]
  v_pk_add_f32 v[98:99], v[98:99], v[114:115]
  v_pk_add_f32 v[100:101], v[100:101], v[116:117]
  v_pk_add_f32 v[102:103], v[102:103], v[118:119]
  v_pk_add_f32 v[104:105], v[104:105], v[120:121]
  v_pk_add_f32 v[106:107], v[106:107], v[122:123]
  v_pk_add_f32 v[108:109], v[108:109], v[124:125]
  v_pk_add_f32 v[110:111], v[110:111], v[126:127]
  s_waitcnt lgkmcnt(4)
  v_pk_add_f32 v[96:97], v[96:97], v[128:129]
  v_pk_add_f32 v[98:99], v[98:99], v[130:131]
  v_pk_add_f32 v[100:101], v[100:101], v[132:133]
  v_pk_add_f32 v[102:103], v[102:103], v[134:135]
  v_pk_add_f32 v[104:105], v[104:105], v[136:137]
  v_pk_add_f32 v[106:107], v[106:107], v[138:139]
  v_pk_add_f32 v[108:109], v[108:109], v[140:141]
  v_pk_add_f32 v[110:111], v[110:111], v[142:143]
  s_waitcnt lgkmcnt(0)
  v_pk_add_f32 v[96:97], v[96:97], v[144:145]
  v_pk_add_f32 v[98:99], v[98:99], v[146:147]
  v_pk_add_f32 v[100:101], v[100:101], v[148:149]
  v_pk_add_f32 v[102:103], v[102:103], v[150:151]
  v_pk_add_f32 v[104:105], v[104:105], v[152:153]
  v_pk_add_f32 v[106:107], v[106:107], v[154:155]
  v_pk_add_f32 v[108:109], v[108:109], v[156:157]
  v_pk_add_f32 v[110:111], v[110:111], v[158:159]
  v_pk_fma_f32 v[96:97], v[96:97], v[216:217], v[64:65]
  v_pk_fma_f32 v[98:99], v[98:99], v[218:219], v[66:67]
  v_pk_fma_f32 v[100:101], v[100:101], v[220:221], v[68:69]
  v_pk_fma_f32 v[102:103], v[102:103], v[222:223], v[70:71]
  v_pk_fma_f32 v[104:105], v[104:105], v[224:225], v[72:73]
  v_pk_fma_f32 v[106:107], v[106:107], v[226:227], v[74:75]
  v_pk_fma_f32 v[108:109], v[108:109], v[228:229], v[76:77]
  v_pk_fma_f32 v[110:111], v[110:111], v[230:231], v[78:79]
  v_cvt_pk_bf16_f32 v64, v96, v97
  v_cvt_pk_bf16_f32 v65, v98, v99
  v_cvt_pk_bf16_f32 v66, v100, v101
  v_cvt_pk_bf16_f32 v67, v102, v103
  v_cvt_pk_bf16_f32 v68, v104, v105
  v_cvt_pk_bf16_f32 v69, v106, v107
  v_cvt_pk_bf16_f32 v70, v108, v109
  v_cvt_pk_bf16_f32 v71, v110, v111
  buffer_store_dwordx4 v[64:67], v14, s[12:15], 0 offen offset:0 nt
  buffer_store_dwordx4 v[68:71], v14, s[12:15], 0 offen offset:64 nt
K4_END:
  s_endpgm
CODE_END:
.section .rodata,"a"
.p2align 6
.amdhsa_kernel adaLN_cond__sliding_block_cached__mixer_gmlp__prompt_kernel
  .amdhsa_next_free_vgpr 512
  .amdhsa_next_free_sgpr 102
  .amdhsa_accum_offset 256
  .amdhsa_group_segment_fixed_size 0
  .amdhsa_kernarg_size 120
  .amdhsa_user_sgpr_count 2
  .amdhsa_user_sgpr_kernarg_segment_ptr 1
  .amdhsa_system_sgpr_workgroup_id_x 1
  .amdhsa_float_denorm_mode_32 3
  .amdhsa_fp16_overflow 1
.end_amdhsa_kernel
```
